```python
import torch

def _softmax(x, axis=-1):
    return torch.softmax(x, dim=axis)
def _gelu(x):
    return torch.nn.functional.gelu(x, approximate="tanh")
def _silu(x):
    return torch.nn.functional.silu(x)
def _sigmoid(x):
    return torch.sigmoid(x)
def _layernorm(x, axis=-1, eps=1e-5):
    m = x.mean(dim=axis, keepdim=True)
    v = x.var(dim=axis, keepdim=True, unbiased=False)
    return (x - m) / torch.sqrt(v + eps)
def _scatter_add(tgt, idx, src, axis=0):
    return tgt.clone().index_add_(axis, idx, src)
def _segment_sum(src, seg, n):
    out = torch.zeros((n,) + src.shape[1:], dtype=src.dtype)
    return out.index_add_(0, seg, src)
def _pad(x, pw):
    flat = tuple(v for pair in reversed(pw) for v in pair)
    return torch.nn.functional.pad(x, flat)

kernel_name = 'interleave_layers__linear_kernel_hedgehog__mixer_s_mlp__prompt'

def setup_inputs():

    _w = (lambda a: (lambda t: t.to(torch.bfloat16) if t.is_floating_point() else t)(torch.as_tensor(a)))
    def _A_setup():
        B, S, D, H = 1, 2048, 512, 32
        Dh = D // H
        return {
            "x": _w((lambda *s: torch.randn(*s, dtype=torch.bfloat16) * 0.05)(B, S, D)),
            "wqkv": _w((lambda *s: torch.randn(*s, dtype=torch.bfloat16) * 0.2)(D, 3 * D)),
            "w_phi": _w((lambda *s: torch.randn(*s, dtype=torch.bfloat16) * 0.2)(H, Dh, Dh) * (Dh ** -0.5)),
            "wo": _w((lambda *s: torch.randn(*s, dtype=torch.bfloat16) * 0.05)(D, D)),
        }
    _A_in = _A_setup()

    def _B_setup():
        B, S, D, F = 1, 2048, 512, 1376
        return {
            "x":  _w((lambda *s: torch.randn(*s, dtype=torch.bfloat16) * 0.05)(B, S, D)),
            "w1": _w((lambda *s: torch.randn(*s, dtype=torch.bfloat16) * 3.2)(D, D) * (D ** -0.5)),
            "w2": _w((lambda *s: torch.randn(*s, dtype=torch.bfloat16) * 3.2)(D, D) * (D ** -0.5)),
            "w3": _w((lambda *s: torch.randn(*s, dtype=torch.bfloat16) * 3.2)(D, F) * (D ** -0.5)),
            "w4": _w((lambda *s: torch.randn(*s, dtype=torch.bfloat16) * 3.2)(F, D) * (F ** -0.5)),
        }
    _B_in = _B_setup()

    return {
        "A_x": _A_in["x"],
        "A_wqkv": _A_in["wqkv"],
        "A_w_phi": _A_in["w_phi"],
        "A_wo": _A_in["wo"],
        "B_x": _B_in["x"],
        "B_w1": _B_in["w1"],
        "B_w2": _B_in["w2"],
        "B_w3": _B_in["w3"],
        "B_w4": _B_in["w4"],
    }

def reference(A_x, A_wqkv, A_w_phi, A_wo, B_x, B_w1, B_w2, B_w3, B_w4):
    def _A_ref(x, wqkv, w_phi, wo):
        B, S, D = x.shape
        H = 32; Dh = D // H
        qkv = (lambda x, *d: x.permute(*d))((x @ wqkv).reshape(B, S, 3, H, Dh), 2, 0, 3, 1, 4)
        q, k, v = qkv[0], qkv[1], qkv[2]
        pq = torch.einsum("bhsd,hdf->bhsf", q, w_phi)
        pk = torch.einsum("bhsd,hdf->bhsf", k, w_phi)
        phi_q = torch.concatenate([_softmax(pq, axis=-1), _softmax(-pq, axis=-1)], axis=-1)
        phi_k = torch.concatenate([_softmax(pk, axis=-1), _softmax(-pk, axis=-1)], axis=-1)
        kv = torch.einsum("bhsf,bhsd->bhfd", phi_k, v)
        z  = torch.einsum("bhsf->bhf", phi_k)
        num = torch.einsum("bhqf,bhfd->bhqd", phi_q, kv)
        den = torch.einsum("bhqf,bhf->bhq", phi_q, z)[..., None] + 1e-6
        o = num / den
        return (lambda x, *d: x.permute(*d))(o, 0, 2, 1, 3).reshape(B, S, D) @ wo

    def _B_ref(x, w1, w2, w3, w4):
        B, S, D = x.shape
        h = _gelu(_layernorm(x, axis=-1) @ w1)
        c = D // 4
        g0 = _pad(h[:, :, 0*c:1*c], ((0, 0), (1, 0), (0, 0)))[:, :S, :]
        g1 = _pad(h[:, :, 1*c:2*c], ((0, 0), (0, 1), (0, 0)))[:, 1:, :]
        g2 = _pad(h[:, :, 2*c:3*c], ((0, 0), (2, 0), (0, 0)))[:, :S, :]
        g3 = _pad(h[:, :, 3*c:   ], ((0, 0), (0, 2), (0, 0)))[:, 2:, :]
        hs = torch.concatenate([g0, g1, g2, g3], axis=-1) @ w2
        x1 = x + hs
        h2 = _gelu(_layernorm(x1, axis=-1) @ w3) @ w4
        return x1 + h2

    x = A_x
    x = x + _A_ref(_layernorm(x, axis=-1), A_wqkv, A_w_phi, A_wo)
    x = x + _B_ref(_layernorm(x, axis=-1), B_w1, B_w2, B_w3, B_w4)
    x = x + _A_ref(_layernorm(x, axis=-1), A_wqkv, A_w_phi, A_wo)
    x = x + _B_ref(_layernorm(x, axis=-1), B_w1, B_w2, B_w3, B_w4)
    return x
```

```asm
; @launch kernel=hh_all_kernel grid=(256,1,1) block=(512,1,1) lds=163840
.amdgcn_target "amdgcn-amd-amdhsa--gfx950"
.text
.globl hh_all_kernel
.p2align 8
.type hh_all_kernel,@function
hh_all_kernel:
  s_cmp_ge_u32 s2, 256
  s_cbranch_scc1 LX_end
  s_load_dwordx16 s[16:31], s[0:1], 0
  s_load_dwordx8 s[32:39], s[0:1], 64
  s_getreg_b32 s100, hwreg(HW_REG_XCC_ID)
  v_and_b32 v1, 63, v0
  v_lshrrev_b32 v4, 6, v0
  v_and_b32 v2, 15, v0
  v_readfirstlane_b32 s101, v4
  v_lshrrev_b32 v3, 4, v1
  s_and_b32 s100, s100, 7
  s_and_b32 s5, s101, 3
  s_cmp_ge_u32 s101, 4
  s_cbranch_scc1 LX_loader
  s_and_b32 s6, s2, 7
  s_lshr_b32 s7, s2, 3
  s_lshl_b32 s6, s6, 1
  s_and_b32 s8, s7, 1
  s_add_u32 s3, s6, s8
  s_lshr_b32 s4, s7, 1
  s_waitcnt lgkmcnt(0)
  s_mov_b32 s24, 0
  s_mov_b32 s25, 0
  s_mov_b32 s0, 60000
  s_mov_b32 s56, s38
  s_mov_b32 s57, s39
  s_mov_b32 s58, 67108864
  s_mov_b32 s59, 0x00020000
  s_mov_b32 s96, s36
  s_mov_b32 s97, s37
  s_mov_b32 s98, 256
  s_mov_b32 s99, 0x00020000
  v_mov_b32 v250, 1
  v_mov_b32 v251, 0
  s_lshl_b32 s49, s100, 5
  s_lshl_b32 s13, s2, 2
  s_add_u32 s13, s13, s5
  v_lshlrev_b32 v228, 4, v1
  s_mov_b32 s40, s16
  s_mov_b32 s41, s17
  s_mov_b32 s42, 2097152
  s_mov_b32 s43, 0x00020000
  s_lshl_b32 s6, s3, 17
  s_lshl_b32 s7, s4, 13
  s_add_u32 s6, s6, s7
  s_lshl_b32 s7, s5, 11
  s_add_u32 s6, s6, s7
  buffer_load_dwordx4 v[234:237], v228, s[40:43], s6 offen offset:0
  buffer_load_dwordx4 v[238:241], v228, s[40:43], s6 offen offset:1024
  s_mov_b32 s44, s18
  s_mov_b32 s45, s19
  s_mov_b32 s46, 1572864
  s_mov_b32 s47, 0x00020000
  v_lshrrev_b32 v24, 3, v1
  v_and_b32 v25, 7, v1
  v_lshlrev_b32 v26, 4, v25
  v_mul_u32_u24 v231, 3072, v24
  v_add_u32 v231, v231, v26
  s_lshr_b32 s6, s13, 4
  s_and_b32 s7, s13, 15
  s_mul_i32 s14, s6, 24576
  s_lshl_b32 s15, s7, 7
  s_add_u32 s14, s14, s15
  buffer_load_dwordx4 v[216:219], v231, s[44:47], s14 offen
  s_mul_i32 s9, s7, 74240
  s_and_b32 s15, s6, 3
  s_lshr_b32 s6, s6, 2
  s_lshl_b32 s6, s6, 11
  s_lshl_b32 s15, s15, 8
  s_add_u32 s6, s6, s15
  s_add_u32 s9, s9, s6
  s_cmp_ge_u32 s7, 8
  s_cbranch_scc1 LS1ac_nob2
  buffer_load_dwordx4 v[220:223], v231, s[44:47], s14 offen offset:2048
LS1ac_nob2:
  v_lshl_add_u32 v230, v24, 10, v26
  v_lshrrev_b32 v229, 2, v25
  v_mul_u32_u24 v229, 37120, v229
  v_lshl_add_u32 v229, v24, 6, v229
  v_and_b32 v27, 3, v1
  v_lshl_add_u32 v229, v27, 4, v229
  v_lshrrev_b32 v27, 1, v3
  v_mul_u32_u24 v229, 37120, v27
  v_and_b32 v27, 1, v3
  v_lshl_add_u32 v229, v27, 10, v229
  v_lshl_add_u32 v229, v2, 4, v229
  v_mov_b32 v252, -1
  v_mov_b32 v253, -1
  v_mov_b32 v254, -1
  v_mov_b32 v255, -1
  v_mov_b32 v244, 0
  v_mov_b32 v245, 0
  v_mov_b32 v246, 0
  v_mov_b32 v247, 0
  s_barrier
  v_mov_b32 v24, 161792
  ds_read_b32 v24, v24
  s_waitcnt lgkmcnt(0)
  v_readfirstlane_b32 s6, v24
  s_lshl_b32 s6, s6, 3
  s_add_u32 s100, s100, s6
  s_mov_b32 s2, s100
  s_cmp_ge_u32 s2, 256
  s_cbranch_scc1 LX_end
  s_and_b32 s6, s2, 7
  s_lshr_b32 s7, s2, 3
  s_lshl_b32 s6, s6, 1
  s_and_b32 s8, s7, 1
  s_add_u32 s3, s6, s8
  s_lshr_b32 s4, s7, 1
  s_cmp_lg_u32 s5, 1
  s_cbranch_scc1 LS1ac_tk2
  s_lshl_b32 s6, s4, 4
  s_add_u32 s6, s6, s3
  s_mul_i32 s6, s6, 2304
  s_add_u32 s6, s6, 30408704
  s_add_u32 s7, s6, 589824
  buffer_store_dwordx4 v[252:255], v228, s[56:59], s6 offen offset:0 sc1
  buffer_store_dwordx4 v[252:255], v228, s[56:59], s6 offen offset:1024 sc1
  buffer_store_dwordx4 v[252:255], v228, s[56:59], s7 offen offset:0 sc1
  buffer_store_dwordx4 v[252:255], v228, s[56:59], s7 offen offset:1024 sc1
  s_mov_b64 exec, 0xffff
  buffer_store_dwordx4 v[252:255], v228, s[56:59], s6 offen offset:2048 sc1
  buffer_store_dwordx4 v[252:255], v228, s[56:59], s7 offen offset:2048 sc1
  s_lshl_b32 s6, s2, 7
  s_add_u32 s6, s6, 21626880
  s_mov_b64 exec, 0xff
  buffer_store_dwordx4 v[244:247], v228, s[56:59], s6 offen sc1
  s_mov_b64 exec, -1
LS1ac_tk2:
  v_mov_b32 v8, 0x3f803f80
  v_mov_b32 v9, 0x3f803f80
  v_mov_b32 v10, 0x3f803f80
  v_mov_b32 v11, 0x3f803f80
  v_lshlrev_b32 v4, 2, v3
  v_add_u32 v5, 0, v4
  v_cmp_eq_u32 s[64:65], v5, v2
  v_add_u32 v5, 1, v4
  v_cmp_eq_u32 s[66:67], v5, v2
  v_add_u32 v5, 2, v4
  v_cmp_eq_u32 s[68:69], v5, v2
  v_add_u32 v5, 3, v4
  v_cmp_eq_u32 s[70:71], v5, v2
  v_lshrrev_b32 v24, 1, v2
  v_xor_b32 v24, v3, v24
  v_lshlrev_b32 v24, 4, v24
  v_lshl_add_u32 v24, v2, 7, v24
  s_mul_i32 s6, s5, 4096
  v_xor_b32 v4, 0, v24
  v_add_u32 v4, s6, v4
  v_xor_b32 v5, 64, v24
  v_add_u32 v5, s6, v5
  v_lshrrev_b32 v24, 2, v2
  v_and_b32 v25, 3, v2
  v_lshl_add_u32 v26, v3, 3, v24
  v_and_b32 v27, 1, v3
  v_lshlrev_b32 v27, 1, v27
  v_lshlrev_b32 v26, 6, v26
  v_and_b32 v28, 1, v25
  v_lshl_add_u32 v26, v28, 3, v26
  v_lshrrev_b32 v25, 1, v25
  v_or_b32 v28, 0, v25
  v_xor_b32 v28, v28, v27
  v_lshl_add_u32 v160, v28, 4, v26
  v_or_b32 v28, 2, v25
  v_xor_b32 v28, v28, v27
  v_lshl_add_u32 v161, v28, 4, v26
  v_add_u32 v162, 4096, v160
  v_add_u32 v163, 4096, v161
  v_add_u32 v164, 8192, v160
  v_add_u32 v165, 8192, v161
  v_add_u32 v166, 65536, v4
  v_add_u32 v167, 65536, v5
  v_add_u32 v168, 131072, v4
  v_add_u32 v169, 131072, v5
  v_add_u32 v170, 65536, v160
  v_add_u32 v171, 65536, v161
  v_add_u32 v172, 65536, v162
  v_add_u32 v173, 65536, v163
  v_add_u32 v174, 65536, v164
  v_add_u32 v175, 65536, v165
  v_add_u32 v176, 131072, v160
  v_add_u32 v177, 131072, v161
  v_add_u32 v178, 131072, v162
  v_add_u32 v179, 131072, v163
  v_add_u32 v180, 131072, v164
  v_add_u32 v181, 131072, v165
  s_barrier
  ds_read_b128 v[96:99], v4 offset:0
  ds_read_b128 v[100:103], v4 offset:2048
  ds_read_b64_tr_b16 v[112:113], v160 offset:16384
  ds_read_b64_tr_b16 v[114:115], v160 offset:16640
  ds_read_b64_tr_b16 v[116:117], v161 offset:16384
  ds_read_b64_tr_b16 v[118:119], v161 offset:16640
  ds_read_b64_tr_b16 v[120:121], v162 offset:16384
  ds_read_b64_tr_b16 v[122:123], v162 offset:16640
  ds_read_b64_tr_b16 v[124:125], v163 offset:16384
  ds_read_b64_tr_b16 v[126:127], v163 offset:16640
  ds_read_b64_tr_b16 v[128:129], v164 offset:16384
  ds_read_b64_tr_b16 v[130:131], v164 offset:16640
  ds_read_b64_tr_b16 v[132:133], v165 offset:16384
  ds_read_b64_tr_b16 v[134:135], v165 offset:16640
  s_waitcnt lgkmcnt(10)
  v_mfma_f32_16x16x32_bf16 v[32:35], v[112:115], v[96:99], 0
  ds_read_b128 v[104:107], v5 offset:0
  v_mfma_f32_16x16x32_bf16 v[56:59], v[112:115], v[100:103], 0
  ds_read_b128 v[108:111], v5 offset:2048
  s_waitcnt lgkmcnt(10)
  v_mfma_f32_16x16x32_bf16 v[36:39], v[116:119], v[96:99], 0
  ds_read_b64_tr_b16 v[136:137], v160 offset:18432
  v_mfma_f32_16x16x32_bf16 v[60:63], v[116:119], v[100:103], 0
  ds_read_b64_tr_b16 v[138:139], v160 offset:18688
  s_waitcnt lgkmcnt(10)
  v_mfma_f32_16x16x32_bf16 v[40:43], v[120:123], v[96:99], 0
  ds_read_b64_tr_b16 v[140:141], v161 offset:18432
  v_mfma_f32_16x16x32_bf16 v[64:67], v[120:123], v[100:103], 0
  ds_read_b64_tr_b16 v[142:143], v161 offset:18688
  s_waitcnt lgkmcnt(10)
  v_mfma_f32_16x16x32_bf16 v[44:47], v[124:127], v[96:99], 0
  ds_read_b64_tr_b16 v[144:145], v162 offset:18432
  v_mfma_f32_16x16x32_bf16 v[68:71], v[124:127], v[100:103], 0
  ds_read_b64_tr_b16 v[146:147], v162 offset:18688
  s_waitcnt lgkmcnt(10)
  v_mfma_f32_16x16x32_bf16 v[48:51], v[96:99], v[128:131], 0
  ds_read_b64_tr_b16 v[148:149], v163 offset:18432
  v_mfma_f32_16x16x32_bf16 v[72:75], v[100:103], v[128:131], 0
  ds_read_b64_tr_b16 v[150:151], v163 offset:18688
  s_waitcnt lgkmcnt(10)
  v_mfma_f32_16x16x32_bf16 v[52:55], v[96:99], v[132:135], 0
  ds_read_b64_tr_b16 v[152:153], v164 offset:18432
  v_mfma_f32_16x16x32_bf16 v[76:79], v[100:103], v[132:135], 0
  ds_read_b64_tr_b16 v[154:155], v164 offset:18688
  v_mfma_f32_16x16x32_bf16 v[80:83], v[8:11], v[96:99], 0
  ds_read_b64_tr_b16 v[156:157], v165 offset:18432
  v_mfma_f32_16x16x32_bf16 v[84:87], v[96:99], v[96:99], 0
  ds_read_b64_tr_b16 v[158:159], v165 offset:18688
  v_mfma_f32_16x16x32_bf16 v[88:91], v[8:11], v[100:103], 0
  v_mfma_f32_16x16x32_bf16 v[92:95], v[100:103], v[100:103], 0
  s_barrier
  s_waitcnt lgkmcnt(10)
  v_mfma_f32_16x16x32_bf16 v[32:35], v[136:139], v[104:107], v[32:35]
  ds_read_b128 v[96:99], v4 offset:28672
  v_mfma_f32_16x16x32_bf16 v[56:59], v[136:139], v[108:111], v[56:59]
  ds_read_b128 v[100:103], v4 offset:30720
  s_waitcnt lgkmcnt(10)
  v_mfma_f32_16x16x32_bf16 v[36:39], v[140:143], v[104:107], v[36:39]
  ds_read_b64_tr_b16 v[112:113], v160 offset:45056
  v_mfma_f32_16x16x32_bf16 v[60:63], v[140:143], v[108:111], v[60:63]
  ds_read_b64_tr_b16 v[114:115], v160 offset:45312
  s_waitcnt lgkmcnt(10)
  v_mfma_f32_16x16x32_bf16 v[40:43], v[144:147], v[104:107], v[40:43]
  ds_read_b64_tr_b16 v[116:117], v161 offset:45056
  v_mfma_f32_16x16x32_bf16 v[64:67], v[144:147], v[108:111], v[64:67]
  ds_read_b64_tr_b16 v[118:119], v161 offset:45312
  s_waitcnt lgkmcnt(10)
  v_mfma_f32_16x16x32_bf16 v[44:47], v[148:151], v[104:107], v[44:47]
  ds_read_b64_tr_b16 v[120:121], v162 offset:45056
  v_mfma_f32_16x16x32_bf16 v[68:71], v[148:151], v[108:111], v[68:71]
  ds_read_b64_tr_b16 v[122:123], v162 offset:45312
  s_waitcnt lgkmcnt(10)
  v_mfma_f32_16x16x32_bf16 v[48:51], v[104:107], v[152:155], v[48:51]
  ds_read_b64_tr_b16 v[124:125], v163 offset:45056
  v_mfma_f32_16x16x32_bf16 v[72:75], v[108:111], v[152:155], v[72:75]
  ds_read_b64_tr_b16 v[126:127], v163 offset:45312
  s_waitcnt lgkmcnt(10)
  v_mfma_f32_16x16x32_bf16 v[52:55], v[104:107], v[156:159], v[52:55]
  ds_read_b64_tr_b16 v[128:129], v164 offset:45056
  v_mfma_f32_16x16x32_bf16 v[76:79], v[108:111], v[156:159], v[76:79]
  ds_read_b64_tr_b16 v[130:131], v164 offset:45312
  v_mfma_f32_16x16x32_bf16 v[80:83], v[8:11], v[104:107], v[80:83]
  ds_read_b64_tr_b16 v[132:133], v165 offset:45056
  v_mfma_f32_16x16x32_bf16 v[84:87], v[104:107], v[104:107], v[84:87]
  ds_read_b64_tr_b16 v[134:135], v165 offset:45312
  v_mfma_f32_16x16x32_bf16 v[88:91], v[8:11], v[108:111], v[88:91]
  v_mfma_f32_16x16x32_bf16 v[92:95], v[108:111], v[108:111], v[92:95]
  s_waitcnt lgkmcnt(10)
  v_mfma_f32_16x16x32_bf16 v[32:35], v[112:115], v[96:99], v[32:35]
  ds_read_b128 v[104:107], v5 offset:28672
  v_mfma_f32_16x16x32_bf16 v[56:59], v[112:115], v[100:103], v[56:59]
  ds_read_b128 v[108:111], v5 offset:30720
  s_waitcnt lgkmcnt(10)
  v_mfma_f32_16x16x32_bf16 v[36:39], v[116:119], v[96:99], v[36:39]
  ds_read_b64_tr_b16 v[136:137], v160 offset:47104
  v_mfma_f32_16x16x32_bf16 v[60:63], v[116:119], v[100:103], v[60:63]
  ds_read_b64_tr_b16 v[138:139], v160 offset:47360
  s_waitcnt lgkmcnt(10)
  v_mfma_f32_16x16x32_bf16 v[40:43], v[120:123], v[96:99], v[40:43]
  ds_read_b64_tr_b16 v[140:141], v161 offset:47104
  v_mfma_f32_16x16x32_bf16 v[64:67], v[120:123], v[100:103], v[64:67]
  ds_read_b64_tr_b16 v[142:143], v161 offset:47360
  s_waitcnt lgkmcnt(10)
  v_mfma_f32_16x16x32_bf16 v[44:47], v[124:127], v[96:99], v[44:47]
  ds_read_b64_tr_b16 v[144:145], v162 offset:47104
  v_mfma_f32_16x16x32_bf16 v[68:71], v[124:127], v[100:103], v[68:71]
  ds_read_b64_tr_b16 v[146:147], v162 offset:47360
  s_waitcnt lgkmcnt(10)
  v_mfma_f32_16x16x32_bf16 v[48:51], v[96:99], v[128:131], v[48:51]
  ds_read_b64_tr_b16 v[148:149], v163 offset:47104
  v_mfma_f32_16x16x32_bf16 v[72:75], v[100:103], v[128:131], v[72:75]
  ds_read_b64_tr_b16 v[150:151], v163 offset:47360
  s_waitcnt lgkmcnt(10)
  v_mfma_f32_16x16x32_bf16 v[52:55], v[96:99], v[132:135], v[52:55]
  ds_read_b64_tr_b16 v[152:153], v164 offset:47104
  v_mfma_f32_16x16x32_bf16 v[76:79], v[100:103], v[132:135], v[76:79]
  ds_read_b64_tr_b16 v[154:155], v164 offset:47360
  v_mfma_f32_16x16x32_bf16 v[80:83], v[8:11], v[96:99], v[80:83]
  ds_read_b64_tr_b16 v[156:157], v165 offset:47104
  v_mfma_f32_16x16x32_bf16 v[84:87], v[96:99], v[96:99], v[84:87]
  ds_read_b64_tr_b16 v[158:159], v165 offset:47360
  v_mfma_f32_16x16x32_bf16 v[88:91], v[8:11], v[100:103], v[88:91]
  v_mfma_f32_16x16x32_bf16 v[92:95], v[100:103], v[100:103], v[92:95]
  s_barrier
  s_cmp_lg_u32 s5, 1
  s_cbranch_scc1 LS1ac_tk3
  s_mov_b64 exec, 1
  s_waitcnt vmcnt(0)
  buffer_atomic_add v250, v251, s[96:99], s49 offen offset:4
  s_mov_b64 exec, -1
LS1ac_tk3:
  s_waitcnt lgkmcnt(10)
  v_mfma_f32_16x16x32_bf16 v[32:35], v[136:139], v[104:107], v[32:35]
  ds_read_b128 v[96:99], v4 offset:57344
  v_mfma_f32_16x16x32_bf16 v[56:59], v[136:139], v[108:111], v[56:59]
  ds_read_b128 v[100:103], v4 offset:59392
  s_waitcnt lgkmcnt(10)
  v_mfma_f32_16x16x32_bf16 v[36:39], v[140:143], v[104:107], v[36:39]
  ds_read_b64_tr_b16 v[112:113], v170 offset:8192
  v_mfma_f32_16x16x32_bf16 v[60:63], v[140:143], v[108:111], v[60:63]
  ds_read_b64_tr_b16 v[114:115], v170 offset:8448
  s_waitcnt lgkmcnt(10)
  v_mfma_f32_16x16x32_bf16 v[40:43], v[144:147], v[104:107], v[40:43]
  ds_read_b64_tr_b16 v[116:117], v171 offset:8192
  v_mfma_f32_16x16x32_bf16 v[64:67], v[144:147], v[108:111], v[64:67]
  ds_read_b64_tr_b16 v[118:119], v171 offset:8448
  s_waitcnt lgkmcnt(10)
  v_mfma_f32_16x16x32_bf16 v[44:47], v[148:151], v[104:107], v[44:47]
  ds_read_b64_tr_b16 v[120:121], v172 offset:8192
  v_mfma_f32_16x16x32_bf16 v[68:71], v[148:151], v[108:111], v[68:71]
  ds_read_b64_tr_b16 v[122:123], v172 offset:8448
  s_waitcnt lgkmcnt(10)
  v_mfma_f32_16x16x32_bf16 v[48:51], v[104:107], v[152:155], v[48:51]
  ds_read_b64_tr_b16 v[124:125], v173 offset:8192
  v_mfma_f32_16x16x32_bf16 v[72:75], v[108:111], v[152:155], v[72:75]
  ds_read_b64_tr_b16 v[126:127], v173 offset:8448
  s_waitcnt lgkmcnt(10)
  v_mfma_f32_16x16x32_bf16 v[52:55], v[104:107], v[156:159], v[52:55]
  ds_read_b64_tr_b16 v[128:129], v174 offset:8192
  v_mfma_f32_16x16x32_bf16 v[76:79], v[108:111], v[156:159], v[76:79]
  ds_read_b64_tr_b16 v[130:131], v174 offset:8448
  v_mfma_f32_16x16x32_bf16 v[80:83], v[8:11], v[104:107], v[80:83]
  ds_read_b64_tr_b16 v[132:133], v175 offset:8192
  v_mfma_f32_16x16x32_bf16 v[84:87], v[104:107], v[104:107], v[84:87]
  ds_read_b64_tr_b16 v[134:135], v175 offset:8448
  v_mfma_f32_16x16x32_bf16 v[88:91], v[8:11], v[108:111], v[88:91]
  v_mfma_f32_16x16x32_bf16 v[92:95], v[108:111], v[108:111], v[92:95]
  s_waitcnt lgkmcnt(10)
  v_mfma_f32_16x16x32_bf16 v[32:35], v[112:115], v[96:99], v[32:35]
  ds_read_b128 v[104:107], v5 offset:57344
  v_mfma_f32_16x16x32_bf16 v[56:59], v[112:115], v[100:103], v[56:59]
  ds_read_b128 v[108:111], v5 offset:59392
  s_waitcnt lgkmcnt(10)
  v_mfma_f32_16x16x32_bf16 v[36:39], v[116:119], v[96:99], v[36:39]
  ds_read_b64_tr_b16 v[136:137], v170 offset:10240
  v_mfma_f32_16x16x32_bf16 v[60:63], v[116:119], v[100:103], v[60:63]
  ds_read_b64_tr_b16 v[138:139], v170 offset:10496
  s_waitcnt lgkmcnt(10)
  v_mfma_f32_16x16x32_bf16 v[40:43], v[120:123], v[96:99], v[40:43]
  ds_read_b64_tr_b16 v[140:141], v171 offset:10240
  v_mfma_f32_16x16x32_bf16 v[64:67], v[120:123], v[100:103], v[64:67]
  ds_read_b64_tr_b16 v[142:143], v171 offset:10496
  s_waitcnt lgkmcnt(10)
  v_mfma_f32_16x16x32_bf16 v[44:47], v[124:127], v[96:99], v[44:47]
  ds_read_b64_tr_b16 v[144:145], v172 offset:10240
  v_mfma_f32_16x16x32_bf16 v[68:71], v[124:127], v[100:103], v[68:71]
  ds_read_b64_tr_b16 v[146:147], v172 offset:10496
  s_waitcnt lgkmcnt(10)
  v_mfma_f32_16x16x32_bf16 v[48:51], v[96:99], v[128:131], v[48:51]
  ds_read_b64_tr_b16 v[148:149], v173 offset:10240
  v_mfma_f32_16x16x32_bf16 v[72:75], v[100:103], v[128:131], v[72:75]
  ds_read_b64_tr_b16 v[150:151], v173 offset:10496
  s_waitcnt lgkmcnt(10)
  v_mfma_f32_16x16x32_bf16 v[52:55], v[96:99], v[132:135], v[52:55]
  ds_read_b64_tr_b16 v[152:153], v174 offset:10240
  v_mfma_f32_16x16x32_bf16 v[76:79], v[100:103], v[132:135], v[76:79]
  ds_read_b64_tr_b16 v[154:155], v174 offset:10496
  v_mfma_f32_16x16x32_bf16 v[80:83], v[8:11], v[96:99], v[80:83]
  ds_read_b64_tr_b16 v[156:157], v175 offset:10240
  v_mfma_f32_16x16x32_bf16 v[84:87], v[96:99], v[96:99], v[84:87]
  ds_read_b64_tr_b16 v[158:159], v175 offset:10496
  v_mfma_f32_16x16x32_bf16 v[88:91], v[8:11], v[100:103], v[88:91]
  v_mfma_f32_16x16x32_bf16 v[92:95], v[100:103], v[100:103], v[92:95]
  s_barrier
  s_waitcnt lgkmcnt(10)
  v_mfma_f32_16x16x32_bf16 v[32:35], v[136:139], v[104:107], v[32:35]
  ds_read_b128 v[96:99], v166 offset:20480
  v_mfma_f32_16x16x32_bf16 v[56:59], v[136:139], v[108:111], v[56:59]
  ds_read_b128 v[100:103], v166 offset:22528
  s_waitcnt lgkmcnt(10)
  v_mfma_f32_16x16x32_bf16 v[36:39], v[140:143], v[104:107], v[36:39]
  ds_read_b64_tr_b16 v[112:113], v170 offset:36864
  v_mfma_f32_16x16x32_bf16 v[60:63], v[140:143], v[108:111], v[60:63]
  ds_read_b64_tr_b16 v[114:115], v170 offset:37120
  s_waitcnt lgkmcnt(10)
  v_mfma_f32_16x16x32_bf16 v[40:43], v[144:147], v[104:107], v[40:43]
  ds_read_b64_tr_b16 v[116:117], v171 offset:36864
  v_mfma_f32_16x16x32_bf16 v[64:67], v[144:147], v[108:111], v[64:67]
  ds_read_b64_tr_b16 v[118:119], v171 offset:37120
  s_waitcnt lgkmcnt(10)
  v_mfma_f32_16x16x32_bf16 v[44:47], v[148:151], v[104:107], v[44:47]
  ds_read_b64_tr_b16 v[120:121], v172 offset:36864
  v_mfma_f32_16x16x32_bf16 v[68:71], v[148:151], v[108:111], v[68:71]
  ds_read_b64_tr_b16 v[122:123], v172 offset:37120
  s_waitcnt lgkmcnt(10)
  v_mfma_f32_16x16x32_bf16 v[48:51], v[104:107], v[152:155], v[48:51]
  ds_read_b64_tr_b16 v[124:125], v173 offset:36864
  v_mfma_f32_16x16x32_bf16 v[72:75], v[108:111], v[152:155], v[72:75]
  ds_read_b64_tr_b16 v[126:127], v173 offset:37120
  s_waitcnt lgkmcnt(10)
  v_mfma_f32_16x16x32_bf16 v[52:55], v[104:107], v[156:159], v[52:55]
  ds_read_b64_tr_b16 v[128:129], v174 offset:36864
  v_mfma_f32_16x16x32_bf16 v[76:79], v[108:111], v[156:159], v[76:79]
  ds_read_b64_tr_b16 v[130:131], v174 offset:37120
  v_mfma_f32_16x16x32_bf16 v[80:83], v[8:11], v[104:107], v[80:83]
  ds_read_b64_tr_b16 v[132:133], v175 offset:36864
  v_mfma_f32_16x16x32_bf16 v[84:87], v[104:107], v[104:107], v[84:87]
  ds_read_b64_tr_b16 v[134:135], v175 offset:37120
  v_mfma_f32_16x16x32_bf16 v[88:91], v[8:11], v[108:111], v[88:91]
  v_mfma_f32_16x16x32_bf16 v[92:95], v[108:111], v[108:111], v[92:95]
  s_waitcnt lgkmcnt(10)
  v_mfma_f32_16x16x32_bf16 v[32:35], v[112:115], v[96:99], v[32:35]
  ds_read_b128 v[104:107], v167 offset:20480
  v_mfma_f32_16x16x32_bf16 v[56:59], v[112:115], v[100:103], v[56:59]
  ds_read_b128 v[108:111], v167 offset:22528
  s_waitcnt lgkmcnt(10)
  v_mfma_f32_16x16x32_bf16 v[36:39], v[116:119], v[96:99], v[36:39]
  ds_read_b64_tr_b16 v[136:137], v170 offset:38912
  v_mfma_f32_16x16x32_bf16 v[60:63], v[116:119], v[100:103], v[60:63]
  ds_read_b64_tr_b16 v[138:139], v170 offset:39168
  s_waitcnt lgkmcnt(10)
  v_mfma_f32_16x16x32_bf16 v[40:43], v[120:123], v[96:99], v[40:43]
  ds_read_b64_tr_b16 v[140:141], v171 offset:38912
  v_mfma_f32_16x16x32_bf16 v[64:67], v[120:123], v[100:103], v[64:67]
  ds_read_b64_tr_b16 v[142:143], v171 offset:39168
  s_waitcnt lgkmcnt(10)
  v_mfma_f32_16x16x32_bf16 v[44:47], v[124:127], v[96:99], v[44:47]
  ds_read_b64_tr_b16 v[144:145], v172 offset:38912
  v_mfma_f32_16x16x32_bf16 v[68:71], v[124:127], v[100:103], v[68:71]
  ds_read_b64_tr_b16 v[146:147], v172 offset:39168
  s_waitcnt lgkmcnt(10)
  v_mfma_f32_16x16x32_bf16 v[48:51], v[96:99], v[128:131], v[48:51]
  ds_read_b64_tr_b16 v[148:149], v173 offset:38912
  v_mfma_f32_16x16x32_bf16 v[72:75], v[100:103], v[128:131], v[72:75]
  ds_read_b64_tr_b16 v[150:151], v173 offset:39168
  s_waitcnt lgkmcnt(10)
  v_mfma_f32_16x16x32_bf16 v[52:55], v[96:99], v[132:135], v[52:55]
  ds_read_b64_tr_b16 v[152:153], v174 offset:38912
  v_mfma_f32_16x16x32_bf16 v[76:79], v[100:103], v[132:135], v[76:79]
  ds_read_b64_tr_b16 v[154:155], v174 offset:39168
  v_mfma_f32_16x16x32_bf16 v[80:83], v[8:11], v[96:99], v[80:83]
  ds_read_b64_tr_b16 v[156:157], v175 offset:38912
  v_mfma_f32_16x16x32_bf16 v[84:87], v[96:99], v[96:99], v[84:87]
  ds_read_b64_tr_b16 v[158:159], v175 offset:39168
  v_mfma_f32_16x16x32_bf16 v[88:91], v[8:11], v[100:103], v[88:91]
  v_mfma_f32_16x16x32_bf16 v[92:95], v[100:103], v[100:103], v[92:95]
  s_barrier
  s_mov_b32 s40, s32
  s_mov_b32 s41, s33
  s_mov_b32 s42, 1409024
  s_mov_b32 s43, 0x00020000
  s_lshr_b32 s6, s13, 3
  s_and_b32 s7, s13, 7
  s_lshl_b32 s14, s6, 13
  s_lshl_b32 s15, s7, 7
  s_add_u32 s14, s14, s15
  buffer_load_dwordx4 v[212:215], v230, s[40:43], s14 offen
  s_mul_i32 s8, s7, 200960
  s_and_b32 s15, s6, 3
  s_lshr_b32 s6, s6, 2
  s_lshl_b32 s6, s6, 12
  s_lshl_b32 s15, s15, 8
  s_add_u32 s6, s6, s15
  s_add_u32 s8, s8, s6
  s_add_u32 s8, s8, 4194304
  s_mov_b32 s60, s22
  s_mov_b32 s61, s23
  s_mov_b32 s62, 524288
  s_mov_b32 s63, 0x00020000
  s_lshl_b32 s6, s13, 9
  v_lshlrev_b32 v27, 3, v1
  buffer_load_dwordx2 v[232:233], v27, s[60:63], s6 offen
  s_cmp_ge_u32 s13, 864
  s_cbranch_scc1 LS1ac_noa2
  s_add_u32 s12, s13, 1024
  s_mov_b32 s10, 200960
  s_mov_b32 s11, 4194304
  s_cmp_lt_u32 s13, 352
  s_cbranch_scc1 LS1ac_a2w4
  s_mov_b32 s40, s28
  s_mov_b32 s41, s29
  s_mov_b32 s42, 524288
  s_mov_b32 s43, 0x00020000
  s_sub_u32 s12, s13, 352
  s_mov_b32 s10, 69888
  s_mov_b32 s11, 2097152
LS1ac_a2w4:
  s_lshr_b32 s6, s12, 3
  s_and_b32 s7, s12, 7
  s_lshl_b32 s14, s6, 13
  s_lshl_b32 s15, s7, 7
  s_add_u32 s14, s14, s15
  buffer_load_dwordx4 v[224:227], v230, s[40:43], s14 offen
  s_mul_i32 s10, s7, s10
  s_and_b32 s15, s6, 3
  s_lshr_b32 s6, s6, 2
  s_lshl_b32 s6, s6, 12
  s_lshl_b32 s15, s15, 8
  s_add_u32 s6, s6, s15
  s_add_u32 s10, s10, s6
  s_add_u32 s10, s10, s11
LS1ac_noa2:
  s_cmp_lg_u32 s5, 3
  s_cbranch_scc1 LS1ac_noc
  s_xor_b32 s12, s2, 128
  s_cmp_ge_u32 s12, 118
  s_cbranch_scc1 LS1ac_noc
  s_mov_b32 s44, s26
  s_mov_b32 s45, s27
  s_mov_b32 s46, 524288
  s_mov_b32 s47, 0x00020000
  s_lshr_b32 s6, s12, 1
  s_mov_b32 s14, 1024
  s_cmp_lt_u32 s6, 16
  s_cbranch_scc1 LS1ac_cw1
  s_mov_b32 s44, s30
  s_mov_b32 s45, s31
  s_mov_b32 s46, 1409024
  s_mov_b32 s47, 0x00020000
  s_sub_u32 s6, s6, 16
  s_mov_b32 s14, 2752
LS1ac_cw1:
  s_and_b32 s7, s12, 1
  s_lshl_b32 s15, s14, 8
  s_mul_i32 s15, s15, s7
  s_lshl_b32 s6, s6, 6
  s_add_u32 s15, s15, s6
  v_lshrrev_b32 v24, 2, v1
  v_and_b32 v26, 3, v1
  v_lshrrev_b32 v25, 5, v1
  v_lshlrev_b32 v25, 1, v25
  v_xor_b32 v26, v26, v25
  v_lshlrev_b32 v26, 4, v26
  v_mul_lo_u32 v24, v24, s14
  v_add_u32 v26, v26, v24
  s_lshl_b32 s14, s14, 4
  s_mov_b32 m0, 145408
  s_nop 0
  buffer_load_dwordx4 v26, s[44:47], s15 offen lds
  s_add_u32 s15, s15, s14
  s_mov_b32 m0, 146432
  s_nop 0
  buffer_load_dwordx4 v26, s[44:47], s15 offen lds
  s_add_u32 s15, s15, s14
  s_mov_b32 m0, 147456
  s_nop 0
  buffer_load_dwordx4 v26, s[44:47], s15 offen lds
  s_add_u32 s15, s15, s14
  s_mov_b32 m0, 148480
  s_nop 0
  buffer_load_dwordx4 v26, s[44:47], s15 offen lds
  s_add_u32 s15, s15, s14
  s_mov_b32 m0, 149504
  s_nop 0
  buffer_load_dwordx4 v26, s[44:47], s15 offen lds
  s_add_u32 s15, s15, s14
  s_mov_b32 m0, 150528
  s_nop 0
  buffer_load_dwordx4 v26, s[44:47], s15 offen lds
  s_add_u32 s15, s15, s14
  s_mov_b32 m0, 151552
  s_nop 0
  buffer_load_dwordx4 v26, s[44:47], s15 offen lds
  s_add_u32 s15, s15, s14
  s_mov_b32 m0, 152576
  s_nop 0
  buffer_load_dwordx4 v26, s[44:47], s15 offen lds
  s_add_u32 s15, s15, s14
  s_mov_b32 m0, 153600
  s_nop 0
  buffer_load_dwordx4 v26, s[44:47], s15 offen lds
  s_add_u32 s15, s15, s14
  s_mov_b32 m0, 154624
  s_nop 0
  buffer_load_dwordx4 v26, s[44:47], s15 offen lds
  s_add_u32 s15, s15, s14
  s_mov_b32 m0, 155648
  s_nop 0
  buffer_load_dwordx4 v26, s[44:47], s15 offen lds
  s_add_u32 s15, s15, s14
  s_mov_b32 m0, 156672
  s_nop 0
  buffer_load_dwordx4 v26, s[44:47], s15 offen lds
  s_add_u32 s15, s15, s14
  s_mov_b32 m0, 157696
  s_nop 0
  buffer_load_dwordx4 v26, s[44:47], s15 offen lds
  s_add_u32 s15, s15, s14
  s_mov_b32 m0, 158720
  s_nop 0
  buffer_load_dwordx4 v26, s[44:47], s15 offen lds
  s_add_u32 s15, s15, s14
  s_mov_b32 m0, 159744
  s_nop 0
  buffer_load_dwordx4 v26, s[44:47], s15 offen lds
  s_add_u32 s15, s15, s14
  s_mov_b32 m0, 160768
  s_nop 0
  buffer_load_dwordx4 v26, s[44:47], s15 offen lds
LS1ac_noc:
  s_cmp_ge_u32 s13, 0
  s_cbranch_scc1 LS1ac_nod
  s_add_u32 s60, s38, 21102592
  s_addc_u32 s61, s39, 0
  s_mov_b32 s62, 131072
  s_mov_b32 s63, 0x00020000
  v_mov_b32 v24, 0
  v_mov_b32 v25, 0
  v_mov_b32 v26, 0
  v_mov_b32 v27, 0
  s_lshl_b32 s6, s13, 10
  buffer_store_dwordx4 v[24:27], v228, s[60:63], s6 offen sc1
  s_nop 1
LS1ac_nod:
  s_add_u32 s60, s38, 22020096
  s_addc_u32 s61, s39, 0
  s_mov_b32 s62, 5801984
  s_mov_b32 s63, 0x00020000
  s_waitcnt lgkmcnt(10)
  v_mfma_f32_16x16x32_bf16 v[32:35], v[136:139], v[104:107], v[32:35]
  ds_read_b128 v[96:99], v166 offset:49152
  v_mfma_f32_16x16x32_bf16 v[56:59], v[136:139], v[108:111], v[56:59]
  ds_read_b128 v[100:103], v166 offset:51200
  s_waitcnt lgkmcnt(10)
  v_mfma_f32_16x16x32_bf16 v[36:39], v[140:143], v[104:107], v[36:39]
  ds_read_b64_tr_b16 v[112:113], v176 offset:0
  v_mfma_f32_16x16x32_bf16 v[60:63], v[140:143], v[108:111], v[60:63]
  ds_read_b64_tr_b16 v[114:115], v176 offset:256
  s_waitcnt lgkmcnt(10)
  v_mfma_f32_16x16x32_bf16 v[40:43], v[144:147], v[104:107], v[40:43]
  ds_read_b64_tr_b16 v[116:117], v177 offset:0
  v_mfma_f32_16x16x32_bf16 v[64:67], v[144:147], v[108:111], v[64:67]
  ds_read_b64_tr_b16 v[118:119], v177 offset:256
  s_waitcnt lgkmcnt(10)
  v_mfma_f32_16x16x32_bf16 v[44:47], v[148:151], v[104:107], v[44:47]
  ds_read_b64_tr_b16 v[120:121], v178 offset:0
  v_mfma_f32_16x16x32_bf16 v[68:71], v[148:151], v[108:111], v[68:71]
  ds_read_b64_tr_b16 v[122:123], v178 offset:256
  s_waitcnt lgkmcnt(10)
  v_mfma_f32_16x16x32_bf16 v[48:51], v[104:107], v[152:155], v[48:51]
  ds_read_b64_tr_b16 v[124:125], v179 offset:0
  v_mfma_f32_16x16x32_bf16 v[72:75], v[108:111], v[152:155], v[72:75]
  ds_read_b64_tr_b16 v[126:127], v179 offset:256
  s_waitcnt lgkmcnt(10)
  v_mfma_f32_16x16x32_bf16 v[52:55], v[104:107], v[156:159], v[52:55]
  ds_read_b64_tr_b16 v[128:129], v180 offset:0
  v_mfma_f32_16x16x32_bf16 v[76:79], v[108:111], v[156:159], v[76:79]
  ds_read_b64_tr_b16 v[130:131], v180 offset:256
  v_mfma_f32_16x16x32_bf16 v[80:83], v[8:11], v[104:107], v[80:83]
  ds_read_b64_tr_b16 v[132:133], v181 offset:0
  v_mfma_f32_16x16x32_bf16 v[84:87], v[104:107], v[104:107], v[84:87]
  ds_read_b64_tr_b16 v[134:135], v181 offset:256
  v_mfma_f32_16x16x32_bf16 v[88:91], v[8:11], v[108:111], v[88:91]
  v_mfma_f32_16x16x32_bf16 v[92:95], v[108:111], v[108:111], v[92:95]
  s_waitcnt lgkmcnt(10)
  v_mfma_f32_16x16x32_bf16 v[32:35], v[112:115], v[96:99], v[32:35]
  ds_read_b128 v[104:107], v167 offset:49152
  v_mfma_f32_16x16x32_bf16 v[56:59], v[112:115], v[100:103], v[56:59]
  ds_read_b128 v[108:111], v167 offset:51200
  s_waitcnt lgkmcnt(10)
  v_mfma_f32_16x16x32_bf16 v[36:39], v[116:119], v[96:99], v[36:39]
  ds_read_b64_tr_b16 v[136:137], v176 offset:2048
  v_mfma_f32_16x16x32_bf16 v[60:63], v[116:119], v[100:103], v[60:63]
  ds_read_b64_tr_b16 v[138:139], v176 offset:2304
  s_waitcnt lgkmcnt(10)
  v_mfma_f32_16x16x32_bf16 v[40:43], v[120:123], v[96:99], v[40:43]
  ds_read_b64_tr_b16 v[140:141], v177 offset:2048
  v_mfma_f32_16x16x32_bf16 v[64:67], v[120:123], v[100:103], v[64:67]
  ds_read_b64_tr_b16 v[142:143], v177 offset:2304
  s_waitcnt lgkmcnt(10)
  v_mfma_f32_16x16x32_bf16 v[44:47], v[124:127], v[96:99], v[44:47]
  ds_read_b64_tr_b16 v[144:145], v178 offset:2048
  v_mfma_f32_16x16x32_bf16 v[68:71], v[124:127], v[100:103], v[68:71]
  ds_read_b64_tr_b16 v[146:147], v178 offset:2304
  s_waitcnt lgkmcnt(10)
  v_mfma_f32_16x16x32_bf16 v[48:51], v[96:99], v[128:131], v[48:51]
  ds_read_b64_tr_b16 v[148:149], v179 offset:2048
  v_mfma_f32_16x16x32_bf16 v[72:75], v[100:103], v[128:131], v[72:75]
  ds_read_b64_tr_b16 v[150:151], v179 offset:2304
  s_waitcnt lgkmcnt(10)
  v_mfma_f32_16x16x32_bf16 v[52:55], v[96:99], v[132:135], v[52:55]
  ds_read_b64_tr_b16 v[152:153], v180 offset:2048
  v_mfma_f32_16x16x32_bf16 v[76:79], v[100:103], v[132:135], v[76:79]
  ds_read_b64_tr_b16 v[154:155], v180 offset:2304
  v_mfma_f32_16x16x32_bf16 v[80:83], v[8:11], v[96:99], v[80:83]
  ds_read_b64_tr_b16 v[156:157], v181 offset:2048
  v_mfma_f32_16x16x32_bf16 v[84:87], v[96:99], v[96:99], v[84:87]
  ds_read_b64_tr_b16 v[158:159], v181 offset:2304
  v_mfma_f32_16x16x32_bf16 v[88:91], v[8:11], v[100:103], v[88:91]
  v_mfma_f32_16x16x32_bf16 v[92:95], v[100:103], v[100:103], v[92:95]
  s_barrier
  s_waitcnt lgkmcnt(10)
  v_mfma_f32_16x16x32_bf16 v[32:35], v[136:139], v[104:107], v[32:35]
  ds_read_b128 v[96:99], v4 offset:0
  v_mfma_f32_16x16x32_bf16 v[56:59], v[136:139], v[108:111], v[56:59]
  ds_read_b128 v[100:103], v4 offset:2048
  s_waitcnt lgkmcnt(10)
  v_mfma_f32_16x16x32_bf16 v[36:39], v[140:143], v[104:107], v[36:39]
  ds_read_b64_tr_b16 v[112:113], v160 offset:16384
  v_mfma_f32_16x16x32_bf16 v[60:63], v[140:143], v[108:111], v[60:63]
  ds_read_b64_tr_b16 v[114:115], v160 offset:16640
  s_waitcnt lgkmcnt(10)
  v_mfma_f32_16x16x32_bf16 v[40:43], v[144:147], v[104:107], v[40:43]
  ds_read_b64_tr_b16 v[116:117], v161 offset:16384
  v_mfma_f32_16x16x32_bf16 v[64:67], v[144:147], v[108:111], v[64:67]
  ds_read_b64_tr_b16 v[118:119], v161 offset:16640
  s_waitcnt lgkmcnt(10)
  v_mfma_f32_16x16x32_bf16 v[44:47], v[148:151], v[104:107], v[44:47]
  ds_read_b64_tr_b16 v[120:121], v162 offset:16384
  v_mfma_f32_16x16x32_bf16 v[68:71], v[148:151], v[108:111], v[68:71]
  ds_read_b64_tr_b16 v[122:123], v162 offset:16640
  s_waitcnt lgkmcnt(10)
  v_mfma_f32_16x16x32_bf16 v[48:51], v[104:107], v[152:155], v[48:51]
  ds_read_b64_tr_b16 v[124:125], v163 offset:16384
  v_mfma_f32_16x16x32_bf16 v[72:75], v[108:111], v[152:155], v[72:75]
  ds_read_b64_tr_b16 v[126:127], v163 offset:16640
  s_waitcnt lgkmcnt(10)
  v_mfma_f32_16x16x32_bf16 v[52:55], v[104:107], v[156:159], v[52:55]
  ds_read_b64_tr_b16 v[128:129], v164 offset:16384
  v_mfma_f32_16x16x32_bf16 v[76:79], v[108:111], v[156:159], v[76:79]
  ds_read_b64_tr_b16 v[130:131], v164 offset:16640
  v_mfma_f32_16x16x32_bf16 v[80:83], v[8:11], v[104:107], v[80:83]
  ds_read_b64_tr_b16 v[132:133], v165 offset:16384
  v_mfma_f32_16x16x32_bf16 v[84:87], v[104:107], v[104:107], v[84:87]
  ds_read_b64_tr_b16 v[134:135], v165 offset:16640
  v_mfma_f32_16x16x32_bf16 v[88:91], v[8:11], v[108:111], v[88:91]
  v_mfma_f32_16x16x32_bf16 v[92:95], v[108:111], v[108:111], v[92:95]
  s_waitcnt lgkmcnt(10)
  v_mfma_f32_16x16x32_bf16 v[32:35], v[112:115], v[96:99], v[32:35]
  ds_read_b128 v[104:107], v5 offset:0
  v_mfma_f32_16x16x32_bf16 v[56:59], v[112:115], v[100:103], v[56:59]
  ds_read_b128 v[108:111], v5 offset:2048
  s_waitcnt lgkmcnt(10)
  v_mfma_f32_16x16x32_bf16 v[36:39], v[116:119], v[96:99], v[36:39]
  ds_read_b64_tr_b16 v[136:137], v160 offset:18432
  v_mfma_f32_16x16x32_bf16 v[60:63], v[116:119], v[100:103], v[60:63]
  ds_read_b64_tr_b16 v[138:139], v160 offset:18688
  s_waitcnt lgkmcnt(10)
  v_mfma_f32_16x16x32_bf16 v[40:43], v[120:123], v[96:99], v[40:43]
  ds_read_b64_tr_b16 v[140:141], v161 offset:18432
  v_mfma_f32_16x16x32_bf16 v[64:67], v[120:123], v[100:103], v[64:67]
  ds_read_b64_tr_b16 v[142:143], v161 offset:18688
  s_waitcnt lgkmcnt(10)
  v_mfma_f32_16x16x32_bf16 v[44:47], v[124:127], v[96:99], v[44:47]
  ds_read_b64_tr_b16 v[144:145], v162 offset:18432
  v_mfma_f32_16x16x32_bf16 v[68:71], v[124:127], v[100:103], v[68:71]
  ds_read_b64_tr_b16 v[146:147], v162 offset:18688
  s_waitcnt lgkmcnt(10)
  v_mfma_f32_16x16x32_bf16 v[48:51], v[96:99], v[128:131], v[48:51]
  ds_read_b64_tr_b16 v[148:149], v163 offset:18432
  v_mfma_f32_16x16x32_bf16 v[72:75], v[100:103], v[128:131], v[72:75]
  ds_read_b64_tr_b16 v[150:151], v163 offset:18688
  s_waitcnt lgkmcnt(10)
  v_mfma_f32_16x16x32_bf16 v[52:55], v[96:99], v[132:135], v[52:55]
  ds_read_b64_tr_b16 v[152:153], v164 offset:18432
  v_mfma_f32_16x16x32_bf16 v[76:79], v[100:103], v[132:135], v[76:79]
  ds_read_b64_tr_b16 v[154:155], v164 offset:18688
  v_mfma_f32_16x16x32_bf16 v[80:83], v[8:11], v[96:99], v[80:83]
  ds_read_b64_tr_b16 v[156:157], v165 offset:18432
  v_mfma_f32_16x16x32_bf16 v[84:87], v[96:99], v[96:99], v[84:87]
  ds_read_b64_tr_b16 v[158:159], v165 offset:18688
  v_mfma_f32_16x16x32_bf16 v[88:91], v[8:11], v[100:103], v[88:91]
  v_mfma_f32_16x16x32_bf16 v[92:95], v[100:103], v[100:103], v[92:95]
  s_barrier
  s_waitcnt lgkmcnt(10)
  v_mfma_f32_16x16x32_bf16 v[32:35], v[136:139], v[104:107], v[32:35]
  ds_read_b128 v[96:99], v4 offset:28672
  v_mfma_f32_16x16x32_bf16 v[56:59], v[136:139], v[108:111], v[56:59]
  ds_read_b128 v[100:103], v4 offset:30720
  s_waitcnt lgkmcnt(10)
  v_mfma_f32_16x16x32_bf16 v[36:39], v[140:143], v[104:107], v[36:39]
  ds_read_b64_tr_b16 v[112:113], v160 offset:45056
  v_mfma_f32_16x16x32_bf16 v[60:63], v[140:143], v[108:111], v[60:63]
  ds_read_b64_tr_b16 v[114:115], v160 offset:45312
  s_waitcnt lgkmcnt(10)
  v_mfma_f32_16x16x32_bf16 v[40:43], v[144:147], v[104:107], v[40:43]
  ds_read_b64_tr_b16 v[116:117], v161 offset:45056
  v_mfma_f32_16x16x32_bf16 v[64:67], v[144:147], v[108:111], v[64:67]
  ds_read_b64_tr_b16 v[118:119], v161 offset:45312
  s_waitcnt lgkmcnt(10)
  v_mfma_f32_16x16x32_bf16 v[44:47], v[148:151], v[104:107], v[44:47]
  ds_read_b64_tr_b16 v[120:121], v162 offset:45056
  v_mfma_f32_16x16x32_bf16 v[68:71], v[148:151], v[108:111], v[68:71]
  ds_read_b64_tr_b16 v[122:123], v162 offset:45312
  s_waitcnt lgkmcnt(10)
  v_mfma_f32_16x16x32_bf16 v[48:51], v[104:107], v[152:155], v[48:51]
  ds_read_b64_tr_b16 v[124:125], v163 offset:45056
  v_mfma_f32_16x16x32_bf16 v[72:75], v[108:111], v[152:155], v[72:75]
  ds_read_b64_tr_b16 v[126:127], v163 offset:45312
  s_waitcnt lgkmcnt(10)
  v_mfma_f32_16x16x32_bf16 v[52:55], v[104:107], v[156:159], v[52:55]
  ds_read_b64_tr_b16 v[128:129], v164 offset:45056
  v_mfma_f32_16x16x32_bf16 v[76:79], v[108:111], v[156:159], v[76:79]
  ds_read_b64_tr_b16 v[130:131], v164 offset:45312
  v_mfma_f32_16x16x32_bf16 v[80:83], v[8:11], v[104:107], v[80:83]
  ds_read_b64_tr_b16 v[132:133], v165 offset:45056
  v_mfma_f32_16x16x32_bf16 v[84:87], v[104:107], v[104:107], v[84:87]
  ds_read_b64_tr_b16 v[134:135], v165 offset:45312
  v_mfma_f32_16x16x32_bf16 v[88:91], v[8:11], v[108:111], v[88:91]
  v_mfma_f32_16x16x32_bf16 v[92:95], v[108:111], v[108:111], v[92:95]
  s_waitcnt lgkmcnt(10)
  v_mfma_f32_16x16x32_bf16 v[32:35], v[112:115], v[96:99], v[32:35]
  ds_read_b128 v[104:107], v5 offset:28672
  v_mfma_f32_16x16x32_bf16 v[56:59], v[112:115], v[100:103], v[56:59]
  ds_read_b128 v[108:111], v5 offset:30720
  s_waitcnt lgkmcnt(10)
  v_mfma_f32_16x16x32_bf16 v[36:39], v[116:119], v[96:99], v[36:39]
  ds_read_b64_tr_b16 v[136:137], v160 offset:47104
  v_mfma_f32_16x16x32_bf16 v[60:63], v[116:119], v[100:103], v[60:63]
  ds_read_b64_tr_b16 v[138:139], v160 offset:47360
  s_waitcnt lgkmcnt(10)
  v_mfma_f32_16x16x32_bf16 v[40:43], v[120:123], v[96:99], v[40:43]
  ds_read_b64_tr_b16 v[140:141], v161 offset:47104
  v_mfma_f32_16x16x32_bf16 v[64:67], v[120:123], v[100:103], v[64:67]
  ds_read_b64_tr_b16 v[142:143], v161 offset:47360
  s_waitcnt lgkmcnt(10)
  v_mfma_f32_16x16x32_bf16 v[44:47], v[124:127], v[96:99], v[44:47]
  ds_read_b64_tr_b16 v[144:145], v162 offset:47104
  v_mfma_f32_16x16x32_bf16 v[68:71], v[124:127], v[100:103], v[68:71]
  ds_read_b64_tr_b16 v[146:147], v162 offset:47360
  s_waitcnt lgkmcnt(10)
  v_mfma_f32_16x16x32_bf16 v[48:51], v[96:99], v[128:131], v[48:51]
  ds_read_b64_tr_b16 v[148:149], v163 offset:47104
  v_mfma_f32_16x16x32_bf16 v[72:75], v[100:103], v[128:131], v[72:75]
  ds_read_b64_tr_b16 v[150:151], v163 offset:47360
  s_waitcnt lgkmcnt(10)
  v_mfma_f32_16x16x32_bf16 v[52:55], v[96:99], v[132:135], v[52:55]
  ds_read_b64_tr_b16 v[152:153], v164 offset:47104
  v_mfma_f32_16x16x32_bf16 v[76:79], v[100:103], v[132:135], v[76:79]
  ds_read_b64_tr_b16 v[154:155], v164 offset:47360
  v_mfma_f32_16x16x32_bf16 v[80:83], v[8:11], v[96:99], v[80:83]
  ds_read_b64_tr_b16 v[156:157], v165 offset:47104
  v_mfma_f32_16x16x32_bf16 v[84:87], v[96:99], v[96:99], v[84:87]
  ds_read_b64_tr_b16 v[158:159], v165 offset:47360
  v_mfma_f32_16x16x32_bf16 v[88:91], v[8:11], v[100:103], v[88:91]
  v_mfma_f32_16x16x32_bf16 v[92:95], v[100:103], v[100:103], v[92:95]
  s_barrier
  s_waitcnt lgkmcnt(10)
  v_mfma_f32_16x16x32_bf16 v[32:35], v[136:139], v[104:107], v[32:35]
  ds_read_b128 v[96:99], v4 offset:57344
  v_mfma_f32_16x16x32_bf16 v[56:59], v[136:139], v[108:111], v[56:59]
  ds_read_b128 v[100:103], v4 offset:59392
  s_waitcnt lgkmcnt(10)
  v_mfma_f32_16x16x32_bf16 v[36:39], v[140:143], v[104:107], v[36:39]
  ds_read_b64_tr_b16 v[112:113], v170 offset:8192
  v_mfma_f32_16x16x32_bf16 v[60:63], v[140:143], v[108:111], v[60:63]
  ds_read_b64_tr_b16 v[114:115], v170 offset:8448
  s_waitcnt lgkmcnt(10)
  v_mfma_f32_16x16x32_bf16 v[40:43], v[144:147], v[104:107], v[40:43]
  ds_read_b64_tr_b16 v[116:117], v171 offset:8192
  v_mfma_f32_16x16x32_bf16 v[64:67], v[144:147], v[108:111], v[64:67]
  ds_read_b64_tr_b16 v[118:119], v171 offset:8448
  s_waitcnt lgkmcnt(10)
  v_mfma_f32_16x16x32_bf16 v[44:47], v[148:151], v[104:107], v[44:47]
  ds_read_b64_tr_b16 v[120:121], v172 offset:8192
  v_mfma_f32_16x16x32_bf16 v[68:71], v[148:151], v[108:111], v[68:71]
  ds_read_b64_tr_b16 v[122:123], v172 offset:8448
  s_waitcnt lgkmcnt(10)
  v_mfma_f32_16x16x32_bf16 v[48:51], v[104:107], v[152:155], v[48:51]
  ds_read_b64_tr_b16 v[124:125], v173 offset:8192
  v_mfma_f32_16x16x32_bf16 v[72:75], v[108:111], v[152:155], v[72:75]
  ds_read_b64_tr_b16 v[126:127], v173 offset:8448
  s_waitcnt lgkmcnt(10)
  v_mfma_f32_16x16x32_bf16 v[52:55], v[104:107], v[156:159], v[52:55]
  ds_read_b64_tr_b16 v[128:129], v174 offset:8192
  v_mfma_f32_16x16x32_bf16 v[76:79], v[108:111], v[156:159], v[76:79]
  ds_read_b64_tr_b16 v[130:131], v174 offset:8448
  v_mfma_f32_16x16x32_bf16 v[80:83], v[8:11], v[104:107], v[80:83]
  ds_read_b64_tr_b16 v[132:133], v175 offset:8192
  v_mfma_f32_16x16x32_bf16 v[84:87], v[104:107], v[104:107], v[84:87]
  ds_read_b64_tr_b16 v[134:135], v175 offset:8448
  v_mfma_f32_16x16x32_bf16 v[88:91], v[8:11], v[108:111], v[88:91]
  v_mfma_f32_16x16x32_bf16 v[92:95], v[108:111], v[108:111], v[92:95]
  s_waitcnt lgkmcnt(10)
  v_mfma_f32_16x16x32_bf16 v[32:35], v[112:115], v[96:99], v[32:35]
  ds_read_b128 v[104:107], v5 offset:57344
  v_mfma_f32_16x16x32_bf16 v[56:59], v[112:115], v[100:103], v[56:59]
  ds_read_b128 v[108:111], v5 offset:59392
  s_waitcnt lgkmcnt(10)
  v_mfma_f32_16x16x32_bf16 v[36:39], v[116:119], v[96:99], v[36:39]
  ds_read_b64_tr_b16 v[136:137], v170 offset:10240
  v_mfma_f32_16x16x32_bf16 v[60:63], v[116:119], v[100:103], v[60:63]
  ds_read_b64_tr_b16 v[138:139], v170 offset:10496
  s_waitcnt lgkmcnt(10)
  v_mfma_f32_16x16x32_bf16 v[40:43], v[120:123], v[96:99], v[40:43]
  ds_read_b64_tr_b16 v[140:141], v171 offset:10240
  v_mfma_f32_16x16x32_bf16 v[64:67], v[120:123], v[100:103], v[64:67]
  ds_read_b64_tr_b16 v[142:143], v171 offset:10496
  s_waitcnt lgkmcnt(10)
  v_mfma_f32_16x16x32_bf16 v[44:47], v[124:127], v[96:99], v[44:47]
  ds_read_b64_tr_b16 v[144:145], v172 offset:10240
  v_mfma_f32_16x16x32_bf16 v[68:71], v[124:127], v[100:103], v[68:71]
  ds_read_b64_tr_b16 v[146:147], v172 offset:10496
  s_waitcnt lgkmcnt(10)
  v_mfma_f32_16x16x32_bf16 v[48:51], v[96:99], v[128:131], v[48:51]
  ds_read_b64_tr_b16 v[148:149], v173 offset:10240
  v_mfma_f32_16x16x32_bf16 v[72:75], v[100:103], v[128:131], v[72:75]
  ds_read_b64_tr_b16 v[150:151], v173 offset:10496
  s_waitcnt lgkmcnt(10)
  v_mfma_f32_16x16x32_bf16 v[52:55], v[96:99], v[132:135], v[52:55]
  ds_read_b64_tr_b16 v[152:153], v174 offset:10240
  v_mfma_f32_16x16x32_bf16 v[76:79], v[100:103], v[132:135], v[76:79]
  ds_read_b64_tr_b16 v[154:155], v174 offset:10496
  v_mfma_f32_16x16x32_bf16 v[80:83], v[8:11], v[96:99], v[80:83]
  ds_read_b64_tr_b16 v[156:157], v175 offset:10240
  v_mfma_f32_16x16x32_bf16 v[84:87], v[96:99], v[96:99], v[84:87]
  ds_read_b64_tr_b16 v[158:159], v175 offset:10496
  v_mfma_f32_16x16x32_bf16 v[88:91], v[8:11], v[100:103], v[88:91]
  v_mfma_f32_16x16x32_bf16 v[92:95], v[100:103], v[100:103], v[92:95]
  s_waitcnt lgkmcnt(10)
  v_mfma_f32_16x16x32_bf16 v[32:35], v[136:139], v[104:107], v[32:35]
  v_mfma_f32_16x16x32_bf16 v[56:59], v[136:139], v[108:111], v[56:59]
  s_waitcnt lgkmcnt(8)
  v_mfma_f32_16x16x32_bf16 v[36:39], v[140:143], v[104:107], v[36:39]
  v_mfma_f32_16x16x32_bf16 v[60:63], v[140:143], v[108:111], v[60:63]
  s_waitcnt lgkmcnt(6)
  v_mfma_f32_16x16x32_bf16 v[40:43], v[144:147], v[104:107], v[40:43]
  v_mfma_f32_16x16x32_bf16 v[64:67], v[144:147], v[108:111], v[64:67]
  s_waitcnt lgkmcnt(4)
  v_mfma_f32_16x16x32_bf16 v[44:47], v[148:151], v[104:107], v[44:47]
  v_mfma_f32_16x16x32_bf16 v[68:71], v[148:151], v[108:111], v[68:71]
  s_waitcnt lgkmcnt(2)
  v_mfma_f32_16x16x32_bf16 v[48:51], v[104:107], v[152:155], v[48:51]
  v_mfma_f32_16x16x32_bf16 v[72:75], v[108:111], v[152:155], v[72:75]
  s_waitcnt lgkmcnt(0)
  v_mfma_f32_16x16x32_bf16 v[52:55], v[104:107], v[156:159], v[52:55]
  v_mfma_f32_16x16x32_bf16 v[76:79], v[108:111], v[156:159], v[76:79]
  v_mfma_f32_16x16x32_bf16 v[80:83], v[8:11], v[104:107], v[80:83]
  v_mfma_f32_16x16x32_bf16 v[84:87], v[104:107], v[104:107], v[84:87]
  v_mfma_f32_16x16x32_bf16 v[88:91], v[8:11], v[108:111], v[88:91]
  v_mfma_f32_16x16x32_bf16 v[92:95], v[108:111], v[108:111], v[92:95]
  s_lshl_b32 s6, s5, 12
  s_add_u32 s6, s6, 57344
  v_add_u32 v26, s6, v228
  v_lshrrev_b32 v24, 2, v2
  v_and_b32 v25, 3, v2
  v_lshlrev_b32 v27, 7, v24
  v_lshl_add_u32 v27, v3, 5, v27
  v_lshl_add_u32 v27, v25, 3, v27
  v_add_u32 v27, s6, v27
  v_lshlrev_b32 v230, 4, v2
  v_lshl_add_u32 v230, v3, 10, v230
  s_waitcnt vmcnt(0)
  ds_write_b128 v26, v[212:215] offset:0
  ds_write_b128 v26, v[216:219] offset:1024
  ds_write_b128 v26, v[220:223] offset:2048
  ds_write_b128 v26, v[224:227] offset:3072
  ds_read_b64_tr_b16 v[212:213], v27 offset:0
  ds_read_b64_tr_b16 v[214:215], v27 offset:512
  ds_read_b64_tr_b16 v[216:217], v27 offset:1024
  ds_read_b64_tr_b16 v[218:219], v27 offset:1536
  ds_read_b64_tr_b16 v[220:221], v27 offset:2048
  ds_read_b64_tr_b16 v[222:223], v27 offset:2560
  ds_read_b64_tr_b16 v[224:225], v27 offset:3072
  ds_read_b64_tr_b16 v[226:227], v27 offset:3584
  s_waitcnt lgkmcnt(6)
  buffer_store_dwordx4 v[212:215], v230, s[60:63], s8 offen sc1
  s_waitcnt lgkmcnt(4)
  buffer_store_dwordx4 v[216:219], v229, s[60:63], s9 offen sc1
  s_waitcnt lgkmcnt(0)
  s_and_b32 s7, s13, 15
  s_cmp_ge_u32 s7, 8
  s_cbranch_scc1 LS1ac_nob2s
  s_add_u32 s9, s9, 1187840
  buffer_store_dwordx4 v[220:223], v229, s[60:63], s9 offen sc1
LS1ac_nob2s:
  s_cmp_ge_u32 s13, 864
  s_cbranch_scc1 LS1ac_noa2s
  buffer_store_dwordx4 v[224:227], v230, s[60:63], s10 offen sc1
LS1ac_noa2s:
  s_mov_b32 s15, 0
  s_barrier
  v_lshlrev_b32 v180, 4, v3
  v_lshlrev_b32 v181, 2, v2
  v_add_u32 v180, 143360, v180
  v_add_u32 v181, 143360, v181
  ds_read_b128 v[192:195], v180 offset:128
  ds_read_b128 v[196:199], v180 offset:192
  ds_read_b32 v200, v181 offset:256
  ds_read_b32 v201, v181 offset:320
  ds_read_b128 v[184:187], v180 offset:0
  ds_read_b128 v[188:191], v180 offset:64
  ds_read_b128 v[220:223], v180 offset:512
  ds_read_b128 v[224:227], v180 offset:576
  ds_read_b32 v228, v181 offset:640
  ds_read_b32 v229, v181 offset:704
  ds_read_b128 v[212:215], v180 offset:384
  ds_read_b128 v[216:219], v180 offset:448
  v_lshrrev_b32 v26, 2, v2
  v_lshl_add_u32 v26, v3, 2, v26
  v_and_b32 v27, 3, v2
  v_lshlrev_b32 v27, 3, v27
  v_lshl_add_u32 v26, v26, 5, v27
  v_add_u32 v26, 144384, v26
  ds_read_b64_tr_b16 v[28:29], v26 offset:0
  ds_read_b64_tr_b16 v[30:31], v26 offset:512
  v_cndmask_b32 v96, 0, v84, s[64:65]
  v_cndmask_b32 v100, 0, v92, s[64:65]
  v_cndmask_b32 v96, v96, v85, s[66:67]
  v_cndmask_b32 v100, v100, v93, s[66:67]
  v_cndmask_b32 v96, v96, v86, s[68:69]
  v_cndmask_b32 v100, v100, v94, s[68:69]
  v_cndmask_b32 v96, v96, v87, s[70:71]
  v_cndmask_b32 v100, v100, v95, s[70:71]
  v_mul_f32 v99, 0x3b000000, v80
  v_mul_f32 v103, 0x3b000000, v88
  v_mov_b32 v97, v96
  v_mov_b32 v101, v100
  s_nop 0
  v_permlane16_swap_b32 v96, v97
  v_permlane16_swap_b32 v100, v101
  v_add_f32 v96, v96, v97
  v_add_f32 v100, v100, v101
  v_mov_b32 v97, v96
  v_mov_b32 v101, v100
  s_nop 0
  v_permlane32_swap_b32 v96, v97
  v_permlane32_swap_b32 v100, v101
  v_add_f32 v96, v96, v97
  v_add_f32 v100, v100, v101
  v_cvt_pk_bf16_f32 v97, v99, v99
  v_cvt_pk_bf16_f32 v101, v103, v103
  v_lshlrev_b32 v16, 16, v97
  v_lshlrev_b32 v18, 16, v101
  v_mul_f32 v96, 0x3b000000, v96
  v_mul_f32 v100, 0x3b000000, v100
  v_fma_f32 v96, -v99, v99, v96
  v_fma_f32 v100, -v103, v103, v100
  v_max_f32 v96, 0, v96
  v_max_f32 v100, 0, v100
  v_cvt_pk_bf16_f32 v97, v96, v96
  v_cvt_pk_bf16_f32 v101, v100, v100
  v_lshlrev_b32 v96, 16, v97
  v_lshlrev_b32 v100, 16, v101
  v_add_f32 v96, 0x3727c5ac, v96
  v_add_f32 v100, 0x3727c5ac, v100
  v_cvt_pk_bf16_f32 v97, v96, v96
  v_cvt_pk_bf16_f32 v101, v100, v100
  v_lshlrev_b32 v96, 16, v97
  v_lshlrev_b32 v100, 16, v101
  v_sqrt_f32 v96, v96
  v_sqrt_f32 v100, v100
  v_cvt_pk_bf16_f32 v97, v96, v96
  v_cvt_pk_bf16_f32 v101, v100, v100
  v_lshlrev_b32 v96, 16, v97
  v_lshlrev_b32 v100, 16, v101
  v_rcp_f32 v17, v96
  v_rcp_f32 v19, v100
  v_sub_f32 v16, 0, v16
  v_sub_f32 v18, 0, v18
  v_mov_b32 v24, 0x3f80
  v_mov_b32 v25, 0x3f800000
  v_cndmask_b32 v22, 0, v24, s[64:65]
  v_cndmask_b32 v26, 0, v25, s[66:67]
  v_or_b32 v22, v22, v26
  v_cndmask_b32 v23, 0, v24, s[68:69]
  v_cndmask_b32 v26, 0, v25, s[70:71]
  v_or_b32 v23, v23, v26
  v_and_b32 v24, 1, v3
  v_lshlrev_b32 v20, 4, v2
  v_lshl_add_u32 v20, v24, 9, v20
  v_lshrrev_b32 v24, 1, v3
  v_lshl_add_u32 v20, v24, 8, v20
  s_lshl_b32 s6, s5, 12
  v_lshlrev_b32 v4, 4, v1
  v_add_u32 v4, s6, v4
  s_lshl_b32 s6, s5, 8
  v_lshlrev_b32 v14, 4, v3
  v_add_u32 v5, s6, v14
  v_mov_b32 v6, 161792
  v_mov_b32 v7, 1
  v_lshlrev_b32 v12, 4, v0
  v_lshlrev_b32 v21, 3, v0
  v_lshl_add_u32 v13, v2, 6, v14
  v_add_u32 v24, 0, v14
  v_add_u32 v25, 4, v14
  v_add_u32 v26, 8, v14
  v_add_u32 v27, 12, v14
  s_lshl_b32 s13, s4, 4
  s_add_u32 s13, s13, s3
  s_mul_i32 s13, s13, 2304
  s_add_u32 s13, s13, 30408704
  s_lshl_b32 s8, s3, 3
  s_lshl_b32 s6, s5, 1
  s_add_u32 s8, s8, s6
  s_mul_i32 s9, s8, 62464
  s_mul_i32 s6, s24, 44032
  s_add_u32 s9, s9, s6
  s_add_u32 s9, s9, 50331648
  s_lshl_b32 s6, s4, 10
  s_add_u32 s9, s9, s6
  s_add_u32 s12, s9, 62464
  ds_bpermute_b32 v132, v24, v16
  ds_bpermute_b32 v128, v24, v17
  ds_bpermute_b32 v133, v25, v16
  ds_bpermute_b32 v129, v25, v17
  ds_bpermute_b32 v134, v26, v16
  ds_bpermute_b32 v130, v26, v17
  ds_bpermute_b32 v135, v27, v16
  ds_bpermute_b32 v131, v27, v17
  ds_bpermute_b32 v140, v24, v18
  ds_bpermute_b32 v136, v24, v19
  ds_bpermute_b32 v141, v25, v18
  ds_bpermute_b32 v137, v25, v19
  ds_bpermute_b32 v142, v26, v18
  ds_bpermute_b32 v138, v26, v19
  ds_bpermute_b32 v143, v27, v18
  ds_bpermute_b32 v139, v27, v19
  v_mov_b32 v202, 0x3fb8aa3b
  v_mov_b32 v203, 0x3fb8aa3b
  s_waitcnt lgkmcnt(15)
  s_mov_b32 s40, s16
  s_mov_b32 s41, s17
  s_mov_b32 s42, 2097152
  s_mov_b32 s43, 0x00020000
  s_and_b32 s6, s100, 7
  s_bfe_u32 s7, s100, 0x20003
  s_lshl_b32 s6, s6, 2
  s_add_u32 s6, s6, s7
  s_lshl_b32 s6, s6, 2
  s_add_u32 s6, s6, s5
  s_lshl_b32 s6, s6, 14
  s_lshr_b32 s7, s100, 5
  s_lshl_b32 s7, s7, 7
  s_add_u32 s6, s6, s7
  v_lshlrev_b32 v250, 10, v2
  v_lshl_add_u32 v250, v3, 3, v250
  buffer_load_dwordx2 v[240:241], v250, s[40:43], s6 offen offset:0
  buffer_load_dwordx2 v[242:243], v250, s[40:43], s6 offen offset:32
  buffer_load_dwordx2 v[244:245], v250, s[40:43], s6 offen offset:64
  buffer_load_dwordx2 v[246:247], v250, s[40:43], s6 offen offset:96
  v_pk_add_f32 v[184:185], v[184:185], v[212:213]
  v_pk_add_f32 v[186:187], v[186:187], v[214:215]
  v_pk_add_f32 v[188:189], v[188:189], v[216:217]
  v_pk_add_f32 v[190:191], v[190:191], v[218:219]
  v_pk_add_f32 v[192:193], v[192:193], v[220:221]
  v_pk_add_f32 v[194:195], v[194:195], v[222:223]
  v_pk_add_f32 v[196:197], v[196:197], v[224:225]
  v_pk_add_f32 v[198:199], v[198:199], v[226:227]
  v_pk_add_f32 v[200:201], v[200:201], v[228:229]
  s_waitcnt lgkmcnt(0)
  s_lshl_b32 s7, s5, 2
  s_add_u32 s6, s15, 2
  s_add_u32 s7, s7, 161808
  v_mov_b32 v232, s6
  v_mov_b32 v233, s7
  s_mov_b64 exec, 1
  ds_write_b32 v233, v232
  s_mov_b64 exec, -1
  v_pk_fma_f32 v[40:41], v[192:193], v[16:17], v[40:41] op_sel_hi:[1,0,1]
  v_pk_fma_f32 v[64:65], v[192:193], v[18:19], v[64:65] op_sel_hi:[1,0,1]
  v_pk_fma_f32 v[42:43], v[194:195], v[16:17], v[42:43] op_sel_hi:[1,0,1]
  v_pk_fma_f32 v[66:67], v[194:195], v[18:19], v[66:67] op_sel_hi:[1,0,1]
  v_pk_mul_f32 v[40:41], v[40:41], v[16:17] op_sel:[0,1] op_sel_hi:[1,1]
  v_pk_mul_f32 v[64:65], v[64:65], v[18:19] op_sel:[0,1] op_sel_hi:[1,1]
  v_pk_mul_f32 v[42:43], v[42:43], v[16:17] op_sel:[0,1] op_sel_hi:[1,1]
  v_pk_mul_f32 v[66:67], v[66:67], v[18:19] op_sel:[0,1] op_sel_hi:[1,1]
  v_pk_fma_f32 v[44:45], v[196:197], v[16:17], v[44:45] op_sel_hi:[1,0,1]
  v_pk_fma_f32 v[68:69], v[196:197], v[18:19], v[68:69] op_sel_hi:[1,0,1]
  v_pk_fma_f32 v[46:47], v[198:199], v[16:17], v[46:47] op_sel_hi:[1,0,1]
  v_pk_fma_f32 v[70:71], v[198:199], v[18:19], v[70:71] op_sel_hi:[1,0,1]
  v_pk_mul_f32 v[44:45], v[44:45], v[16:17] op_sel:[0,1] op_sel_hi:[1,1]
  v_pk_mul_f32 v[68:69], v[68:69], v[18:19] op_sel:[0,1] op_sel_hi:[1,1]
  v_pk_mul_f32 v[46:47], v[46:47], v[16:17] op_sel:[0,1] op_sel_hi:[1,1]
  v_pk_mul_f32 v[70:71], v[70:71], v[18:19] op_sel:[0,1] op_sel_hi:[1,1]
  v_cvt_pk_bf16_f32 v212, v40, v41
  v_cvt_pk_bf16_f32 v152, v64, v65
  v_cvt_pk_bf16_f32 v213, v42, v43
  v_cvt_pk_bf16_f32 v153, v66, v67
  v_cvt_pk_bf16_f32 v214, v44, v45
  v_cvt_pk_bf16_f32 v154, v68, v69
  v_cvt_pk_bf16_f32 v215, v46, v47
  v_cvt_pk_bf16_f32 v155, v70, v71
  v_mfma_f32_16x16x16_bf16 v[216:219], v[28:29], v[212:213], 0
  v_mfma_f32_16x16x16_bf16 v[156:159], v[28:29], v[152:153], 0
  v_mfma_f32_16x16x16_bf16 v[220:223], v[30:31], v[214:215], 0
  v_mfma_f32_16x16x16_bf16 v[160:163], v[30:31], v[154:155], 0
  v_pk_fma_f32 v[48:49], v[132:133], v[200:201], v[48:49] op_sel_hi:[1,0,1]
  v_pk_fma_f32 v[72:73], v[140:141], v[200:201], v[72:73] op_sel_hi:[1,0,1]
  v_pk_fma_f32 v[50:51], v[134:135], v[200:201], v[50:51] op_sel_hi:[1,0,1]
  v_pk_fma_f32 v[74:75], v[142:143], v[200:201], v[74:75] op_sel_hi:[1,0,1]
  v_pk_mul_f32 v[48:49], v[48:49], v[128:129]
  v_pk_mul_f32 v[72:73], v[72:73], v[136:137]
  v_pk_mul_f32 v[50:51], v[50:51], v[130:131]
  v_pk_mul_f32 v[74:75], v[74:75], v[138:139]
  v_cvt_pk_bf16_f32 v204, v48, v49
  v_cvt_pk_bf16_f32 v206, v72, v73
  v_cvt_pk_bf16_f32 v205, v50, v51
  v_cvt_pk_bf16_f32 v207, v74, v75
  v_pk_fma_f32 v[52:53], v[132:133], v[200:201], v[52:53] op_sel:[0,1,0] op_sel_hi:[1,1,1]
  v_pk_fma_f32 v[76:77], v[140:141], v[200:201], v[76:77] op_sel:[0,1,0] op_sel_hi:[1,1,1]
  v_pk_fma_f32 v[54:55], v[134:135], v[200:201], v[54:55] op_sel:[0,1,0] op_sel_hi:[1,1,1]
  v_pk_fma_f32 v[78:79], v[142:143], v[200:201], v[78:79] op_sel:[0,1,0] op_sel_hi:[1,1,1]
  v_pk_mul_f32 v[52:53], v[52:53], v[128:129]
  v_pk_mul_f32 v[76:77], v[76:77], v[136:137]
  v_pk_mul_f32 v[54:55], v[54:55], v[130:131]
  v_pk_mul_f32 v[78:79], v[78:79], v[138:139]
  v_cvt_pk_bf16_f32 v208, v52, v53
  v_cvt_pk_bf16_f32 v210, v76, v77
  v_cvt_pk_bf16_f32 v209, v54, v55
  v_cvt_pk_bf16_f32 v211, v78, v79
  v_cvt_pk_bf16_f32 v212, v216, v217
  v_cvt_pk_bf16_f32 v152, v156, v157
  v_cvt_pk_bf16_f32 v213, v218, v219
  v_cvt_pk_bf16_f32 v153, v158, v159
  v_lshlrev_b32 v216, 16, v212
  v_lshlrev_b32 v156, 16, v152
  v_and_b32 v217, 0xffff0000, v212
  v_and_b32 v157, 0xffff0000, v152
  v_lshlrev_b32 v218, 16, v213
  v_lshlrev_b32 v158, 16, v153
  v_and_b32 v219, 0xffff0000, v213
  v_and_b32 v159, 0xffff0000, v153
  v_cvt_pk_bf16_f32 v214, v220, v221
  v_cvt_pk_bf16_f32 v154, v160, v161
  v_cvt_pk_bf16_f32 v215, v222, v223
  v_cvt_pk_bf16_f32 v155, v162, v163
  v_lshlrev_b32 v220, 16, v214
  v_lshlrev_b32 v160, 16, v154
  v_and_b32 v221, 0xffff0000, v214
  v_and_b32 v161, 0xffff0000, v154
  v_lshlrev_b32 v222, 16, v215
  v_lshlrev_b32 v162, 16, v155
  v_and_b32 v223, 0xffff0000, v215
  v_and_b32 v163, 0xffff0000, v155
  v_max3_f32 v232, v216, v217, v218
  v_max3_f32 v172, v156, v157, v158
  v_max3_f32 v234, -v216, -v217, -v218
  v_max3_f32 v174, -v156, -v157, -v158
  v_max_f32 v232, v232, v219
  v_max_f32 v172, v172, v159
  v_max_f32_e64 v234, v234, -v219
  v_max_f32_e64 v174, v174, -v159
  v_max3_f32 v236, v220, v221, v222
  v_max3_f32 v176, v160, v161, v162
  v_max3_f32 v238, -v220, -v221, -v222
  v_max3_f32 v178, -v160, -v161, -v162
  v_max_f32 v236, v236, v223
  v_max_f32 v176, v176, v163
  v_max_f32_e64 v238, v238, -v223
  v_max_f32_e64 v178, v178, -v163
  v_permlane16_swap_b32 v232, v234
  v_permlane16_swap_b32 v172, v174
  v_permlane16_swap_b32 v236, v238
  v_permlane16_swap_b32 v176, v178
  v_max_f32 v232, v232, v234
  v_max_f32 v172, v172, v174
  v_max_f32 v236, v236, v238
  v_max_f32 v176, v176, v178
  s_nop 0
  v_permlane32_swap_b32 v232, v236
  v_permlane32_swap_b32 v172, v176
  v_max_f32 v232, v232, v236
  v_max_f32 v172, v172, v176
  v_mul_f32 v232, 0xbfb8aa3b, v232
  v_mul_f32 v172, 0xbfb8aa3b, v172
  v_mov_b32 v236, v232
  v_mov_b32 v176, v172
  s_nop 0
  v_permlane32_swap_b32 v232, v236
  v_permlane32_swap_b32 v172, v176
  v_mov_b32 v234, v232
  v_mov_b32 v174, v172
  v_mov_b32 v238, v236
  v_mov_b32 v178, v176
  v_permlane16_swap_b32 v232, v234
  v_permlane16_swap_b32 v172, v174
  v_permlane16_swap_b32 v236, v238
  v_permlane16_swap_b32 v176, v178
  v_pk_fma_f32 v[224:225], v[216:217], v[202:203], v[234:235] op_sel_hi:[1,1,0] neg_lo:[0,1,0] neg_hi:[0,1,0]
  v_pk_fma_f32 v[164:165], v[156:157], v[202:203], v[174:175] op_sel_hi:[1,1,0] neg_lo:[0,1,0] neg_hi:[0,1,0]
  v_pk_fma_f32 v[226:227], v[218:219], v[202:203], v[234:235] op_sel_hi:[1,1,0] neg_lo:[0,1,0] neg_hi:[0,1,0]
  v_pk_fma_f32 v[166:167], v[158:159], v[202:203], v[174:175] op_sel_hi:[1,1,0] neg_lo:[0,1,0] neg_hi:[0,1,0]
  v_pk_fma_f32 v[216:217], v[216:217], v[202:203], v[232:233] op_sel_hi:[1,1,0]
  v_pk_fma_f32 v[156:157], v[156:157], v[202:203], v[172:173] op_sel_hi:[1,1,0]
  v_pk_fma_f32 v[218:219], v[218:219], v[202:203], v[232:233] op_sel_hi:[1,1,0]
  v_pk_fma_f32 v[158:159], v[158:159], v[202:203], v[172:173] op_sel_hi:[1,1,0]
  v_pk_fma_f32 v[228:229], v[220:221], v[202:203], v[238:239] op_sel_hi:[1,1,0] neg_lo:[0,1,0] neg_hi:[0,1,0]
  v_pk_fma_f32 v[168:169], v[160:161], v[202:203], v[178:179] op_sel_hi:[1,1,0] neg_lo:[0,1,0] neg_hi:[0,1,0]
  v_pk_fma_f32 v[230:231], v[222:223], v[202:203], v[238:239] op_sel_hi:[1,1,0] neg_lo:[0,1,0] neg_hi:[0,1,0]
  v_pk_fma_f32 v[170:171], v[162:163], v[202:203], v[178:179] op_sel_hi:[1,1,0] neg_lo:[0,1,0] neg_hi:[0,1,0]
  v_pk_fma_f32 v[220:221], v[220:221], v[202:203], v[236:237] op_sel_hi:[1,1,0]
  v_pk_fma_f32 v[160:161], v[160:161], v[202:203], v[176:177] op_sel_hi:[1,1,0]
  v_pk_fma_f32 v[222:223], v[222:223], v[202:203], v[236:237] op_sel_hi:[1,1,0]
  v_pk_fma_f32 v[162:163], v[162:163], v[202:203], v[176:177] op_sel_hi:[1,1,0]
  v_exp_f32 v216, v216
  v_exp_f32 v156, v156
  v_exp_f32 v217, v217
  v_exp_f32 v157, v157
  v_exp_f32 v218, v218
  v_exp_f32 v158, v158
  v_exp_f32 v219, v219
  v_exp_f32 v159, v159
  v_exp_f32 v224, v224
  v_exp_f32 v164, v164
  v_exp_f32 v225, v225
  v_exp_f32 v165, v165
  v_exp_f32 v226, v226
  v_exp_f32 v166, v166
  v_exp_f32 v227, v227
  v_exp_f32 v167, v167
  v_exp_f32 v220, v220
  v_exp_f32 v160, v160
  v_exp_f32 v221, v221
  v_exp_f32 v161, v161
  v_exp_f32 v222, v222
  v_exp_f32 v162, v162
  v_exp_f32 v223, v223
  v_exp_f32 v163, v163
  v_exp_f32 v228, v228
  v_exp_f32 v168, v168
  v_exp_f32 v229, v229
  v_exp_f32 v169, v169
  v_exp_f32 v230, v230
  v_exp_f32 v170, v170
  v_exp_f32 v231, v231
  v_exp_f32 v171, v171
  v_pk_add_f32 v[232:233], v[216:217], v[218:219]
  v_pk_add_f32 v[172:173], v[156:157], v[158:159]
  v_pk_add_f32 v[234:235], v[224:225], v[226:227]
  v_pk_add_f32 v[174:175], v[164:165], v[166:167]
  v_pk_add_f32 v[236:237], v[220:221], v[222:223]
  v_pk_add_f32 v[176:177], v[160:161], v[162:163]
  v_pk_add_f32 v[238:239], v[228:229], v[230:231]
  v_pk_add_f32 v[178:179], v[168:169], v[170:171]
  v_add_f32 v232, v232, v233
  v_add_f32 v172, v172, v173
  v_add_f32 v234, v234, v235
  v_add_f32 v174, v174, v175
  v_add_f32 v236, v236, v237
  v_add_f32 v176, v176, v177
  v_add_f32 v238, v238, v239
  v_add_f32 v178, v178, v179
  v_permlane16_swap_b32 v232, v234
  v_permlane16_swap_b32 v172, v174
  v_permlane16_swap_b32 v236, v238
  v_permlane16_swap_b32 v176, v178
  v_add_f32 v232, v232, v234
  v_add_f32 v172, v172, v174
  v_add_f32 v236, v236, v238
  v_add_f32 v176, v176, v178
  s_nop 0
  v_permlane32_swap_b32 v232, v236
  v_permlane32_swap_b32 v172, v176
  v_add_f32 v232, v232, v236
  v_add_f32 v172, v172, v176
  v_rcp_f32 v232, v232
  v_rcp_f32 v172, v172
  v_mov_b32 v236, v232
  v_mov_b32 v176, v172
  s_nop 0
  v_permlane32_swap_b32 v232, v236
  v_permlane32_swap_b32 v172, v176
  v_mov_b32 v234, v232
  v_mov_b32 v174, v172
  v_mov_b32 v238, v236
  v_mov_b32 v178, v176
  v_permlane16_swap_b32 v232, v234
  v_permlane16_swap_b32 v172, v174
  v_permlane16_swap_b32 v236, v238
  v_permlane16_swap_b32 v176, v178
  v_pk_mul_f32 v[216:217], v[216:217], v[232:233] op_sel_hi:[1,0]
  v_pk_mul_f32 v[156:157], v[156:157], v[172:173] op_sel_hi:[1,0]
  v_pk_mul_f32 v[218:219], v[218:219], v[232:233] op_sel_hi:[1,0]
  v_pk_mul_f32 v[158:159], v[158:159], v[172:173] op_sel_hi:[1,0]
  v_pk_mul_f32 v[224:225], v[224:225], v[234:235] op_sel_hi:[1,0]
  v_pk_mul_f32 v[164:165], v[164:165], v[174:175] op_sel_hi:[1,0]
  v_pk_mul_f32 v[226:227], v[226:227], v[234:235] op_sel_hi:[1,0]
  v_pk_mul_f32 v[166:167], v[166:167], v[174:175] op_sel_hi:[1,0]
  v_pk_mul_f32 v[220:221], v[220:221], v[236:237] op_sel_hi:[1,0]
  v_pk_mul_f32 v[160:161], v[160:161], v[176:177] op_sel_hi:[1,0]
  v_pk_mul_f32 v[222:223], v[222:223], v[236:237] op_sel_hi:[1,0]
  v_pk_mul_f32 v[162:163], v[162:163], v[176:177] op_sel_hi:[1,0]
  v_pk_mul_f32 v[228:229], v[228:229], v[238:239] op_sel_hi:[1,0]
  v_pk_mul_f32 v[168:169], v[168:169], v[178:179] op_sel_hi:[1,0]
  v_pk_mul_f32 v[230:231], v[230:231], v[238:239] op_sel_hi:[1,0]
  v_pk_mul_f32 v[170:171], v[170:171], v[178:179] op_sel_hi:[1,0]
  v_cvt_pk_bf16_f32 v216, v216, v217
  v_cvt_pk_bf16_f32 v156, v156, v157
  v_cvt_pk_bf16_f32 v217, v218, v219
  v_cvt_pk_bf16_f32 v157, v158, v159
  s_nop 0
  v_mfma_f32_16x16x16_bf16 v[40:43], v[216:217], v[22:23], 0
  v_mfma_f32_16x16x16_bf16 v[64:67], v[156:157], v[22:23], 0
  v_cvt_pk_bf16_f32 v224, v224, v225
  v_cvt_pk_bf16_f32 v164, v164, v165
  v_cvt_pk_bf16_f32 v225, v226, v227
  v_cvt_pk_bf16_f32 v165, v166, v167
  s_nop 0
  v_mfma_f32_16x16x16_bf16 v[44:47], v[224:225], v[22:23], 0
  v_mfma_f32_16x16x16_bf16 v[68:71], v[164:165], v[22:23], 0
  v_cvt_pk_bf16_f32 v220, v220, v221
  v_cvt_pk_bf16_f32 v160, v160, v161
  v_cvt_pk_bf16_f32 v221, v222, v223
  v_cvt_pk_bf16_f32 v161, v162, v163
  s_nop 0
  v_mfma_f32_16x16x16_bf16 v[48:51], v[220:221], v[22:23], 0
  v_mfma_f32_16x16x16_bf16 v[72:75], v[160:161], v[22:23], 0
  v_cvt_pk_bf16_f32 v228, v228, v229
  v_cvt_pk_bf16_f32 v168, v168, v169
  v_cvt_pk_bf16_f32 v229, v230, v231
  v_cvt_pk_bf16_f32 v169, v170, v171
  s_nop 0
  v_mfma_f32_16x16x16_bf16 v[52:55], v[228:229], v[22:23], 0
  v_mfma_f32_16x16x16_bf16 v[76:79], v[168:169], v[22:23], 0
  v_cvt_pk_bf16_f32 v80, v40, v41
  v_cvt_pk_bf16_f32 v82, v64, v65
  v_cvt_pk_bf16_f32 v81, v42, v43
  v_cvt_pk_bf16_f32 v83, v66, v67
  v_cvt_pk_bf16_f32 v84, v44, v45
  v_cvt_pk_bf16_f32 v86, v68, v69
  v_cvt_pk_bf16_f32 v85, v46, v47
  v_cvt_pk_bf16_f32 v87, v70, v71
  v_cvt_pk_bf16_f32 v88, v48, v49
  v_cvt_pk_bf16_f32 v90, v72, v73
  v_cvt_pk_bf16_f32 v89, v50, v51
  v_cvt_pk_bf16_f32 v91, v74, v75
  v_cvt_pk_bf16_f32 v92, v52, v53
  v_cvt_pk_bf16_f32 v94, v76, v77
  v_cvt_pk_bf16_f32 v93, v54, v55
  v_cvt_pk_bf16_f32 v95, v78, v79
  v_mfma_f32_16x16x32_bf16 v[120:123], v[80:83], v[204:207], 0
  v_mfma_f32_16x16x32_bf16 v[124:127], v[84:87], v[204:207], 0
  v_mfma_f32_16x16x32_bf16 v[128:131], v[88:91], v[208:211], 0
  v_mfma_f32_16x16x32_bf16 v[132:135], v[92:95], v[208:211], 0
  v_mfma_f32_16x16x32_bf16 v[136:139], v[80:83], v[8:11], 0
  v_mfma_f32_16x16x32_bf16 v[140:143], v[84:87], v[8:11], 0
  v_mfma_f32_16x16x32_bf16 v[144:147], v[88:91], v[8:11], 0
  v_mfma_f32_16x16x32_bf16 v[148:151], v[92:95], v[8:11], 0
  s_nop 0
  ds_write_b128 v4, v[120:123] offset:24576
  ds_write_b128 v4, v[124:127] offset:25600
  ds_write_b128 v4, v[128:131] offset:26624
  ds_write_b128 v4, v[132:135] offset:27648
  s_mov_b32 exec_lo, 0x00010001
  s_mov_b32 exec_hi, 0x00010001
  ds_write_b128 v5, v[136:139] offset:40960
  ds_write_b128 v5, v[140:143] offset:41024
  ds_write_b128 v5, v[144:147] offset:41088
  ds_write_b128 v5, v[148:151] offset:41152
  s_mov_b64 exec, 1
  ds_add_u32 v6, v7 offset:4
  s_mov_b64 exec, -1
LS1ac_rs:
  ds_read_b32 v7, v6 offset:4
  s_waitcnt lgkmcnt(0)
  v_readfirstlane_b32 s6, v7
  s_cmp_lt_u32 s6, 4
  s_cbranch_scc1 LS1ac_rs
  ds_read_b128 v[120:123], v12 offset:24576
  ds_read_b128 v[124:127], v12 offset:28672
  ds_read_b128 v[128:131], v12 offset:32768
  ds_read_b128 v[132:135], v12 offset:36864
  s_cmp_lg_u32 s5, 0
  s_cbranch_scc1 LS1ac_noz
  ds_read_b128 v[136:139], v12 offset:40960
  ds_read_b128 v[140:143], v12 offset:41216
  ds_read_b128 v[144:147], v12 offset:41472
  ds_read_b128 v[148:151], v12 offset:41728
  s_waitcnt lgkmcnt(0)
  v_pk_add_f32 v[136:137], v[136:137], v[144:145]
  v_pk_add_f32 v[138:139], v[138:139], v[146:147]
  v_pk_add_f32 v[140:141], v[140:141], v[148:149]
  v_pk_add_f32 v[142:143], v[142:143], v[150:151]
  v_pk_add_f32 v[136:137], v[136:137], v[140:141]
  v_pk_add_f32 v[138:139], v[138:139], v[142:143]
  s_mov_b64 exec, 0xffff
  buffer_store_dwordx4 v[136:139], v12, s[56:59], s13 offen offset:2048 sc1
  s_mov_b64 exec, -1
LS1ac_noz:
  s_waitcnt lgkmcnt(0)
  v_pk_add_f32 v[120:121], v[120:121], v[128:129]
  v_pk_add_f32 v[122:123], v[122:123], v[130:131]
  v_pk_add_f32 v[124:125], v[124:125], v[132:133]
  v_pk_add_f32 v[126:127], v[126:127], v[134:135]
  v_pk_add_f32 v[120:121], v[120:121], v[124:125]
  v_pk_add_f32 v[122:123], v[122:123], v[126:127]
  v_cvt_pk_bf16_f32 v120, v120, v121
  v_cvt_pk_bf16_f32 v121, v122, v123
  buffer_store_dwordx2 v[120:121], v21, s[56:59], s13 offen sc1
  v_pk_fma_f32 v[32:33], v[184:185], v[16:17], v[32:33] op_sel_hi:[1,0,1]
  v_pk_fma_f32 v[56:57], v[184:185], v[18:19], v[56:57] op_sel_hi:[1,0,1]
  v_pk_fma_f32 v[34:35], v[186:187], v[16:17], v[34:35] op_sel_hi:[1,0,1]
  v_pk_fma_f32 v[58:59], v[186:187], v[18:19], v[58:59] op_sel_hi:[1,0,1]
  v_pk_mul_f32 v[32:33], v[32:33], v[16:17] op_sel:[0,1] op_sel_hi:[1,1]
  v_pk_mul_f32 v[56:57], v[56:57], v[18:19] op_sel:[0,1] op_sel_hi:[1,1]
  v_pk_mul_f32 v[34:35], v[34:35], v[16:17] op_sel:[0,1] op_sel_hi:[1,1]
  v_pk_mul_f32 v[58:59], v[58:59], v[18:19] op_sel:[0,1] op_sel_hi:[1,1]
  v_pk_fma_f32 v[36:37], v[188:189], v[16:17], v[36:37] op_sel_hi:[1,0,1]
  v_pk_fma_f32 v[60:61], v[188:189], v[18:19], v[60:61] op_sel_hi:[1,0,1]
  v_pk_fma_f32 v[38:39], v[190:191], v[16:17], v[38:39] op_sel_hi:[1,0,1]
  v_pk_fma_f32 v[62:63], v[190:191], v[18:19], v[62:63] op_sel_hi:[1,0,1]
  v_pk_mul_f32 v[36:37], v[36:37], v[16:17] op_sel:[0,1] op_sel_hi:[1,1]
  v_pk_mul_f32 v[60:61], v[60:61], v[18:19] op_sel:[0,1] op_sel_hi:[1,1]
  v_pk_mul_f32 v[38:39], v[38:39], v[16:17] op_sel:[0,1] op_sel_hi:[1,1]
  v_pk_mul_f32 v[62:63], v[62:63], v[18:19] op_sel:[0,1] op_sel_hi:[1,1]
  v_cvt_pk_bf16_f32 v212, v32, v33
  v_cvt_pk_bf16_f32 v152, v56, v57
  v_cvt_pk_bf16_f32 v213, v34, v35
  v_cvt_pk_bf16_f32 v153, v58, v59
  v_cvt_pk_bf16_f32 v214, v36, v37
  v_cvt_pk_bf16_f32 v154, v60, v61
  v_cvt_pk_bf16_f32 v215, v38, v39
  v_cvt_pk_bf16_f32 v155, v62, v63
  v_mfma_f32_16x16x16_bf16 v[216:219], v[28:29], v[212:213], 0
  v_mfma_f32_16x16x16_bf16 v[156:159], v[28:29], v[152:153], 0
  v_mfma_f32_16x16x16_bf16 v[220:223], v[30:31], v[214:215], 0
  v_mfma_f32_16x16x16_bf16 v[160:163], v[30:31], v[154:155], 0
  s_nop 4
  v_cvt_pk_bf16_f32 v212, v216, v217
  v_cvt_pk_bf16_f32 v152, v156, v157
  v_cvt_pk_bf16_f32 v213, v218, v219
  v_cvt_pk_bf16_f32 v153, v158, v159
  v_lshlrev_b32 v216, 16, v212
  v_lshlrev_b32 v156, 16, v152
  v_and_b32 v217, 0xffff0000, v212
  v_and_b32 v157, 0xffff0000, v152
  v_lshlrev_b32 v218, 16, v213
  v_lshlrev_b32 v158, 16, v153
  v_and_b32 v219, 0xffff0000, v213
  v_and_b32 v159, 0xffff0000, v153
  v_cvt_pk_bf16_f32 v214, v220, v221
  v_cvt_pk_bf16_f32 v154, v160, v161
  v_cvt_pk_bf16_f32 v215, v222, v223
  v_cvt_pk_bf16_f32 v155, v162, v163
  v_lshlrev_b32 v220, 16, v214
  v_lshlrev_b32 v160, 16, v154
  v_and_b32 v221, 0xffff0000, v214
  v_and_b32 v161, 0xffff0000, v154
  v_lshlrev_b32 v222, 16, v215
  v_lshlrev_b32 v162, 16, v155
  v_and_b32 v223, 0xffff0000, v215
  v_and_b32 v163, 0xffff0000, v155
  v_max3_f32 v232, v216, v217, v218
  v_max3_f32 v172, v156, v157, v158
  v_max3_f32 v234, -v216, -v217, -v218
  v_max3_f32 v174, -v156, -v157, -v158
  v_max_f32 v232, v232, v219
  v_max_f32 v172, v172, v159
  v_max_f32_e64 v234, v234, -v219
  v_max_f32_e64 v174, v174, -v159
  v_max3_f32 v236, v220, v221, v222
  v_max3_f32 v176, v160, v161, v162
  v_max3_f32 v238, -v220, -v221, -v222
  v_max3_f32 v178, -v160, -v161, -v162
  v_max_f32 v236, v236, v223
  v_max_f32 v176, v176, v163
  v_max_f32_e64 v238, v238, -v223
  v_max_f32_e64 v178, v178, -v163
  v_permlane16_swap_b32 v232, v234
  v_permlane16_swap_b32 v172, v174
  v_permlane16_swap_b32 v236, v238
  v_permlane16_swap_b32 v176, v178
  v_max_f32 v232, v232, v234
  v_max_f32 v172, v172, v174
  v_max_f32 v236, v236, v238
  v_max_f32 v176, v176, v178
  s_nop 0
  v_permlane32_swap_b32 v232, v236
  v_permlane32_swap_b32 v172, v176
  v_max_f32 v232, v232, v236
  v_max_f32 v172, v172, v176
  v_mul_f32 v232, 0xbfb8aa3b, v232
  v_mul_f32 v172, 0xbfb8aa3b, v172
  v_mov_b32 v236, v232
  v_mov_b32 v176, v172
  s_nop 0
  v_permlane32_swap_b32 v232, v236
  v_permlane32_swap_b32 v172, v176
  v_mov_b32 v234, v232
  v_mov_b32 v174, v172
  v_mov_b32 v238, v236
  v_mov_b32 v178, v176
  v_permlane16_swap_b32 v232, v234
  v_permlane16_swap_b32 v172, v174
  v_permlane16_swap_b32 v236, v238
  v_permlane16_swap_b32 v176, v178
  v_pk_fma_f32 v[224:225], v[216:217], v[202:203], v[234:235] op_sel_hi:[1,1,0] neg_lo:[0,1,0] neg_hi:[0,1,0]
  v_pk_fma_f32 v[164:165], v[156:157], v[202:203], v[174:175] op_sel_hi:[1,1,0] neg_lo:[0,1,0] neg_hi:[0,1,0]
  v_pk_fma_f32 v[226:227], v[218:219], v[202:203], v[234:235] op_sel_hi:[1,1,0] neg_lo:[0,1,0] neg_hi:[0,1,0]
  v_pk_fma_f32 v[166:167], v[158:159], v[202:203], v[174:175] op_sel_hi:[1,1,0] neg_lo:[0,1,0] neg_hi:[0,1,0]
  v_pk_fma_f32 v[216:217], v[216:217], v[202:203], v[232:233] op_sel_hi:[1,1,0]
  v_pk_fma_f32 v[156:157], v[156:157], v[202:203], v[172:173] op_sel_hi:[1,1,0]
  v_pk_fma_f32 v[218:219], v[218:219], v[202:203], v[232:233] op_sel_hi:[1,1,0]
  v_pk_fma_f32 v[158:159], v[158:159], v[202:203], v[172:173] op_sel_hi:[1,1,0]
  v_pk_fma_f32 v[228:229], v[220:221], v[202:203], v[238:239] op_sel_hi:[1,1,0] neg_lo:[0,1,0] neg_hi:[0,1,0]
  v_pk_fma_f32 v[168:169], v[160:161], v[202:203], v[178:179] op_sel_hi:[1,1,0] neg_lo:[0,1,0] neg_hi:[0,1,0]
  v_pk_fma_f32 v[230:231], v[222:223], v[202:203], v[238:239] op_sel_hi:[1,1,0] neg_lo:[0,1,0] neg_hi:[0,1,0]
  v_pk_fma_f32 v[170:171], v[162:163], v[202:203], v[178:179] op_sel_hi:[1,1,0] neg_lo:[0,1,0] neg_hi:[0,1,0]
  v_pk_fma_f32 v[220:221], v[220:221], v[202:203], v[236:237] op_sel_hi:[1,1,0]
  v_pk_fma_f32 v[160:161], v[160:161], v[202:203], v[176:177] op_sel_hi:[1,1,0]
  v_pk_fma_f32 v[222:223], v[222:223], v[202:203], v[236:237] op_sel_hi:[1,1,0]
  v_pk_fma_f32 v[162:163], v[162:163], v[202:203], v[176:177] op_sel_hi:[1,1,0]
  v_exp_f32 v216, v216
  v_exp_f32 v156, v156
  v_exp_f32 v217, v217
  v_exp_f32 v157, v157
  v_exp_f32 v218, v218
  v_exp_f32 v158, v158
  v_exp_f32 v219, v219
  v_exp_f32 v159, v159
  v_exp_f32 v224, v224
  v_exp_f32 v164, v164
  v_exp_f32 v225, v225
  v_exp_f32 v165, v165
  v_exp_f32 v226, v226
  v_exp_f32 v166, v166
  v_exp_f32 v227, v227
  v_exp_f32 v167, v167
  v_exp_f32 v220, v220
  v_exp_f32 v160, v160
  v_exp_f32 v221, v221
  v_exp_f32 v161, v161
  v_exp_f32 v222, v222
  v_exp_f32 v162, v162
  v_exp_f32 v223, v223
  v_exp_f32 v163, v163
  v_exp_f32 v228, v228
  v_exp_f32 v168, v168
  v_exp_f32 v229, v229
  v_exp_f32 v169, v169
  v_exp_f32 v230, v230
  v_exp_f32 v170, v170
  v_exp_f32 v231, v231
  v_exp_f32 v171, v171
  v_pk_add_f32 v[232:233], v[216:217], v[218:219]
  v_pk_add_f32 v[172:173], v[156:157], v[158:159]
  v_pk_add_f32 v[234:235], v[224:225], v[226:227]
  v_pk_add_f32 v[174:175], v[164:165], v[166:167]
  v_pk_add_f32 v[236:237], v[220:221], v[222:223]
  v_pk_add_f32 v[176:177], v[160:161], v[162:163]
  v_pk_add_f32 v[238:239], v[228:229], v[230:231]
  v_pk_add_f32 v[178:179], v[168:169], v[170:171]
  v_add_f32 v232, v232, v233
  v_add_f32 v172, v172, v173
  v_add_f32 v234, v234, v235
  v_add_f32 v174, v174, v175
  v_add_f32 v236, v236, v237
  v_add_f32 v176, v176, v177
  v_add_f32 v238, v238, v239
  v_add_f32 v178, v178, v179
  v_permlane16_swap_b32 v232, v234
  v_permlane16_swap_b32 v172, v174
  v_permlane16_swap_b32 v236, v238
  v_permlane16_swap_b32 v176, v178
  v_add_f32 v232, v232, v234
  v_add_f32 v172, v172, v174
  v_add_f32 v236, v236, v238
  v_add_f32 v176, v176, v178
  s_nop 0
  v_permlane32_swap_b32 v232, v236
  v_permlane32_swap_b32 v172, v176
  v_add_f32 v232, v232, v236
  v_add_f32 v172, v172, v176
  v_rcp_f32 v232, v232
  v_rcp_f32 v172, v172
  v_mov_b32 v236, v232
  v_mov_b32 v176, v172
  s_nop 0
  v_permlane32_swap_b32 v232, v236
  v_permlane32_swap_b32 v172, v176
  v_mov_b32 v234, v232
  v_mov_b32 v174, v172
  v_mov_b32 v238, v236
  v_mov_b32 v178, v176
  v_permlane16_swap_b32 v232, v234
  v_permlane16_swap_b32 v172, v174
  v_permlane16_swap_b32 v236, v238
  v_permlane16_swap_b32 v176, v178
  v_pk_mul_f32 v[216:217], v[216:217], v[232:233] op_sel_hi:[1,0]
  v_pk_mul_f32 v[156:157], v[156:157], v[172:173] op_sel_hi:[1,0]
  v_pk_mul_f32 v[218:219], v[218:219], v[232:233] op_sel_hi:[1,0]
  v_pk_mul_f32 v[158:159], v[158:159], v[172:173] op_sel_hi:[1,0]
  v_pk_mul_f32 v[224:225], v[224:225], v[234:235] op_sel_hi:[1,0]
  v_pk_mul_f32 v[164:165], v[164:165], v[174:175] op_sel_hi:[1,0]
  v_pk_mul_f32 v[226:227], v[226:227], v[234:235] op_sel_hi:[1,0]
  v_pk_mul_f32 v[166:167], v[166:167], v[174:175] op_sel_hi:[1,0]
  v_pk_mul_f32 v[220:221], v[220:221], v[236:237] op_sel_hi:[1,0]
  v_pk_mul_f32 v[160:161], v[160:161], v[176:177] op_sel_hi:[1,0]
  v_pk_mul_f32 v[222:223], v[222:223], v[236:237] op_sel_hi:[1,0]
  v_pk_mul_f32 v[162:163], v[162:163], v[176:177] op_sel_hi:[1,0]
  v_pk_mul_f32 v[228:229], v[228:229], v[238:239] op_sel_hi:[1,0]
  v_pk_mul_f32 v[168:169], v[168:169], v[178:179] op_sel_hi:[1,0]
  v_pk_mul_f32 v[230:231], v[230:231], v[238:239] op_sel_hi:[1,0]
  v_pk_mul_f32 v[170:171], v[170:171], v[178:179] op_sel_hi:[1,0]
  v_cvt_pk_bf16_f32 v32, v216, v217
  v_cvt_pk_bf16_f32 v56, v156, v157
  v_cvt_pk_bf16_f32 v33, v218, v219
  v_cvt_pk_bf16_f32 v57, v158, v159
  v_cvt_pk_bf16_f32 v34, v224, v225
  v_cvt_pk_bf16_f32 v58, v164, v165
  v_cvt_pk_bf16_f32 v35, v226, v227
  v_cvt_pk_bf16_f32 v59, v166, v167
  v_cvt_pk_bf16_f32 v36, v220, v221
  v_cvt_pk_bf16_f32 v60, v160, v161
  v_cvt_pk_bf16_f32 v37, v222, v223
  v_cvt_pk_bf16_f32 v61, v162, v163
  v_cvt_pk_bf16_f32 v38, v228, v229
  v_cvt_pk_bf16_f32 v62, v168, v169
  v_cvt_pk_bf16_f32 v39, v230, v231
  v_cvt_pk_bf16_f32 v63, v170, v171
  s_and_b32 s1, s2, 7
  s_lshl_b32 s1, s1, 5
  s_and_b32 s6, s3, 1
  s_lshl_b32 s6, s6, 3
  s_add_u32 s1, s1, s6
  s_lshl_b32 s6, s5, 1
  s_add_u32 s1, s1, s6
  s_lshl_b32 s1, s1, 7
  s_lshl_b32 s6, s4, 2
  s_add_u32 s1, s1, s6
  s_add_u32 s1, s1, 21626880
  s_add_u32 s6, s25, 1
  v_mov_b32 v236, s6
  v_lshlrev_b32 v237, 7, v1
  s_waitcnt vmcnt(0)
  v_mov_b32 v248, 161792
  v_mov_b32 v249, 1
  v_mov_b32 v250, 1
  s_mov_b64 exec, 1
  ds_add_rtn_u32 v249, v248, v249 offset:8
  s_and_b32 s6, s100, 7
  s_lshl_b32 s6, s6, 12
  s_lshr_b32 s7, s100, 3
  s_lshl_b32 s7, s7, 2
  s_add_u32 s7, s7, s6
  s_add_u32 s7, s7, 21626880
  v_mov_b32 v248, s7
  s_waitcnt lgkmcnt(0)
  v_readfirstlane_b32 s6, v249
  s_cmp_lg_u32 s6, 7
  s_cbranch_scc1 LS1ac_arr_no
  buffer_store_dword v250, v248, s[56:59], 0 offen offset:2560 sc1
LS1ac_arr_no:
  s_mov_b64 exec, -1
  s_and_b32 s6, s2, 7
  s_lshl_b32 s6, s6, 4
  s_lshr_b32 s7, s2, 4
  s_add_u32 s6, s6, s7
  s_and_b32 s7, s2, 8
  s_add_u32 s7, s7, s101
  s_mul_i32 s6, s6, 62464
  s_mul_i32 s7, s7, 1024
  s_add_u32 s6, s6, s7
  s_add_u32 s6, s6, 50331648
  s_add_u32 s94, s38, s6
  s_addc_u32 s95, s39, 0
  s_load_dword s93, s[94:95], 0
  s_load_dword s93, s[94:95], 64
  s_load_dword s93, s[94:95], 128
  s_load_dword s93, s[94:95], 192
  s_load_dword s93, s[94:95], 256
  s_load_dword s93, s[94:95], 320
  s_load_dword s93, s[94:95], 384
  s_load_dword s93, s[94:95], 448
  s_load_dword s93, s[94:95], 512
  s_load_dword s93, s[94:95], 576
  s_load_dword s93, s[94:95], 640
  s_load_dword s93, s[94:95], 704
  s_load_dword s93, s[94:95], 768
  s_load_dword s93, s[94:95], 832
  s_load_dword s93, s[94:95], 896
  s_load_dword s93, s[94:95], 960
LS1ac_st1:
  s_barrier
  ds_read_b128 v[152:155], v13 offset:41984
  ds_read_b128 v[156:159], v14 offset:44032
  ds_read_b128 v[160:163], v13 offset:43008
  ds_read_b128 v[164:167], v14 offset:44096
  s_waitcnt lgkmcnt(2)
  v_mfma_f32_16x16x32_bf16 v[172:175], v[156:159], v[32:35], 0
  v_mfma_f32_16x16x32_bf16 v[168:171], v[152:155], v[32:35], 0
  v_mfma_f32_16x16x32_bf16 v[188:191], v[156:159], v[56:59], 0
  v_mfma_f32_16x16x32_bf16 v[184:187], v[152:155], v[56:59], 0
  s_waitcnt lgkmcnt(0)
  v_mfma_f32_16x16x32_bf16 v[180:183], v[164:167], v[36:39], 0
  v_mfma_f32_16x16x32_bf16 v[176:179], v[160:163], v[36:39], 0
  v_mfma_f32_16x16x32_bf16 v[196:199], v[164:167], v[60:63], 0
  v_mfma_f32_16x16x32_bf16 v[192:195], v[160:163], v[60:63], 0
  v_cvt_pk_bf16_f32 v96, v172, v172
  s_nop 0
  v_cvt_pk_bf16_f32 v100, v188, v188
  s_nop 1
  v_cvt_pk_bf16_f32 v98, v180, v180
  s_nop 0
  v_cvt_pk_bf16_f32 v102, v196, v196
  v_lshlrev_b32 v172, 16, v96
  v_lshlrev_b32 v188, 16, v100
  v_lshlrev_b32 v180, 16, v98
  v_lshlrev_b32 v196, 16, v102
  v_add_f32 v172, 0x358637bd, v172
  v_add_f32 v188, 0x358637bd, v188
  v_add_f32 v180, 0x358637bd, v180
  v_add_f32 v196, 0x358637bd, v196
  v_cvt_pk_bf16_f32 v96, v172, v172
  v_cvt_pk_bf16_f32 v100, v188, v188
  v_cvt_pk_bf16_f32 v98, v180, v180
  v_cvt_pk_bf16_f32 v102, v196, v196
  v_lshlrev_b32 v172, 16, v96
  v_lshlrev_b32 v188, 16, v100
  v_lshlrev_b32 v180, 16, v98
  v_lshlrev_b32 v196, 16, v102
  v_rcp_f32 v172, v172
  v_rcp_f32 v188, v188
  v_rcp_f32 v180, v180
  v_rcp_f32 v196, v196
  v_cvt_pk_bf16_f32 v96, v168, v169
  v_cvt_pk_bf16_f32 v100, v184, v185
  v_cvt_pk_bf16_f32 v98, v176, v177
  v_cvt_pk_bf16_f32 v102, v192, v193
  v_cvt_pk_bf16_f32 v97, v170, v171
  v_cvt_pk_bf16_f32 v101, v186, v187
  v_cvt_pk_bf16_f32 v99, v178, v179
  v_cvt_pk_bf16_f32 v103, v194, v195
  v_lshlrev_b32 v168, 16, v96
  v_lshlrev_b32 v184, 16, v100
  v_lshlrev_b32 v176, 16, v98
  v_lshlrev_b32 v192, 16, v102
  v_and_b32 v169, 0xffff0000, v96
  v_and_b32 v185, 0xffff0000, v100
  v_and_b32 v177, 0xffff0000, v98
  v_and_b32 v193, 0xffff0000, v102
  v_lshlrev_b32 v170, 16, v97
  v_lshlrev_b32 v186, 16, v101
  v_lshlrev_b32 v178, 16, v99
  v_lshlrev_b32 v194, 16, v103
  v_and_b32 v171, 0xffff0000, v97
  v_and_b32 v187, 0xffff0000, v101
  v_and_b32 v179, 0xffff0000, v99
  v_and_b32 v195, 0xffff0000, v103
  v_pk_mul_f32 v[168:169], v[168:169], v[172:173] op_sel_hi:[1,0]
  v_pk_mul_f32 v[184:185], v[184:185], v[188:189] op_sel_hi:[1,0]
  v_pk_mul_f32 v[176:177], v[176:177], v[180:181] op_sel_hi:[1,0]
  v_pk_mul_f32 v[192:193], v[192:193], v[196:197] op_sel_hi:[1,0]
  v_pk_mul_f32 v[170:171], v[170:171], v[172:173] op_sel_hi:[1,0]
  v_pk_mul_f32 v[186:187], v[186:187], v[188:189] op_sel_hi:[1,0]
  v_pk_mul_f32 v[178:179], v[178:179], v[180:181] op_sel_hi:[1,0]
  v_pk_mul_f32 v[194:195], v[194:195], v[196:197] op_sel_hi:[1,0]
  v_cvt_pk_bf16_f32 v104, v168, v169
  v_cvt_pk_bf16_f32 v108, v184, v185
  v_cvt_pk_bf16_f32 v106, v176, v177
  v_cvt_pk_bf16_f32 v110, v192, v193
  v_cvt_pk_bf16_f32 v105, v170, v171
  v_cvt_pk_bf16_f32 v109, v186, v187
  v_cvt_pk_bf16_f32 v107, v178, v179
  v_cvt_pk_bf16_f32 v111, v194, v195
  v_permlane16_swap_b32 v104, v106
  v_permlane16_swap_b32 v105, v107
  v_permlane16_swap_b32 v108, v110
  v_permlane16_swap_b32 v109, v111
  buffer_store_dwordx4 v[104:107], v20, s[56:59], s9 offen
  buffer_store_dwordx4 v[108:111], v20, s[56:59], s12 offen
LS1ac_fin:
LS1ac_skip:
  s_mov_b32 s2, s100
  s_cmp_ge_u32 s2, 256
  s_cbranch_scc1 LX_end
LXc_loop:
  s_and_b32 s6, s2, 7
  s_lshr_b32 s7, s2, 3
  s_lshl_b32 s6, s6, 2
  s_and_b32 s8, s7, 3
  s_add_u32 s3, s6, s8
  s_lshr_b32 s4, s7, 2
  s_lshl_b32 s8, s3, 2
  s_add_u32 s8, s8, s5
  s_mul_i32 s9, s8, 62464
  s_mul_i32 s6, s24, -44032
  s_add_u32 s9, s9, s6
  s_add_u32 s9, s9, 50375680
  s_lshl_b32 s6, s4, 11
  s_add_u32 s9, s9, s6
  v_and_b32 v24, 1, v3
  v_lshlrev_b32 v8, 4, v2
  v_lshl_add_u32 v8, v24, 9, v8
  v_lshrrev_b32 v24, 1, v3
  v_lshl_add_u32 v8, v24, 8, v8
  s_mul_i32 s10, s8, 62464
  s_mul_i32 s6, s24, -1024
  s_add_u32 s10, s10, s6
  s_add_u32 s10, s10, 50393088
  s_lshl_b32 s6, s4, 3
  s_add_u32 s10, s10, s6
  v_lshlrev_b32 v9, 6, v2
  v_lshl_add_u32 v9, v3, 2, v9
  v_mov_b32 v10, 0x3f803f80
  s_and_b32 s6, s2, 7
  s_lshl_b32 s6, s6, 5
  s_and_b32 s7, s3, 3
  s_lshl_b32 s7, s7, 2
  s_add_u32 s6, s6, s7
  s_add_u32 s6, s6, s5
  s_add_u32 s6, s6, 1
  s_lshl_b32 s6, s6, 7
  v_min_u32 v230, 15, v1
  v_lshlrev_b32 v230, 2, v230
  v_add_u32 v230, s6, v230
  v_add_u32 v230, 21626880, v230
  s_lshl_b32 s7, s5, 2
  s_add_u32 s7, s7, 161808
  v_mov_b32 v233, s7
  v_lshrrev_b32 v24, 2, v2
  v_and_b32 v25, 3, v2
  v_lshl_add_u32 v26, v3, 3, v24
  v_and_b32 v27, 2, v24
  v_and_b32 v28, 1, v3
  v_lshl_or_b32 v27, v28, 2, v27
  v_lshlrev_b32 v26, 7, v26
  v_and_b32 v28, 1, v25
  v_lshl_add_u32 v26, v28, 3, v26
  v_lshrrev_b32 v25, 1, v25
  v_or_b32 v28, 0, v25
  v_xor_b32 v28, v28, v27
  v_lshl_add_u32 v12, v28, 4, v26
  v_or_b32 v28, 2, v25
  v_xor_b32 v28, v28, v27
  v_lshl_add_u32 v13, v28, 4, v26
  v_or_b32 v28, 4, v25
  v_xor_b32 v28, v28, v27
  v_lshl_add_u32 v14, v28, 4, v26
  v_or_b32 v28, 6, v25
  v_xor_b32 v28, v28, v27
  v_lshl_add_u32 v15, v28, 4, v26
  v_lshlrev_b32 v4, 4, v1
  s_mul_i32 s11, s8, 62464
  s_mul_i32 s6, s24, 44032
  s_add_u32 s11, s11, s6
  s_add_u32 s11, s11, 50331648
  s_waitcnt vmcnt(0)
  s_mov_b64 exec, 3
  buffer_store_dword v236, v237, s[56:59], s1 offen offset:128
  s_mov_b64 exec, -1
  buffer_load_dword v231, v230, s[56:59], 0 offen sc1
  s_and_b32 s1, s2, 7
  s_lshl_b32 s1, s1, 5
  s_and_b32 s6, s3, 3
  s_lshl_b32 s6, s6, 2
  s_add_u32 s1, s1, s6
  s_add_u32 s1, s1, s5
  s_lshl_b32 s1, s1, 7
  s_lshl_b32 s6, s4, 2
  s_add_u32 s1, s1, s6
  s_add_u32 s1, s1, 21626880
  s_add_u32 s6, s25, 2
  v_mov_b32 v236, s6
  v_lshlrev_b32 v237, 7, v1
  v_mov_b32 v234, 161824
  s_add_u32 s7, s15, 2
LS2c_pw7:
  ds_read_b128 v[226:229], v234
  s_waitcnt lgkmcnt(0)
  v_min_u32 v226, v226, v227
  v_min3_u32 v226, v226, v228, v229
  s_nop 0
  v_readfirstlane_b32 s6, v226
  s_cmp_ge_u32 s6, s7
  s_cbranch_scc1 LS2c_pw7_ok
  s_sleep 1
  s_sub_u32 s0, s0, 1
  s_cbranch_scc0 LS2c_pw7
  s_mov_b32 s0, 0
LS2c_pw7_ok:
  ds_read_b64_tr_b16 v[48:49], v12 offset:0
  ds_read_b64_tr_b16 v[50:51], v12 offset:512
  ds_read_b64_tr_b16 v[52:53], v13 offset:0
  ds_read_b64_tr_b16 v[54:55], v13 offset:512
  ds_read_b64_tr_b16 v[56:57], v14 offset:0
  ds_read_b64_tr_b16 v[58:59], v14 offset:512
  ds_read_b64_tr_b16 v[60:61], v15 offset:0
  ds_read_b64_tr_b16 v[62:63], v15 offset:512
  ds_read_b64_tr_b16 v[64:65], v12 offset:4096
  ds_read_b64_tr_b16 v[66:67], v12 offset:4608
  ds_read_b64_tr_b16 v[68:69], v13 offset:4096
  ds_read_b64_tr_b16 v[70:71], v13 offset:4608
  ds_read_b64_tr_b16 v[72:73], v14 offset:4096
  ds_read_b64_tr_b16 v[74:75], v14 offset:4608
  ds_read_b64_tr_b16 v[76:77], v15 offset:4096
  ds_read_b64_tr_b16 v[78:79], v15 offset:4608
  s_add_u32 s6, s25, 1
LS2c_poll8:
  s_waitcnt vmcnt(0)
  v_cmp_gt_u32 vcc, s6, v231
  s_cmp_eq_u64 vcc, 0
  s_cbranch_scc1 LS2c_poll8_ok
  buffer_load_dword v231, v230, s[56:59], 0 offen sc1
  s_sub_u32 s0, s0, 1
  s_cbranch_scc0 LS2c_poll8
  s_mov_b32 s0, 0
  s_waitcnt vmcnt(0)
LS2c_poll8_ok:
  buffer_load_dwordx4 v[96:99], v4, s[56:59], s11 offen offset:0 sc1
  buffer_load_dwordx4 v[100:103], v4, s[56:59], s11 offen offset:1024 sc1
  buffer_load_dwordx4 v[104:107], v4, s[56:59], s11 offen offset:2048 sc1
  buffer_load_dwordx4 v[108:111], v4, s[56:59], s11 offen offset:3072 sc1
  s_add_u32 s7, s11, 4096
  buffer_load_dwordx4 v[112:115], v4, s[56:59], s7 offen offset:0 sc1
  s_add_u32 s7, s11, 4096
  buffer_load_dwordx4 v[116:119], v4, s[56:59], s7 offen offset:1024 sc1
  s_add_u32 s7, s11, 4096
  buffer_load_dwordx4 v[120:123], v4, s[56:59], s7 offen offset:2048 sc1
  s_add_u32 s7, s11, 4096
  buffer_load_dwordx4 v[124:127], v4, s[56:59], s7 offen offset:3072 sc1
  s_add_u32 s7, s11, 8192
  buffer_load_dwordx4 v[128:131], v4, s[56:59], s7 offen offset:0 sc1
  s_add_u32 s7, s11, 8192
  buffer_load_dwordx4 v[132:135], v4, s[56:59], s7 offen offset:1024 sc1
  s_add_u32 s7, s11, 8192
  buffer_load_dwordx4 v[136:139], v4, s[56:59], s7 offen offset:2048 sc1
  s_add_u32 s7, s11, 8192
  buffer_load_dwordx4 v[140:143], v4, s[56:59], s7 offen offset:3072 sc1
  s_add_u32 s7, s11, 12288
  buffer_load_dwordx4 v[144:147], v4, s[56:59], s7 offen offset:0 sc1
  s_add_u32 s7, s11, 12288
  buffer_load_dwordx4 v[148:151], v4, s[56:59], s7 offen offset:1024 sc1
  s_add_u32 s7, s11, 12288
  buffer_load_dwordx4 v[152:155], v4, s[56:59], s7 offen offset:2048 sc1
  s_add_u32 s7, s11, 12288
  buffer_load_dwordx4 v[156:159], v4, s[56:59], s7 offen offset:3072 sc1
  s_add_u32 s6, s15, 4
  s_mov_b64 exec, 1
  v_mov_b32 v232, s6
  ds_write_b32 v233, v232
  s_mov_b64 exec, -1
  s_waitcnt vmcnt(15)
  s_waitcnt lgkmcnt(12)
  v_mfma_f32_16x16x32_bf16 v[32:35], v[48:51], v[96:99], 0
  ds_read_b64_tr_b16 v[80:81], v12 offset:8192
  ds_read_b64_tr_b16 v[82:83], v12 offset:8704
  v_mfma_f32_16x16x32_bf16 v[36:39], v[52:55], v[96:99], 0
  ds_read_b64_tr_b16 v[84:85], v13 offset:8192
  ds_read_b64_tr_b16 v[86:87], v13 offset:8704
  s_waitcnt lgkmcnt(12)
  v_mfma_f32_16x16x32_bf16 v[40:43], v[56:59], v[96:99], 0
  ds_read_b64_tr_b16 v[88:89], v14 offset:8192
  ds_read_b64_tr_b16 v[90:91], v14 offset:8704
  v_mfma_f32_16x16x32_bf16 v[44:47], v[60:63], v[96:99], 0
  ds_read_b64_tr_b16 v[92:93], v15 offset:8192
  ds_read_b64_tr_b16 v[94:95], v15 offset:8704
  s_waitcnt vmcnt(14)
  s_waitcnt lgkmcnt(12)
  v_mfma_f32_16x16x32_bf16 v[32:35], v[64:67], v[100:103], v[32:35]
  ds_read_b64_tr_b16 v[48:49], v12 offset:12288
  ds_read_b64_tr_b16 v[50:51], v12 offset:12800
  v_mfma_f32_16x16x32_bf16 v[36:39], v[68:71], v[100:103], v[36:39]
  ds_read_b64_tr_b16 v[52:53], v13 offset:12288
  ds_read_b64_tr_b16 v[54:55], v13 offset:12800
  s_waitcnt lgkmcnt(12)
  v_mfma_f32_16x16x32_bf16 v[40:43], v[72:75], v[100:103], v[40:43]
  ds_read_b64_tr_b16 v[56:57], v14 offset:12288
  ds_read_b64_tr_b16 v[58:59], v14 offset:12800
  v_mfma_f32_16x16x32_bf16 v[44:47], v[76:79], v[100:103], v[44:47]
  ds_read_b64_tr_b16 v[60:61], v15 offset:12288
  ds_read_b64_tr_b16 v[62:63], v15 offset:12800
  s_waitcnt vmcnt(13)
  s_waitcnt lgkmcnt(12)
  v_mfma_f32_16x16x32_bf16 v[32:35], v[80:83], v[104:107], v[32:35]
  v_add_u32 v12, 94208, v12
  v_add_u32 v13, 94208, v13
  v_add_u32 v14, 94208, v14
  v_add_u32 v15, 94208, v15
  ds_read_b64_tr_b16 v[64:65], v12 offset:20480
  ds_read_b64_tr_b16 v[66:67], v12 offset:20992
  v_mfma_f32_16x16x32_bf16 v[36:39], v[84:87], v[104:107], v[36:39]
  ds_read_b64_tr_b16 v[68:69], v13 offset:20480
  ds_read_b64_tr_b16 v[70:71], v13 offset:20992
  s_waitcnt lgkmcnt(12)
  v_mfma_f32_16x16x32_bf16 v[40:43], v[88:91], v[104:107], v[40:43]
  ds_read_b64_tr_b16 v[72:73], v14 offset:20480
  ds_read_b64_tr_b16 v[74:75], v14 offset:20992
  v_mfma_f32_16x16x32_bf16 v[44:47], v[92:95], v[104:107], v[44:47]
  ds_read_b64_tr_b16 v[76:77], v15 offset:20480
  ds_read_b64_tr_b16 v[78:79], v15 offset:20992
  s_waitcnt vmcnt(12)
  s_waitcnt lgkmcnt(12)
  v_mfma_f32_16x16x32_bf16 v[32:35], v[48:51], v[108:111], v[32:35]
  ds_read_b64_tr_b16 v[80:81], v12 offset:24576
  ds_read_b64_tr_b16 v[82:83], v12 offset:25088
  v_mfma_f32_16x16x32_bf16 v[36:39], v[52:55], v[108:111], v[36:39]
  ds_read_b64_tr_b16 v[84:85], v13 offset:24576
  ds_read_b64_tr_b16 v[86:87], v13 offset:25088
  s_waitcnt lgkmcnt(12)
  v_mfma_f32_16x16x32_bf16 v[40:43], v[56:59], v[108:111], v[40:43]
  ds_read_b64_tr_b16 v[88:89], v14 offset:24576
  ds_read_b64_tr_b16 v[90:91], v14 offset:25088
  v_mfma_f32_16x16x32_bf16 v[44:47], v[60:63], v[108:111], v[44:47]
  ds_read_b64_tr_b16 v[92:93], v15 offset:24576
  ds_read_b64_tr_b16 v[94:95], v15 offset:25088
  s_waitcnt vmcnt(11)
  s_waitcnt lgkmcnt(12)
  v_mfma_f32_16x16x32_bf16 v[32:35], v[64:67], v[112:115], v[32:35]
  ds_read_b64_tr_b16 v[48:49], v12 offset:28672
  ds_read_b64_tr_b16 v[50:51], v12 offset:29184
  v_mfma_f32_16x16x32_bf16 v[36:39], v[68:71], v[112:115], v[36:39]
  ds_read_b64_tr_b16 v[52:53], v13 offset:28672
  ds_read_b64_tr_b16 v[54:55], v13 offset:29184
  s_waitcnt lgkmcnt(12)
  v_mfma_f32_16x16x32_bf16 v[40:43], v[72:75], v[112:115], v[40:43]
  ds_read_b64_tr_b16 v[56:57], v14 offset:28672
  ds_read_b64_tr_b16 v[58:59], v14 offset:29184
  v_mfma_f32_16x16x32_bf16 v[44:47], v[76:79], v[112:115], v[44:47]
  ds_read_b64_tr_b16 v[60:61], v15 offset:28672
  ds_read_b64_tr_b16 v[62:63], v15 offset:29184
  s_waitcnt vmcnt(10)
  s_waitcnt lgkmcnt(12)
  v_mfma_f32_16x16x32_bf16 v[32:35], v[80:83], v[116:119], v[32:35]
  ds_read_b64_tr_b16 v[64:65], v12 offset:32768
  ds_read_b64_tr_b16 v[66:67], v12 offset:33280
  v_mfma_f32_16x16x32_bf16 v[36:39], v[84:87], v[116:119], v[36:39]
  ds_read_b64_tr_b16 v[68:69], v13 offset:32768
  ds_read_b64_tr_b16 v[70:71], v13 offset:33280
  s_waitcnt lgkmcnt(12)
  v_mfma_f32_16x16x32_bf16 v[40:43], v[88:91], v[116:119], v[40:43]
  ds_read_b64_tr_b16 v[72:73], v14 offset:32768
  ds_read_b64_tr_b16 v[74:75], v14 offset:33280
  v_mfma_f32_16x16x32_bf16 v[44:47], v[92:95], v[116:119], v[44:47]
  ds_read_b64_tr_b16 v[76:77], v15 offset:32768
  ds_read_b64_tr_b16 v[78:79], v15 offset:33280
  s_waitcnt vmcnt(9)
  s_waitcnt lgkmcnt(12)
  v_mfma_f32_16x16x32_bf16 v[32:35], v[48:51], v[120:123], v[32:35]
  ds_read_b64_tr_b16 v[80:81], v12 offset:61440
  ds_read_b64_tr_b16 v[82:83], v12 offset:61952
  v_mfma_f32_16x16x32_bf16 v[36:39], v[52:55], v[120:123], v[36:39]
  ds_read_b64_tr_b16 v[84:85], v13 offset:61440
  ds_read_b64_tr_b16 v[86:87], v13 offset:61952
  s_waitcnt lgkmcnt(12)
  v_mfma_f32_16x16x32_bf16 v[40:43], v[56:59], v[120:123], v[40:43]
  ds_read_b64_tr_b16 v[88:89], v14 offset:61440
  ds_read_b64_tr_b16 v[90:91], v14 offset:61952
  v_mfma_f32_16x16x32_bf16 v[44:47], v[60:63], v[120:123], v[44:47]
  ds_read_b64_tr_b16 v[92:93], v15 offset:61440
  ds_read_b64_tr_b16 v[94:95], v15 offset:61952
  s_waitcnt vmcnt(8)
  s_waitcnt lgkmcnt(12)
  v_mfma_f32_16x16x32_bf16 v[32:35], v[64:67], v[124:127], v[32:35]
  ds_read_b64_tr_b16 v[48:49], v12 offset:36864
  ds_read_b64_tr_b16 v[50:51], v12 offset:37376
  v_mfma_f32_16x16x32_bf16 v[36:39], v[68:71], v[124:127], v[36:39]
  ds_read_b64_tr_b16 v[52:53], v13 offset:36864
  ds_read_b64_tr_b16 v[54:55], v13 offset:37376
  s_waitcnt lgkmcnt(12)
  v_mfma_f32_16x16x32_bf16 v[40:43], v[72:75], v[124:127], v[40:43]
  ds_read_b64_tr_b16 v[56:57], v14 offset:36864
  ds_read_b64_tr_b16 v[58:59], v14 offset:37376
  v_mfma_f32_16x16x32_bf16 v[44:47], v[76:79], v[124:127], v[44:47]
  ds_read_b64_tr_b16 v[60:61], v15 offset:36864
  ds_read_b64_tr_b16 v[62:63], v15 offset:37376
  s_waitcnt vmcnt(7)
  s_waitcnt lgkmcnt(12)
  v_mfma_f32_16x16x32_bf16 v[32:35], v[80:83], v[128:131], v[32:35]
  ds_read_b64_tr_b16 v[64:65], v12 offset:40960
  ds_read_b64_tr_b16 v[66:67], v12 offset:41472
  v_mfma_f32_16x16x32_bf16 v[36:39], v[84:87], v[128:131], v[36:39]
  ds_read_b64_tr_b16 v[68:69], v13 offset:40960
  ds_read_b64_tr_b16 v[70:71], v13 offset:41472
  s_waitcnt lgkmcnt(12)
  v_mfma_f32_16x16x32_bf16 v[40:43], v[88:91], v[128:131], v[40:43]
  ds_read_b64_tr_b16 v[72:73], v14 offset:40960
  ds_read_b64_tr_b16 v[74:75], v14 offset:41472
  v_mfma_f32_16x16x32_bf16 v[44:47], v[92:95], v[128:131], v[44:47]
  ds_read_b64_tr_b16 v[76:77], v15 offset:40960
  ds_read_b64_tr_b16 v[78:79], v15 offset:41472
  s_add_u32 s6, s15, 5
  s_mov_b64 exec, 1
  v_mov_b32 v232, s6
  ds_write_b32 v233, v232
  s_mov_b64 exec, -1
  s_waitcnt vmcnt(6)
  s_waitcnt lgkmcnt(12)
  v_mfma_f32_16x16x32_bf16 v[32:35], v[48:51], v[132:135], v[32:35]
  ds_read_b64_tr_b16 v[80:81], v12 offset:45056
  ds_read_b64_tr_b16 v[82:83], v12 offset:45568
  v_mfma_f32_16x16x32_bf16 v[36:39], v[52:55], v[132:135], v[36:39]
  ds_read_b64_tr_b16 v[84:85], v13 offset:45056
  ds_read_b64_tr_b16 v[86:87], v13 offset:45568
  s_waitcnt lgkmcnt(12)
  v_mfma_f32_16x16x32_bf16 v[40:43], v[56:59], v[132:135], v[40:43]
  ds_read_b64_tr_b16 v[88:89], v14 offset:45056
  ds_read_b64_tr_b16 v[90:91], v14 offset:45568
  v_mfma_f32_16x16x32_bf16 v[44:47], v[60:63], v[132:135], v[44:47]
  ds_read_b64_tr_b16 v[92:93], v15 offset:45056
  ds_read_b64_tr_b16 v[94:95], v15 offset:45568
  s_waitcnt vmcnt(5)
  s_waitcnt lgkmcnt(12)
  v_mfma_f32_16x16x32_bf16 v[32:35], v[64:67], v[136:139], v[32:35]
  ds_read_b64_tr_b16 v[48:49], v12 offset:49152
  ds_read_b64_tr_b16 v[50:51], v12 offset:49664
  v_mfma_f32_16x16x32_bf16 v[36:39], v[68:71], v[136:139], v[36:39]
  ds_read_b64_tr_b16 v[52:53], v13 offset:49152
  ds_read_b64_tr_b16 v[54:55], v13 offset:49664
  s_waitcnt lgkmcnt(12)
  v_mfma_f32_16x16x32_bf16 v[40:43], v[72:75], v[136:139], v[40:43]
  ds_read_b64_tr_b16 v[56:57], v14 offset:49152
  ds_read_b64_tr_b16 v[58:59], v14 offset:49664
  v_mfma_f32_16x16x32_bf16 v[44:47], v[76:79], v[136:139], v[44:47]
  ds_read_b64_tr_b16 v[60:61], v15 offset:49152
  ds_read_b64_tr_b16 v[62:63], v15 offset:49664
  s_waitcnt vmcnt(4)
  s_waitcnt lgkmcnt(12)
  v_mfma_f32_16x16x32_bf16 v[32:35], v[80:83], v[140:143], v[32:35]
  ds_read_b64_tr_b16 v[64:65], v12 offset:53248
  ds_read_b64_tr_b16 v[66:67], v12 offset:53760
  v_mfma_f32_16x16x32_bf16 v[36:39], v[84:87], v[140:143], v[36:39]
  ds_read_b64_tr_b16 v[68:69], v13 offset:53248
  ds_read_b64_tr_b16 v[70:71], v13 offset:53760
  s_waitcnt lgkmcnt(12)
  v_mfma_f32_16x16x32_bf16 v[40:43], v[88:91], v[140:143], v[40:43]
  ds_read_b64_tr_b16 v[72:73], v14 offset:53248
  ds_read_b64_tr_b16 v[74:75], v14 offset:53760
  v_mfma_f32_16x16x32_bf16 v[44:47], v[92:95], v[140:143], v[44:47]
  ds_read_b64_tr_b16 v[76:77], v15 offset:53248
  ds_read_b64_tr_b16 v[78:79], v15 offset:53760
  s_waitcnt vmcnt(3)
  s_waitcnt lgkmcnt(12)
  v_mfma_f32_16x16x32_bf16 v[32:35], v[48:51], v[144:147], v[32:35]
  ds_read_b64_tr_b16 v[80:81], v12 offset:57344
  ds_read_b64_tr_b16 v[82:83], v12 offset:57856
  v_mfma_f32_16x16x32_bf16 v[36:39], v[52:55], v[144:147], v[36:39]
  ds_read_b64_tr_b16 v[84:85], v13 offset:57344
  ds_read_b64_tr_b16 v[86:87], v13 offset:57856
  s_waitcnt lgkmcnt(12)
  v_mfma_f32_16x16x32_bf16 v[40:43], v[56:59], v[144:147], v[40:43]
  ds_read_b64_tr_b16 v[88:89], v14 offset:57344
  ds_read_b64_tr_b16 v[90:91], v14 offset:57856
  v_mfma_f32_16x16x32_bf16 v[44:47], v[60:63], v[144:147], v[44:47]
  ds_read_b64_tr_b16 v[92:93], v15 offset:57344
  ds_read_b64_tr_b16 v[94:95], v15 offset:57856
  s_waitcnt vmcnt(2)
  s_waitcnt lgkmcnt(12)
  v_mfma_f32_16x16x32_bf16 v[32:35], v[64:67], v[148:151], v[32:35]
  ds_read_b64_tr_b16 v[48:49], v12 offset:16384
  ds_read_b64_tr_b16 v[50:51], v12 offset:16896
  v_mfma_f32_16x16x32_bf16 v[36:39], v[68:71], v[148:151], v[36:39]
  ds_read_b64_tr_b16 v[52:53], v13 offset:16384
  ds_read_b64_tr_b16 v[54:55], v13 offset:16896
  s_waitcnt lgkmcnt(12)
  v_mfma_f32_16x16x32_bf16 v[40:43], v[72:75], v[148:151], v[40:43]
  ds_read_b64_tr_b16 v[56:57], v14 offset:16384
  ds_read_b64_tr_b16 v[58:59], v14 offset:16896
  v_mfma_f32_16x16x32_bf16 v[44:47], v[76:79], v[148:151], v[44:47]
  ds_read_b64_tr_b16 v[60:61], v15 offset:16384
  ds_read_b64_tr_b16 v[62:63], v15 offset:16896
  s_waitcnt vmcnt(1)
  s_waitcnt lgkmcnt(12)
  v_mfma_f32_16x16x32_bf16 v[32:35], v[80:83], v[152:155], v[32:35]
  v_mfma_f32_16x16x32_bf16 v[36:39], v[84:87], v[152:155], v[36:39]
  s_waitcnt lgkmcnt(8)
  v_mfma_f32_16x16x32_bf16 v[40:43], v[88:91], v[152:155], v[40:43]
  v_mfma_f32_16x16x32_bf16 v[44:47], v[92:95], v[152:155], v[44:47]
  s_waitcnt vmcnt(0)
  s_waitcnt lgkmcnt(4)
  v_mfma_f32_16x16x32_bf16 v[32:35], v[48:51], v[156:159], v[32:35]
  v_mfma_f32_16x16x32_bf16 v[36:39], v[52:55], v[156:159], v[36:39]
  s_waitcnt lgkmcnt(0)
  v_mfma_f32_16x16x32_bf16 v[40:43], v[56:59], v[156:159], v[40:43]
  v_mfma_f32_16x16x32_bf16 v[44:47], v[60:63], v[156:159], v[44:47]
  s_nop 3
  v_cvt_pk_bf16_f32 v100, v32, v33
  v_cvt_pk_bf16_f32 v108, v36, v37
  s_nop 0
  v_cvt_pk_bf16_f32 v116, v40, v41
  v_cvt_pk_bf16_f32 v124, v44, v45
  v_cvt_pk_bf16_f32 v101, v34, v35
  v_cvt_pk_bf16_f32 v109, v38, v39
  v_cvt_pk_bf16_f32 v117, v42, v43
  v_cvt_pk_bf16_f32 v125, v46, v47
  v_lshlrev_b32 v32, 16, v100
  v_lshlrev_b32 v36, 16, v108
  v_lshlrev_b32 v40, 16, v116
  v_lshlrev_b32 v44, 16, v124
  v_and_b32 v33, 0xffff0000, v100
  v_and_b32 v37, 0xffff0000, v108
  v_and_b32 v41, 0xffff0000, v116
  v_and_b32 v45, 0xffff0000, v124
  v_lshlrev_b32 v34, 16, v101
  v_lshlrev_b32 v38, 16, v109
  v_lshlrev_b32 v42, 16, v117
  v_lshlrev_b32 v46, 16, v125
  v_and_b32 v35, 0xffff0000, v101
  v_and_b32 v39, 0xffff0000, v109
  v_and_b32 v43, 0xffff0000, v117
  v_and_b32 v47, 0xffff0000, v125
  v_lshlrev_b32 v96, 16, v240
  v_lshlrev_b32 v104, 16, v242
  v_lshlrev_b32 v112, 16, v244
  v_lshlrev_b32 v120, 16, v246
  v_and_b32 v97, 0xffff0000, v240
  v_and_b32 v105, 0xffff0000, v242
  v_and_b32 v113, 0xffff0000, v244
  v_and_b32 v121, 0xffff0000, v246
  v_lshlrev_b32 v98, 16, v241
  v_lshlrev_b32 v106, 16, v243
  v_lshlrev_b32 v114, 16, v245
  v_lshlrev_b32 v122, 16, v247
  v_and_b32 v99, 0xffff0000, v241
  v_and_b32 v107, 0xffff0000, v243
  v_and_b32 v115, 0xffff0000, v245
  v_and_b32 v123, 0xffff0000, v247
  v_pk_add_f32 v[32:33], v[32:33], v[96:97]
  v_pk_add_f32 v[36:37], v[36:37], v[104:105]
  v_pk_add_f32 v[40:41], v[40:41], v[112:113]
  v_pk_add_f32 v[44:45], v[44:45], v[120:121]
  v_pk_add_f32 v[34:35], v[34:35], v[98:99]
  v_pk_add_f32 v[38:39], v[38:39], v[106:107]
  v_pk_add_f32 v[42:43], v[42:43], v[114:115]
  v_pk_add_f32 v[46:47], v[46:47], v[122:123]
  v_cvt_pk_bf16_f32 v240, v32, v33
  v_cvt_pk_bf16_f32 v242, v36, v37
  v_cvt_pk_bf16_f32 v244, v40, v41
  v_cvt_pk_bf16_f32 v246, v44, v45
  v_cvt_pk_bf16_f32 v241, v34, v35
  v_cvt_pk_bf16_f32 v243, v38, v39
  v_cvt_pk_bf16_f32 v245, v42, v43
  v_cvt_pk_bf16_f32 v247, v46, v47
  v_mov_b32 v48, v240
  v_mov_b32 v49, v241
  v_mov_b32 v50, v242
  v_mov_b32 v51, v243
  v_mov_b32 v52, v244
  v_mov_b32 v53, v245
  v_mov_b32 v54, v246
  v_mov_b32 v55, v247
  v_permlane16_swap_b32 v48, v50
  v_permlane16_swap_b32 v49, v51
  buffer_store_dwordx4 v[48:51], v8, s[56:59], s9 offen offset:0
  v_permlane16_swap_b32 v52, v54
  v_permlane16_swap_b32 v53, v55
  buffer_store_dwordx4 v[52:55], v8, s[56:59], s9 offen offset:1024
  v_dot2_f32_bf16 v24, v240, v10, 0
  v_dot2_f32_bf16 v26, v240, v240, 0
  v_dot2_f32_bf16 v25, v241, v10, 0
  v_dot2_f32_bf16 v27, v241, v241, 0
  v_dot2_f32_bf16 v24, v242, v10, v24
  v_dot2_f32_bf16 v26, v242, v242, v26
  v_dot2_f32_bf16 v25, v243, v10, v25
  v_dot2_f32_bf16 v27, v243, v243, v27
  v_dot2_f32_bf16 v24, v244, v10, v24
  v_dot2_f32_bf16 v26, v244, v244, v26
  v_dot2_f32_bf16 v25, v245, v10, v25
  v_dot2_f32_bf16 v27, v245, v245, v27
  v_dot2_f32_bf16 v24, v246, v10, v24
  v_dot2_f32_bf16 v26, v246, v246, v26
  v_dot2_f32_bf16 v25, v247, v10, v25
  v_dot2_f32_bf16 v27, v247, v247, v27
  s_nop 1
  v_add_f32 v24, v24, v25
  v_add_f32 v26, v26, v27
  s_nop 1
  v_permlane16_swap_b32 v24, v26
  v_add_f32 v24, v24, v26
  v_mov_b32 v26, v24
  s_nop 1
  v_permlane32_swap_b32 v24, v26
  v_add_f32 v24, v24, v26
  s_mov_b32 exec_hi, 0
  buffer_store_dword v24, v9, s[56:59], s10 offen
  s_mov_b32 exec_hi, -1
LS2c_fin:
LS2c_skip:
  s_and_b32 s6, s2, 7
  s_lshr_b32 s7, s2, 3
  s_lshl_b32 s6, s6, 2
  s_and_b32 s8, s7, 3
  s_add_u32 s3, s6, s8
  s_lshr_b32 s4, s7, 2
  s_lshl_b32 s8, s3, 2
  s_add_u32 s8, s8, s5
  s_lshr_b32 s6, s8, 4
  s_lshl_b32 s6, s6, 1
  s_add_u32 s6, s6, s8
  s_add_u32 s6, s6, 1
  s_lshl_b32 s9, s6, 14
  s_add_u32 s9, s9, 58720256
  s_lshl_b32 s6, s4, 11
  s_add_u32 s9, s9, s6
  v_and_b32 v24, 1, v3
  v_lshlrev_b32 v8, 4, v2
  v_lshl_add_u32 v8, v24, 9, v8
  v_lshrrev_b32 v24, 1, v3
  v_lshl_add_u32 v8, v24, 8, v8
  s_and_b32 s6, s2, 7
  s_lshl_b32 s6, s6, 5
  s_and_b32 s7, s3, 3
  s_lshl_b32 s7, s7, 2
  s_add_u32 s6, s6, s7
  s_add_u32 s6, s6, s5
  s_add_u32 s6, s6, 1
  s_lshl_b32 s6, s6, 7
  v_min_u32 v230, 7, v1
  v_lshlrev_b32 v230, 2, v230
  v_add_u32 v230, s6, v230
  v_add_u32 v230, 21626880, v230
  s_lshl_b32 s7, s5, 2
  s_add_u32 s7, s7, 161808
  v_mov_b32 v233, s7
  v_lshrrev_b32 v24, 2, v2
  v_and_b32 v25, 3, v2
  v_lshl_add_u32 v26, v3, 3, v24
  v_and_b32 v27, 2, v24
  v_and_b32 v28, 1, v3
  v_lshl_or_b32 v27, v28, 2, v27
  v_lshlrev_b32 v26, 7, v26
  v_and_b32 v28, 1, v25
  v_lshl_add_u32 v26, v28, 3, v26
  v_lshrrev_b32 v25, 1, v25
  v_or_b32 v28, 0, v25
  v_xor_b32 v28, v28, v27
  v_lshl_add_u32 v12, v28, 4, v26
  v_or_b32 v28, 2, v25
  v_xor_b32 v28, v28, v27
  v_lshl_add_u32 v13, v28, 4, v26
  v_or_b32 v28, 4, v25
  v_xor_b32 v28, v28, v27
  v_lshl_add_u32 v14, v28, 4, v26
  v_or_b32 v28, 6, v25
  v_xor_b32 v28, v28, v27
  v_lshl_add_u32 v15, v28, 4, v26
  v_mov_b32 v176, 0xc0135761
  v_mov_b32 v177, 0xc0135761
  v_mov_b32 v178, 0xbdd2d3e8
  v_mov_b32 v179, 0xbdd2d3e8
  v_lshlrev_b32 v4, 4, v1
  s_mul_i32 s11, s8, 62464
  s_mul_i32 s6, s24, -44032
  s_add_u32 s11, s11, s6
  s_add_u32 s11, s11, 50375680
  v_lshlrev_b32 v5, 6, v2
  v_lshl_add_u32 v5, v3, 4, v5
  s_mul_i32 s10, s8, 62464
  s_mul_i32 s6, s24, -1024
  s_add_u32 s10, s10, s6
  s_add_u32 s10, s10, 50393088
  v_lshlrev_b32 v22, 4, v3
  v_add_u32 v22, 159744, v22
  s_waitcnt vmcnt(0)
  s_mov_b64 exec, 1
  buffer_store_dword v236, v237, s[56:59], s1 offen offset:128
  s_mov_b64 exec, -1
  buffer_load_dword v231, v230, s[56:59], 0 offen sc1
  s_and_b32 s1, s2, 7
  s_lshl_b32 s1, s1, 5
  s_and_b32 s6, s3, 3
  s_lshl_b32 s6, s6, 2
  s_add_u32 s1, s1, s6
  s_add_u32 s1, s1, s5
  s_lshl_b32 s1, s1, 7
  s_lshl_b32 s6, s4, 2
  s_add_u32 s1, s1, s6
  s_add_u32 s1, s1, 21626880
  s_add_u32 s6, s25, 3
  v_mov_b32 v236, s6
  v_lshlrev_b32 v237, 7, v1
  v_mov_b32 v234, 161824
  s_add_u32 s7, s15, 3
LS3c_pw12:
  ds_read_b128 v[226:229], v234
  s_waitcnt lgkmcnt(0)
  v_min_u32 v226, v226, v227
  v_min3_u32 v226, v226, v228, v229
  s_nop 0
  v_readfirstlane_b32 s6, v226
  s_cmp_ge_u32 s6, s7
  s_cbranch_scc1 LS3c_pw12_ok
  s_sleep 1
  s_sub_u32 s0, s0, 1
  s_cbranch_scc0 LS3c_pw12
  s_mov_b32 s0, 0
LS3c_pw12_ok:
  ds_read_b128 v[160:163], v22 offset:0
  ds_read_b128 v[200:203], v22 offset:1024
  ds_read_b128 v[164:167], v22 offset:64
  ds_read_b128 v[204:207], v22 offset:1088
  ds_read_b128 v[168:171], v22 offset:128
  ds_read_b128 v[208:211], v22 offset:1152
  ds_read_b128 v[172:175], v22 offset:192
  ds_read_b128 v[212:215], v22 offset:1216
  s_waitcnt lgkmcnt(0)
  v_pk_add_f32 v[160:161], v[160:161], v[200:201]
  v_pk_add_f32 v[162:163], v[162:163], v[202:203]
  v_pk_add_f32 v[164:165], v[164:165], v[204:205]
  v_pk_add_f32 v[166:167], v[166:167], v[206:207]
  v_pk_add_f32 v[168:169], v[168:169], v[208:209]
  v_pk_add_f32 v[170:171], v[170:171], v[210:211]
  v_pk_add_f32 v[172:173], v[172:173], v[212:213]
  v_pk_add_f32 v[174:175], v[174:175], v[214:215]
  ds_read_b64_tr_b16 v[48:49], v12 offset:45056
  ds_read_b64_tr_b16 v[50:51], v12 offset:45568
  ds_read_b64_tr_b16 v[52:53], v13 offset:45056
  ds_read_b64_tr_b16 v[54:55], v13 offset:45568
  ds_read_b64_tr_b16 v[56:57], v14 offset:45056
  ds_read_b64_tr_b16 v[58:59], v14 offset:45568
  ds_read_b64_tr_b16 v[60:61], v15 offset:45056
  ds_read_b64_tr_b16 v[62:63], v15 offset:45568
  ds_read_b64_tr_b16 v[64:65], v12 offset:49152
  ds_read_b64_tr_b16 v[66:67], v12 offset:49664
  ds_read_b64_tr_b16 v[68:69], v13 offset:49152
  ds_read_b64_tr_b16 v[70:71], v13 offset:49664
  ds_read_b64_tr_b16 v[72:73], v14 offset:49152
  ds_read_b64_tr_b16 v[74:75], v14 offset:49664
  ds_read_b64_tr_b16 v[76:77], v15 offset:49152
  ds_read_b64_tr_b16 v[78:79], v15 offset:49664
  s_add_u32 s6, s25, 2
LS3c_poll13:
  s_waitcnt vmcnt(0)
  v_cmp_gt_u32 vcc, s6, v231
  s_cmp_eq_u64 vcc, 0
  s_cbranch_scc1 LS3c_poll13_ok
  buffer_load_dword v231, v230, s[56:59], 0 offen sc1
  s_sub_u32 s0, s0, 1
  s_cbranch_scc0 LS3c_poll13
  s_mov_b32 s0, 0
  s_waitcnt vmcnt(0)
LS3c_poll13_ok:
  buffer_load_dwordx4 v[180:183], v5, s[56:59], s10 offen sc1
  buffer_load_dwordx4 v[96:99], v4, s[56:59], s11 offen offset:0 sc1
  buffer_load_dwordx4 v[100:103], v4, s[56:59], s11 offen offset:1024 sc1
  buffer_load_dwordx4 v[104:107], v4, s[56:59], s11 offen offset:2048 sc1
  buffer_load_dwordx4 v[108:111], v4, s[56:59], s11 offen offset:3072 sc1
  s_add_u32 s7, s11, 4096
  buffer_load_dwordx4 v[112:115], v4, s[56:59], s7 offen offset:0 sc1
  s_add_u32 s7, s11, 4096
  buffer_load_dwordx4 v[116:119], v4, s[56:59], s7 offen offset:1024 sc1
  s_add_u32 s7, s11, 4096
  buffer_load_dwordx4 v[120:123], v4, s[56:59], s7 offen offset:2048 sc1
  s_add_u32 s7, s11, 4096
  buffer_load_dwordx4 v[124:127], v4, s[56:59], s7 offen offset:3072 sc1
  s_add_u32 s7, s11, 8192
  buffer_load_dwordx4 v[128:131], v4, s[56:59], s7 offen offset:0 sc1
  s_add_u32 s7, s11, 8192
  buffer_load_dwordx4 v[132:135], v4, s[56:59], s7 offen offset:1024 sc1
  s_add_u32 s7, s11, 8192
  buffer_load_dwordx4 v[136:139], v4, s[56:59], s7 offen offset:2048 sc1
  s_add_u32 s7, s11, 8192
  buffer_load_dwordx4 v[140:143], v4, s[56:59], s7 offen offset:3072 sc1
  s_add_u32 s7, s11, 12288
  buffer_load_dwordx4 v[144:147], v4, s[56:59], s7 offen offset:0 sc1
  s_add_u32 s7, s11, 12288
  buffer_load_dwordx4 v[148:151], v4, s[56:59], s7 offen offset:1024 sc1
  s_add_u32 s7, s11, 12288
  buffer_load_dwordx4 v[152:155], v4, s[56:59], s7 offen offset:2048 sc1
  s_add_u32 s7, s11, 12288
  buffer_load_dwordx4 v[156:159], v4, s[56:59], s7 offen offset:3072 sc1
  s_add_u32 s6, s15, 7
  s_mov_b64 exec, 1
  v_mov_b32 v232, s6
  ds_write_b32 v233, v232
  s_mov_b64 exec, -1
  s_waitcnt vmcnt(15)
  s_waitcnt lgkmcnt(12)
  v_mfma_f32_16x16x32_bf16 v[32:35], v[48:51], v[96:99], 0
  ds_read_b64_tr_b16 v[80:81], v12 offset:53248
  ds_read_b64_tr_b16 v[82:83], v12 offset:53760
  v_mfma_f32_16x16x32_bf16 v[36:39], v[52:55], v[96:99], 0
  ds_read_b64_tr_b16 v[84:85], v13 offset:53248
  ds_read_b64_tr_b16 v[86:87], v13 offset:53760
  s_waitcnt lgkmcnt(12)
  v_mfma_f32_16x16x32_bf16 v[40:43], v[56:59], v[96:99], 0
  ds_read_b64_tr_b16 v[88:89], v14 offset:53248
  ds_read_b64_tr_b16 v[90:91], v14 offset:53760
  v_mfma_f32_16x16x32_bf16 v[44:47], v[60:63], v[96:99], 0
  ds_read_b64_tr_b16 v[92:93], v15 offset:53248
  ds_read_b64_tr_b16 v[94:95], v15 offset:53760
  s_waitcnt vmcnt(14)
  s_waitcnt lgkmcnt(12)
  v_mfma_f32_16x16x32_bf16 v[32:35], v[64:67], v[100:103], v[32:35]
  ds_read_b64_tr_b16 v[48:49], v12 offset:57344
  ds_read_b64_tr_b16 v[50:51], v12 offset:57856
  v_pk_add_f32 v[180:181], v[180:181], v[182:183]
  v_mov_b32 v182, v180
  v_mfma_f32_16x16x32_bf16 v[36:39], v[68:71], v[100:103], v[36:39]
  ds_read_b64_tr_b16 v[52:53], v13 offset:57344
  ds_read_b64_tr_b16 v[54:55], v13 offset:57856
  v_mov_b32 v183, v181
  v_permlane16_swap_b32 v180, v182
  s_waitcnt lgkmcnt(12)
  v_mfma_f32_16x16x32_bf16 v[40:43], v[72:75], v[100:103], v[40:43]
  ds_read_b64_tr_b16 v[56:57], v14 offset:57344
  ds_read_b64_tr_b16 v[58:59], v14 offset:57856
  v_permlane16_swap_b32 v181, v183
  v_pk_add_f32 v[180:181], v[180:181], v[182:183]
  v_mfma_f32_16x16x32_bf16 v[44:47], v[76:79], v[100:103], v[44:47]
  ds_read_b64_tr_b16 v[60:61], v15 offset:57344
  ds_read_b64_tr_b16 v[62:63], v15 offset:57856
  v_mov_b32 v182, v180
  v_mov_b32 v183, v181
  s_waitcnt vmcnt(13)
  s_waitcnt lgkmcnt(12)
  v_mfma_f32_16x16x32_bf16 v[32:35], v[80:83], v[104:107], v[32:35]
  ds_read_b64_tr_b16 v[64:65], v12 offset:61440
  ds_read_b64_tr_b16 v[66:67], v12 offset:61952
  v_permlane32_swap_b32 v180, v182
  v_permlane32_swap_b32 v181, v183
  v_mfma_f32_16x16x32_bf16 v[36:39], v[84:87], v[104:107], v[36:39]
  ds_read_b64_tr_b16 v[68:69], v13 offset:61440
  ds_read_b64_tr_b16 v[70:71], v13 offset:61952
  v_pk_add_f32 v[180:181], v[180:181], v[182:183]
  v_mul_f32 v184, 0x3b000000, v180
  s_waitcnt lgkmcnt(12)
  v_mfma_f32_16x16x32_bf16 v[40:43], v[88:91], v[104:107], v[40:43]
  ds_read_b64_tr_b16 v[72:73], v14 offset:61440
  ds_read_b64_tr_b16 v[74:75], v14 offset:61952
  v_mul_f32 v185, 0x3b000000, v181
  v_fma_f32 v185, -v184, v184, v185
  v_mfma_f32_16x16x32_bf16 v[44:47], v[92:95], v[104:107], v[44:47]
  ds_read_b64_tr_b16 v[76:77], v15 offset:61440
  ds_read_b64_tr_b16 v[78:79], v15 offset:61952
  v_max_f32 v185, 0, v185
  v_cvt_pk_bf16_f32 v24, v184, v184
  s_waitcnt vmcnt(12)
  s_waitcnt lgkmcnt(12)
  v_mfma_f32_16x16x32_bf16 v[32:35], v[48:51], v[108:111], v[32:35]
  v_add_u32 v12, 65536, v12
  v_add_u32 v13, 65536, v13
  v_add_u32 v14, 65536, v14
  v_add_u32 v15, 65536, v15
  ds_read_b64_tr_b16 v[80:81], v12 offset:0
  ds_read_b64_tr_b16 v[82:83], v12 offset:512
  v_lshlrev_b32 v18, 16, v24
  v_cvt_pk_bf16_f32 v24, v185, v185
  v_mfma_f32_16x16x32_bf16 v[36:39], v[52:55], v[108:111], v[36:39]
  ds_read_b64_tr_b16 v[84:85], v13 offset:0
  ds_read_b64_tr_b16 v[86:87], v13 offset:512
  v_lshlrev_b32 v19, 16, v24
  v_add_f32 v19, 0x3727c5ac, v19
  s_waitcnt lgkmcnt(12)
  v_mfma_f32_16x16x32_bf16 v[40:43], v[56:59], v[108:111], v[40:43]
  ds_read_b64_tr_b16 v[88:89], v14 offset:0
  ds_read_b64_tr_b16 v[90:91], v14 offset:512
  v_cvt_pk_bf16_f32 v24, v19, v19
  v_lshlrev_b32 v19, 16, v24
  v_mfma_f32_16x16x32_bf16 v[44:47], v[60:63], v[108:111], v[44:47]
  ds_read_b64_tr_b16 v[92:93], v15 offset:0
  ds_read_b64_tr_b16 v[94:95], v15 offset:512
  v_sqrt_f32 v19, v19
  s_nop 0
  v_cvt_pk_bf16_f32 v24, v19, v19
  s_waitcnt vmcnt(11)
  s_waitcnt lgkmcnt(12)
  v_mfma_f32_16x16x32_bf16 v[32:35], v[64:67], v[112:115], v[32:35]
  ds_read_b64_tr_b16 v[48:49], v12 offset:4096
  ds_read_b64_tr_b16 v[50:51], v12 offset:4608
  v_lshlrev_b32 v19, 16, v24
  v_rcp_f32 v19, v19
  v_mfma_f32_16x16x32_bf16 v[36:39], v[68:71], v[112:115], v[36:39]
  ds_read_b64_tr_b16 v[52:53], v13 offset:4096
  ds_read_b64_tr_b16 v[54:55], v13 offset:4608
  v_sub_f32 v186, v184, v18
  v_mul_f32 v187, v185, v19
  s_waitcnt lgkmcnt(12)
  v_mfma_f32_16x16x32_bf16 v[40:43], v[72:75], v[112:115], v[40:43]
  ds_read_b64_tr_b16 v[56:57], v14 offset:4096
  ds_read_b64_tr_b16 v[58:59], v14 offset:4608
  v_mul_f32 v186, v186, v19
  v_mul_f32 v187, v187, v19
  v_mfma_f32_16x16x32_bf16 v[44:47], v[76:79], v[112:115], v[44:47]
  ds_read_b64_tr_b16 v[60:61], v15 offset:4096
  ds_read_b64_tr_b16 v[62:63], v15 offset:4608
  v_cvt_pk_bf16_f32 v24, v186, v186
  v_lshlrev_b32 v186, 16, v24
  s_waitcnt vmcnt(10)
  s_waitcnt lgkmcnt(12)
  v_mfma_f32_16x16x32_bf16 v[32:35], v[80:83], v[116:119], v[32:35]
  ds_read_b64_tr_b16 v[64:65], v12 offset:8192
  ds_read_b64_tr_b16 v[66:67], v12 offset:8704
  v_cvt_pk_bf16_f32 v25, v187, v187
  v_lshlrev_b32 v17, 16, v25
  v_mfma_f32_16x16x32_bf16 v[36:39], v[84:87], v[116:119], v[36:39]
  ds_read_b64_tr_b16 v[68:69], v13 offset:8192
  ds_read_b64_tr_b16 v[70:71], v13 offset:8704
  v_add_f32 v17, 0x3727c5ac, v17
  v_cvt_pk_bf16_f32 v25, v17, v17
  s_waitcnt lgkmcnt(12)
  v_mfma_f32_16x16x32_bf16 v[40:43], v[88:91], v[116:119], v[40:43]
  ds_read_b64_tr_b16 v[72:73], v14 offset:8192
  ds_read_b64_tr_b16 v[74:75], v14 offset:8704
  v_lshlrev_b32 v17, 16, v25
  v_sqrt_f32 v17, v17
  v_mfma_f32_16x16x32_bf16 v[44:47], v[92:95], v[116:119], v[44:47]
  ds_read_b64_tr_b16 v[76:77], v15 offset:8192
  ds_read_b64_tr_b16 v[78:79], v15 offset:8704
  v_cvt_pk_bf16_f32 v25, v17, v17
  v_lshlrev_b32 v17, 16, v25
  s_waitcnt vmcnt(9)
  s_waitcnt lgkmcnt(12)
  v_mfma_f32_16x16x32_bf16 v[32:35], v[48:51], v[120:123], v[32:35]
  ds_read_b64_tr_b16 v[80:81], v12 offset:12288
  ds_read_b64_tr_b16 v[82:83], v12 offset:12800
  v_rcp_f32 v17, v17
  v_mul_f32 v18, v18, v19
  v_mfma_f32_16x16x32_bf16 v[36:39], v[52:55], v[120:123], v[36:39]
  ds_read_b64_tr_b16 v[84:85], v13 offset:12288
  ds_read_b64_tr_b16 v[86:87], v13 offset:12800
  v_rcp_f32 v24, v19
  v_add_f32 v16, v18, v186
  s_waitcnt lgkmcnt(12)
  v_mfma_f32_16x16x32_bf16 v[40:43], v[56:59], v[120:123], v[40:43]
  ds_read_b64_tr_b16 v[88:89], v14 offset:12288
  ds_read_b64_tr_b16 v[90:91], v14 offset:12800
  v_sub_f32 v18, 0, v18
  v_mul_f32 v16, v16, v24
  v_mfma_f32_16x16x32_bf16 v[44:47], v[60:63], v[120:123], v[44:47]
  ds_read_b64_tr_b16 v[92:93], v15 offset:12288
  ds_read_b64_tr_b16 v[94:95], v15 offset:12800
  v_mul_f32 v17, v17, v19
  v_mul_f32 v16, -v16, v17
  s_waitcnt vmcnt(8)
  s_waitcnt lgkmcnt(12)
  v_mfma_f32_16x16x32_bf16 v[32:35], v[64:67], v[124:127], v[32:35]
  ds_read_b64_tr_b16 v[48:49], v12 offset:16384
  ds_read_b64_tr_b16 v[50:51], v12 offset:16896
  v_mul_f32 v160, v160, v16
  v_mul_f32 v161, v161, v16
  v_mfma_f32_16x16x32_bf16 v[36:39], v[68:71], v[124:127], v[36:39]
  ds_read_b64_tr_b16 v[52:53], v13 offset:16384
  ds_read_b64_tr_b16 v[54:55], v13 offset:16896
  v_mul_f32 v162, v162, v16
  v_mul_f32 v163, v163, v16
  s_waitcnt lgkmcnt(12)
  v_mfma_f32_16x16x32_bf16 v[40:43], v[72:75], v[124:127], v[40:43]
  ds_read_b64_tr_b16 v[56:57], v14 offset:16384
  ds_read_b64_tr_b16 v[58:59], v14 offset:16896
  v_mul_f32 v164, v164, v16
  v_mul_f32 v165, v165, v16
  v_mfma_f32_16x16x32_bf16 v[44:47], v[76:79], v[124:127], v[44:47]
  ds_read_b64_tr_b16 v[60:61], v15 offset:16384
  ds_read_b64_tr_b16 v[62:63], v15 offset:16896
  v_mul_f32 v166, v166, v16
  v_mul_f32 v167, v167, v16
  s_waitcnt vmcnt(7)
  s_waitcnt lgkmcnt(12)
  v_mfma_f32_16x16x32_bf16 v[32:35], v[80:83], v[128:131], v[32:35]
  ds_read_b64_tr_b16 v[64:65], v12 offset:20480
  ds_read_b64_tr_b16 v[66:67], v12 offset:20992
  v_mul_f32 v168, v168, v16
  v_mul_f32 v169, v169, v16
  v_mfma_f32_16x16x32_bf16 v[36:39], v[84:87], v[128:131], v[36:39]
  ds_read_b64_tr_b16 v[68:69], v13 offset:20480
  ds_read_b64_tr_b16 v[70:71], v13 offset:20992
  v_mul_f32 v170, v170, v16
  v_mul_f32 v171, v171, v16
  s_waitcnt lgkmcnt(12)
  v_mfma_f32_16x16x32_bf16 v[40:43], v[88:91], v[128:131], v[40:43]
  ds_read_b64_tr_b16 v[72:73], v14 offset:20480
  ds_read_b64_tr_b16 v[74:75], v14 offset:20992
  v_mul_f32 v172, v172, v16
  v_mul_f32 v173, v173, v16
  v_mfma_f32_16x16x32_bf16 v[44:47], v[92:95], v[128:131], v[44:47]
  ds_read_b64_tr_b16 v[76:77], v15 offset:20480
  ds_read_b64_tr_b16 v[78:79], v15 offset:20992
  v_mul_f32 v174, v174, v16
  v_mul_f32 v175, v175, v16
  s_add_u32 s6, s15, 8
  s_mov_b64 exec, 1
  v_mov_b32 v232, s6
  ds_write_b32 v233, v232
  s_mov_b64 exec, -1
  s_waitcnt vmcnt(6)
  s_waitcnt lgkmcnt(12)
  v_mfma_f32_16x16x32_bf16 v[32:35], v[48:51], v[132:135], v[32:35]
  ds_read_b64_tr_b16 v[80:81], v12 offset:24576
  ds_read_b64_tr_b16 v[82:83], v12 offset:25088
  v_mfma_f32_16x16x32_bf16 v[36:39], v[52:55], v[132:135], v[36:39]
  ds_read_b64_tr_b16 v[84:85], v13 offset:24576
  ds_read_b64_tr_b16 v[86:87], v13 offset:25088
  s_waitcnt lgkmcnt(12)
  v_mfma_f32_16x16x32_bf16 v[40:43], v[56:59], v[132:135], v[40:43]
  ds_read_b64_tr_b16 v[88:89], v14 offset:24576
  ds_read_b64_tr_b16 v[90:91], v14 offset:25088
  v_mfma_f32_16x16x32_bf16 v[44:47], v[60:63], v[132:135], v[44:47]
  ds_read_b64_tr_b16 v[92:93], v15 offset:24576
  ds_read_b64_tr_b16 v[94:95], v15 offset:25088
  s_waitcnt vmcnt(5)
  s_waitcnt lgkmcnt(12)
  v_mfma_f32_16x16x32_bf16 v[32:35], v[64:67], v[136:139], v[32:35]
  ds_read_b64_tr_b16 v[48:49], v12 offset:28672
  ds_read_b64_tr_b16 v[50:51], v12 offset:29184
  v_mfma_f32_16x16x32_bf16 v[36:39], v[68:71], v[136:139], v[36:39]
  ds_read_b64_tr_b16 v[52:53], v13 offset:28672
  ds_read_b64_tr_b16 v[54:55], v13 offset:29184
  s_waitcnt lgkmcnt(12)
  v_mfma_f32_16x16x32_bf16 v[40:43], v[72:75], v[136:139], v[40:43]
  ds_read_b64_tr_b16 v[56:57], v14 offset:28672
  ds_read_b64_tr_b16 v[58:59], v14 offset:29184
  v_mfma_f32_16x16x32_bf16 v[44:47], v[76:79], v[136:139], v[44:47]
  ds_read_b64_tr_b16 v[60:61], v15 offset:28672
  ds_read_b64_tr_b16 v[62:63], v15 offset:29184
  s_waitcnt vmcnt(4)
  s_waitcnt lgkmcnt(12)
  v_mfma_f32_16x16x32_bf16 v[32:35], v[80:83], v[140:143], v[32:35]
  ds_read_b64_tr_b16 v[64:65], v12 offset:32768
  ds_read_b64_tr_b16 v[66:67], v12 offset:33280
  v_mfma_f32_16x16x32_bf16 v[36:39], v[84:87], v[140:143], v[36:39]
  ds_read_b64_tr_b16 v[68:69], v13 offset:32768
  ds_read_b64_tr_b16 v[70:71], v13 offset:33280
  s_waitcnt lgkmcnt(12)
  v_mfma_f32_16x16x32_bf16 v[40:43], v[88:91], v[140:143], v[40:43]
  ds_read_b64_tr_b16 v[72:73], v14 offset:32768
  ds_read_b64_tr_b16 v[74:75], v14 offset:33280
  v_mfma_f32_16x16x32_bf16 v[44:47], v[92:95], v[140:143], v[44:47]
  ds_read_b64_tr_b16 v[76:77], v15 offset:32768
  ds_read_b64_tr_b16 v[78:79], v15 offset:33280
  s_waitcnt vmcnt(3)
  s_waitcnt lgkmcnt(12)
  v_mfma_f32_16x16x32_bf16 v[32:35], v[48:51], v[144:147], v[32:35]
  ds_read_b64_tr_b16 v[80:81], v12 offset:36864
  ds_read_b64_tr_b16 v[82:83], v12 offset:37376
  v_mfma_f32_16x16x32_bf16 v[36:39], v[52:55], v[144:147], v[36:39]
  ds_read_b64_tr_b16 v[84:85], v13 offset:36864
  ds_read_b64_tr_b16 v[86:87], v13 offset:37376
  s_waitcnt lgkmcnt(12)
  v_mfma_f32_16x16x32_bf16 v[40:43], v[56:59], v[144:147], v[40:43]
  ds_read_b64_tr_b16 v[88:89], v14 offset:36864
  ds_read_b64_tr_b16 v[90:91], v14 offset:37376
  v_mfma_f32_16x16x32_bf16 v[44:47], v[60:63], v[144:147], v[44:47]
  ds_read_b64_tr_b16 v[92:93], v15 offset:36864
  ds_read_b64_tr_b16 v[94:95], v15 offset:37376
  s_waitcnt vmcnt(2)
  s_waitcnt lgkmcnt(12)
  v_mfma_f32_16x16x32_bf16 v[32:35], v[64:67], v[148:151], v[32:35]
  ds_read_b64_tr_b16 v[48:49], v12 offset:40960
  ds_read_b64_tr_b16 v[50:51], v12 offset:41472
  v_mfma_f32_16x16x32_bf16 v[36:39], v[68:71], v[148:151], v[36:39]
  ds_read_b64_tr_b16 v[52:53], v13 offset:40960
  ds_read_b64_tr_b16 v[54:55], v13 offset:41472
  s_waitcnt lgkmcnt(12)
  v_mfma_f32_16x16x32_bf16 v[40:43], v[72:75], v[148:151], v[40:43]
  ds_read_b64_tr_b16 v[56:57], v14 offset:40960
  ds_read_b64_tr_b16 v[58:59], v14 offset:41472
  v_mfma_f32_16x16x32_bf16 v[44:47], v[76:79], v[148:151], v[44:47]
  ds_read_b64_tr_b16 v[60:61], v15 offset:40960
  ds_read_b64_tr_b16 v[62:63], v15 offset:41472
  s_waitcnt vmcnt(1)
  s_waitcnt lgkmcnt(12)
  v_mfma_f32_16x16x32_bf16 v[32:35], v[80:83], v[152:155], v[32:35]
  v_mfma_f32_16x16x32_bf16 v[36:39], v[84:87], v[152:155], v[36:39]
  s_waitcnt lgkmcnt(8)
  v_mfma_f32_16x16x32_bf16 v[40:43], v[88:91], v[152:155], v[40:43]
  v_mfma_f32_16x16x32_bf16 v[44:47], v[92:95], v[152:155], v[44:47]
  s_waitcnt vmcnt(0)
  s_waitcnt lgkmcnt(4)
  v_mfma_f32_16x16x32_bf16 v[32:35], v[48:51], v[156:159], v[32:35]
  v_mfma_f32_16x16x32_bf16 v[36:39], v[52:55], v[156:159], v[36:39]
  s_waitcnt lgkmcnt(0)
  v_mfma_f32_16x16x32_bf16 v[40:43], v[56:59], v[156:159], v[40:43]
  v_mfma_f32_16x16x32_bf16 v[44:47], v[60:63], v[156:159], v[44:47]
  s_nop 3
  v_pk_fma_f32 v[32:33], v[32:33], v[16:17], v[160:161] op_sel:[0,1,0] op_sel_hi:[1,1,1]
  v_pk_fma_f32 v[36:37], v[36:37], v[16:17], v[164:165] op_sel:[0,1,0] op_sel_hi:[1,1,1]
  v_pk_fma_f32 v[34:35], v[34:35], v[16:17], v[162:163] op_sel:[0,1,0] op_sel_hi:[1,1,1]
  v_pk_fma_f32 v[38:39], v[38:39], v[16:17], v[166:167] op_sel:[0,1,0] op_sel_hi:[1,1,1]
  v_cvt_pk_bf16_f32 v24, v32, v33
  v_cvt_pk_bf16_f32 v26, v36, v37
  v_cvt_pk_bf16_f32 v25, v34, v35
  v_cvt_pk_bf16_f32 v27, v38, v39
  v_lshlrev_b32 v32, 16, v24
  v_lshlrev_b32 v36, 16, v26
  v_and_b32 v33, 0xffff0000, v24
  v_and_b32 v37, 0xffff0000, v26
  v_lshlrev_b32 v34, 16, v25
  v_lshlrev_b32 v38, 16, v27
  v_and_b32 v35, 0xffff0000, v25
  v_and_b32 v39, 0xffff0000, v27
  v_pk_mul_f32 v[188:189], v[32:33], v[32:33]
  v_pk_mul_f32 v[192:193], v[36:37], v[36:37]
  v_pk_mul_f32 v[190:191], v[34:35], v[34:35]
  v_pk_mul_f32 v[194:195], v[38:39], v[38:39]
  v_pk_fma_f32 v[188:189], v[188:189], v[178:179], v[176:177]
  v_pk_fma_f32 v[192:193], v[192:193], v[178:179], v[176:177]
  v_pk_fma_f32 v[190:191], v[190:191], v[178:179], v[176:177]
  v_pk_fma_f32 v[194:195], v[194:195], v[178:179], v[176:177]
  v_pk_mul_f32 v[188:189], v[188:189], v[32:33]
  v_pk_mul_f32 v[192:193], v[192:193], v[36:37]
  v_pk_mul_f32 v[190:191], v[190:191], v[34:35]
  v_pk_mul_f32 v[194:195], v[194:195], v[38:39]
  v_exp_f32 v188, v188
  v_exp_f32 v192, v192
  v_exp_f32 v189, v189
  v_exp_f32 v193, v193
  v_exp_f32 v190, v190
  v_exp_f32 v194, v194
  v_exp_f32 v191, v191
  v_exp_f32 v195, v195
  v_pk_add_f32 v[188:189], v[188:189], 1.0 op_sel_hi:[1,0]
  v_pk_add_f32 v[192:193], v[192:193], 1.0 op_sel_hi:[1,0]
  v_pk_add_f32 v[190:191], v[190:191], 1.0 op_sel_hi:[1,0]
  v_pk_add_f32 v[194:195], v[194:195], 1.0 op_sel_hi:[1,0]
  v_rcp_f32 v188, v188
  v_rcp_f32 v192, v192
  v_rcp_f32 v189, v189
  v_rcp_f32 v193, v193
  v_rcp_f32 v190, v190
  v_rcp_f32 v194, v194
  v_rcp_f32 v191, v191
  v_rcp_f32 v195, v195
  v_pk_mul_f32 v[32:33], v[32:33], v[188:189]
  v_pk_mul_f32 v[36:37], v[36:37], v[192:193]
  v_pk_mul_f32 v[34:35], v[34:35], v[190:191]
  v_pk_mul_f32 v[38:39], v[38:39], v[194:195]
  v_cvt_pk_bf16_f32 v48, v32, v33
  v_cvt_pk_bf16_f32 v50, v36, v37
  v_cvt_pk_bf16_f32 v49, v34, v35
  v_cvt_pk_bf16_f32 v51, v38, v39
  v_permlane16_swap_b32 v48, v50
  s_nop 0
  v_permlane16_swap_b32 v49, v51
  buffer_store_dwordx4 v[48:51], v8, s[56:59], s9 offen offset:0
  v_pk_fma_f32 v[40:41], v[40:41], v[16:17], v[168:169] op_sel:[0,1,0] op_sel_hi:[1,1,1]
  v_pk_fma_f32 v[44:45], v[44:45], v[16:17], v[172:173] op_sel:[0,1,0] op_sel_hi:[1,1,1]
  v_pk_fma_f32 v[42:43], v[42:43], v[16:17], v[170:171] op_sel:[0,1,0] op_sel_hi:[1,1,1]
  v_pk_fma_f32 v[46:47], v[46:47], v[16:17], v[174:175] op_sel:[0,1,0] op_sel_hi:[1,1,1]
  v_cvt_pk_bf16_f32 v24, v40, v41
  v_cvt_pk_bf16_f32 v26, v44, v45
  v_cvt_pk_bf16_f32 v25, v42, v43
  v_cvt_pk_bf16_f32 v27, v46, v47
  v_lshlrev_b32 v40, 16, v24
  v_lshlrev_b32 v44, 16, v26
  v_and_b32 v41, 0xffff0000, v24
  v_and_b32 v45, 0xffff0000, v26
  v_lshlrev_b32 v42, 16, v25
  v_lshlrev_b32 v46, 16, v27
  v_and_b32 v43, 0xffff0000, v25
  v_and_b32 v47, 0xffff0000, v27
  v_pk_mul_f32 v[188:189], v[40:41], v[40:41]
  v_pk_mul_f32 v[192:193], v[44:45], v[44:45]
  v_pk_mul_f32 v[190:191], v[42:43], v[42:43]
  v_pk_mul_f32 v[194:195], v[46:47], v[46:47]
  v_pk_fma_f32 v[188:189], v[188:189], v[178:179], v[176:177]
  v_pk_fma_f32 v[192:193], v[192:193], v[178:179], v[176:177]
  v_pk_fma_f32 v[190:191], v[190:191], v[178:179], v[176:177]
  v_pk_fma_f32 v[194:195], v[194:195], v[178:179], v[176:177]
  v_pk_mul_f32 v[188:189], v[188:189], v[40:41]
  v_pk_mul_f32 v[192:193], v[192:193], v[44:45]
  v_pk_mul_f32 v[190:191], v[190:191], v[42:43]
  v_pk_mul_f32 v[194:195], v[194:195], v[46:47]
  v_exp_f32 v188, v188
  v_exp_f32 v192, v192
  v_exp_f32 v189, v189
  v_exp_f32 v193, v193
  v_exp_f32 v190, v190
  v_exp_f32 v194, v194
  v_exp_f32 v191, v191
  v_exp_f32 v195, v195
  v_pk_add_f32 v[188:189], v[188:189], 1.0 op_sel_hi:[1,0]
  v_pk_add_f32 v[192:193], v[192:193], 1.0 op_sel_hi:[1,0]
  v_pk_add_f32 v[190:191], v[190:191], 1.0 op_sel_hi:[1,0]
  v_pk_add_f32 v[194:195], v[194:195], 1.0 op_sel_hi:[1,0]
  v_rcp_f32 v188, v188
  v_rcp_f32 v192, v192
  v_rcp_f32 v189, v189
  v_rcp_f32 v193, v193
  v_rcp_f32 v190, v190
  v_rcp_f32 v194, v194
  v_rcp_f32 v191, v191
  v_rcp_f32 v195, v195
  v_pk_mul_f32 v[40:41], v[40:41], v[188:189]
  v_pk_mul_f32 v[44:45], v[44:45], v[192:193]
  v_pk_mul_f32 v[42:43], v[42:43], v[190:191]
  v_pk_mul_f32 v[46:47], v[46:47], v[194:195]
  v_cvt_pk_bf16_f32 v52, v40, v41
  v_cvt_pk_bf16_f32 v54, v44, v45
  v_cvt_pk_bf16_f32 v53, v42, v43
  v_cvt_pk_bf16_f32 v55, v46, v47
  v_permlane16_swap_b32 v52, v54
  s_nop 0
  v_permlane16_swap_b32 v53, v55
  buffer_store_dwordx4 v[52:55], v8, s[56:59], s9 offen offset:1024
  s_mov_b32 s60, 0
  s_and_b32 s7, s8, 15
  s_cmp_eq_u32 s7, 15
  s_cbranch_scc1 LS3c_hlo
  s_cmp_lg_u32 s7, 0
  s_cbranch_scc1 LS3c_nohalo
  s_cmp_eq_u32 s8, 0
  s_cbranch_scc1 LS3c_nohalo
  s_sub_u32 s9, s9, 32768
  s_sub_u32 s60, s1, 2048
  s_mov_b32 exec_lo, 0x00030003
  s_mov_b32 exec_hi, 0x00030003
  s_branch LS3c_hst
LS3c_hlo:
  s_cmp_eq_u32 s8, 127
  s_cbranch_scc1 LS3c_nohalo
  s_add_u32 s9, s9, 32768
  s_add_u32 s60, s1, 2048
  s_mov_b32 exec_lo, 0xc000c000
  s_mov_b32 exec_hi, 0xc000c000
LS3c_hst:
  buffer_store_dwordx4 v[48:51], v8, s[56:59], s9 offen offset:0 sc1
  buffer_store_dwordx4 v[52:55], v8, s[56:59], s9 offen offset:1024 sc1
  s_mov_b64 exec, -1
LS3c_nohalo:
  v_lshlrev_b32 v96, 16, v240
  v_lshlrev_b32 v100, 16, v242
  v_lshlrev_b32 v104, 16, v244
  v_lshlrev_b32 v108, 16, v246
  v_and_b32 v97, 0xffff0000, v240
  v_and_b32 v101, 0xffff0000, v242
  v_and_b32 v105, 0xffff0000, v244
  v_and_b32 v109, 0xffff0000, v246
  v_lshlrev_b32 v98, 16, v241
  v_lshlrev_b32 v102, 16, v243
  v_lshlrev_b32 v106, 16, v245
  v_lshlrev_b32 v110, 16, v247
  v_and_b32 v99, 0xffff0000, v241
  v_and_b32 v103, 0xffff0000, v243
  v_and_b32 v107, 0xffff0000, v245
  v_and_b32 v111, 0xffff0000, v247
  v_pk_fma_f32 v[96:97], v[96:97], v[18:19], v[18:19] op_sel:[0,1,0] op_sel_hi:[1,1,0]
  v_pk_fma_f32 v[100:101], v[100:101], v[18:19], v[18:19] op_sel:[0,1,0] op_sel_hi:[1,1,0]
  v_pk_fma_f32 v[104:105], v[104:105], v[18:19], v[18:19] op_sel:[0,1,0] op_sel_hi:[1,1,0]
  v_pk_fma_f32 v[108:109], v[108:109], v[18:19], v[18:19] op_sel:[0,1,0] op_sel_hi:[1,1,0]
  v_pk_fma_f32 v[98:99], v[98:99], v[18:19], v[18:19] op_sel:[0,1,0] op_sel_hi:[1,1,0]
  v_pk_fma_f32 v[102:103], v[102:103], v[18:19], v[18:19] op_sel:[0,1,0] op_sel_hi:[1,1,0]
  v_pk_fma_f32 v[106:107], v[106:107], v[18:19], v[18:19] op_sel:[0,1,0] op_sel_hi:[1,1,0]
  v_pk_fma_f32 v[110:111], v[110:111], v[18:19], v[18:19] op_sel:[0,1,0] op_sel_hi:[1,1,0]
  v_cvt_pk_bf16_f32 v248, v96, v97
  v_cvt_pk_bf16_f32 v250, v100, v101
  v_cvt_pk_bf16_f32 v252, v104, v105
  v_cvt_pk_bf16_f32 v254, v108, v109
  v_cvt_pk_bf16_f32 v249, v98, v99
  v_cvt_pk_bf16_f32 v251, v102, v103
  v_cvt_pk_bf16_f32 v253, v106, v107
  v_cvt_pk_bf16_f32 v255, v110, v111
LS3c_fin:
LS3c_skip:
  s_and_b32 s6, s2, 7
  s_lshr_b32 s7, s2, 3
  s_lshl_b32 s6, s6, 2
  s_and_b32 s8, s7, 3
  s_add_u32 s3, s6, s8
  s_lshr_b32 s4, s7, 2
  s_lshl_b32 s8, s3, 2
  s_add_u32 s8, s8, s5
  s_mul_i32 s9, s8, 62464
  s_mul_i32 s6, s24, 44032
  s_add_u32 s9, s9, s6
  s_add_u32 s9, s9, 50331648
  s_lshl_b32 s6, s4, 11
  s_add_u32 s9, s9, s6
  v_and_b32 v24, 1, v3
  v_lshlrev_b32 v8, 4, v2
  v_lshl_add_u32 v8, v24, 9, v8
  v_lshrrev_b32 v24, 1, v3
  v_lshl_add_u32 v8, v24, 8, v8
  s_mul_i32 s10, s8, 62464
  s_mul_i32 s6, s24, 1024
  s_add_u32 s10, s10, s6
  s_add_u32 s10, s10, 50392064
  s_lshl_b32 s6, s4, 3
  s_add_u32 s10, s10, s6
  v_lshlrev_b32 v9, 6, v2
  v_lshl_add_u32 v9, v3, 2, v9
  v_mov_b32 v10, 0x3f803f80
  s_and_b32 s6, s2, 7
  s_lshl_b32 s6, s6, 5
  s_and_b32 s7, s3, 3
  s_lshl_b32 s7, s7, 2
  s_add_u32 s6, s6, s7
  s_add_u32 s6, s6, s5
  v_lshrrev_b32 v230, 3, v1
  v_min_u32 v230, 2, v230
  v_add_u32 v230, s6, v230
  v_max_u32 v230, 1, v230
  v_min_u32 v230, 240, v230
  v_and_b32 v231, 7, v1
  v_lshlrev_b32 v231, 2, v231
  v_lshl_add_u32 v230, v230, 7, v231
  v_add_u32 v230, 21626880, v230
  s_lshl_b32 s7, s5, 2
  s_add_u32 s7, s7, 161808
  v_mov_b32 v233, s7
  v_lshlrev_b32 v12, 4, v1
  s_lshr_b32 s6, s8, 4
  s_lshl_b32 s6, s6, 1
  s_add_u32 s6, s6, s8
  s_lshl_b32 s11, s6, 14
  s_add_u32 s11, s11, 58720256
  v_lshlrev_b32 v24, 8, v3
  s_lshl_b32 s6, s8, 4
  v_mov_b32 v27, 2146435072
  v_add_u32 v25, 15, v2
  v_and_b32 v26, 15, v25
  v_lshl_add_u32 v4, v26, 4, v24
  v_lshrrev_b32 v26, 4, v25
  v_lshl_add_u32 v4, v26, 14, v4
  v_add_u32 v4, 0, v4
  v_add_u32 v25, s6, v25
  v_subrev_u32 v25, 16, v25
  v_cmp_gt_u32 vcc, 2048, v25
  s_nop 1
  v_cndmask_b32 v4, v27, v4, vcc
  v_add_u32 v25, 17, v2
  v_and_b32 v26, 15, v25
  v_lshl_add_u32 v5, v26, 4, v24
  v_lshrrev_b32 v26, 4, v25
  v_lshl_add_u32 v5, v26, 14, v5
  v_add_u32 v5, 4096, v5
  v_add_u32 v25, s6, v25
  v_subrev_u32 v25, 16, v25
  v_cmp_gt_u32 vcc, 2048, v25
  s_nop 1
  v_cndmask_b32 v5, v27, v5, vcc
  v_add_u32 v25, 14, v2
  v_and_b32 v26, 15, v25
  v_lshl_add_u32 v6, v26, 4, v24
  v_lshrrev_b32 v26, 4, v25
  v_lshl_add_u32 v6, v26, 14, v6
  v_add_u32 v6, 8192, v6
  v_add_u32 v25, s6, v25
  v_subrev_u32 v25, 16, v25
  v_cmp_gt_u32 vcc, 2048, v25
  s_nop 1
  v_cndmask_b32 v6, v27, v6, vcc
  v_add_u32 v25, 18, v2
  v_and_b32 v26, 15, v25
  v_lshl_add_u32 v7, v26, 4, v24
  v_lshrrev_b32 v26, 4, v25
  v_lshl_add_u32 v7, v26, 14, v7
  v_add_u32 v7, 12288, v7
  v_add_u32 v25, s6, v25
  v_subrev_u32 v25, 16, v25
  v_cmp_gt_u32 vcc, 2048, v25
  s_nop 1
  v_cndmask_b32 v7, v27, v7, vcc
  s_mov_b64 exec, 1
  s_cmp_eq_u32 s60, 0
  s_cbranch_scc1 LS4c_p3n
  s_waitcnt vmcnt(2)
  buffer_store_dword v236, v237, s[56:59], s1 offen offset:128
  s_waitcnt vmcnt(1)
  buffer_store_dword v236, v237, s[56:59], s60 offen offset:128 sc1
  s_branch LS4c_p3d
LS4c_p3n:
  s_waitcnt vmcnt(0)
  buffer_store_dword v236, v237, s[56:59], s1 offen offset:128
LS4c_p3d:
  s_mov_b64 exec, -1
  buffer_load_dword v231, v230, s[56:59], 0 offen sc1
  s_and_b32 s1, s2, 7
  s_lshl_b32 s1, s1, 5
  s_and_b32 s6, s3, 3
  s_lshl_b32 s6, s6, 2
  s_add_u32 s1, s1, s6
  s_add_u32 s1, s1, s5
  s_lshl_b32 s1, s1, 7
  s_lshl_b32 s6, s4, 2
  s_add_u32 s1, s1, s6
  s_add_u32 s1, s1, 21626880
  s_add_u32 s6, s25, 4
  v_mov_b32 v236, s6
  v_lshlrev_b32 v237, 7, v1
  v_mov_b32 v234, 161824
  s_add_u32 s7, s15, 4
LS4c_pw17:
  ds_read_b128 v[226:229], v234
  s_waitcnt lgkmcnt(0)
  v_min_u32 v226, v226, v227
  v_min3_u32 v226, v226, v228, v229
  s_nop 0
  v_readfirstlane_b32 s6, v226
  s_cmp_ge_u32 s6, s7
  s_cbranch_scc1 LS4c_pw17_ok
  s_sleep 1
  s_sub_u32 s0, s0, 1
  s_cbranch_scc0 LS4c_pw17
  s_mov_b32 s0, 0
LS4c_pw17_ok:
  v_add_u32 v12, 94208, v12
  ds_read_b128 v[48:51], v12 offset:61440
  ds_read_b128 v[52:55], v12 offset:62464
  ds_read_b128 v[56:59], v12 offset:63488
  ds_read_b128 v[60:63], v12 offset:64512
  v_add_u32 v12, 4294873088, v12
  ds_read_b128 v[64:67], v12 offset:0
  ds_read_b128 v[68:71], v12 offset:1024
  ds_read_b128 v[72:75], v12 offset:2048
  ds_read_b128 v[76:79], v12 offset:3072
  s_add_u32 s6, s25, 3
LS4c_poll18:
  s_waitcnt vmcnt(0)
  v_cmp_gt_u32 vcc, s6, v231
  s_cmp_eq_u64 vcc, 0
  s_cbranch_scc1 LS4c_poll18_ok
  buffer_load_dword v231, v230, s[56:59], 0 offen sc1
  s_sub_u32 s0, s0, 1
  s_cbranch_scc0 LS4c_poll18
  s_mov_b32 s0, 0
  s_waitcnt vmcnt(0)
LS4c_poll18_ok:
  buffer_load_dwordx4 v[96:99], v4, s[56:59], s11 offen offset:0 sc1
  buffer_load_dwordx4 v[100:103], v4, s[56:59], s11 offen offset:1024 sc1
  buffer_load_dwordx4 v[104:107], v4, s[56:59], s11 offen offset:2048 sc1
  buffer_load_dwordx4 v[108:111], v4, s[56:59], s11 offen offset:3072 sc1
  buffer_load_dwordx4 v[112:115], v5, s[56:59], s11 offen offset:0 sc1
  buffer_load_dwordx4 v[116:119], v5, s[56:59], s11 offen offset:1024 sc1
  buffer_load_dwordx4 v[120:123], v5, s[56:59], s11 offen offset:2048 sc1
  buffer_load_dwordx4 v[124:127], v5, s[56:59], s11 offen offset:3072 sc1
  buffer_load_dwordx4 v[128:131], v6, s[56:59], s11 offen offset:0 sc1
  buffer_load_dwordx4 v[132:135], v6, s[56:59], s11 offen offset:1024 sc1
  buffer_load_dwordx4 v[136:139], v6, s[56:59], s11 offen offset:2048 sc1
  buffer_load_dwordx4 v[140:143], v6, s[56:59], s11 offen offset:3072 sc1
  buffer_load_dwordx4 v[144:147], v7, s[56:59], s11 offen offset:0 sc1
  buffer_load_dwordx4 v[148:151], v7, s[56:59], s11 offen offset:1024 sc1
  buffer_load_dwordx4 v[152:155], v7, s[56:59], s11 offen offset:2048 sc1
  buffer_load_dwordx4 v[156:159], v7, s[56:59], s11 offen offset:3072 sc1
  s_add_u32 s6, s15, 10
  s_mov_b64 exec, 1
  v_mov_b32 v232, s6
  ds_write_b32 v233, v232
  s_mov_b64 exec, -1
  s_waitcnt vmcnt(15)
  s_waitcnt lgkmcnt(6)
  v_mfma_f32_16x16x32_bf16 v[32:35], v[48:51], v[96:99], 0
  ds_read_b128 v[80:83], v12 offset:4096
  v_mfma_f32_16x16x32_bf16 v[36:39], v[52:55], v[96:99], 0
  ds_read_b128 v[84:87], v12 offset:5120
  s_waitcnt lgkmcnt(6)
  v_mfma_f32_16x16x32_bf16 v[40:43], v[56:59], v[96:99], 0
  ds_read_b128 v[88:91], v12 offset:6144
  v_mfma_f32_16x16x32_bf16 v[44:47], v[60:63], v[96:99], 0
  ds_read_b128 v[92:95], v12 offset:7168
  s_waitcnt vmcnt(14)
  s_waitcnt lgkmcnt(6)
  v_mfma_f32_16x16x32_bf16 v[32:35], v[64:67], v[100:103], v[32:35]
  ds_read_b128 v[48:51], v12 offset:8192
  v_mfma_f32_16x16x32_bf16 v[36:39], v[68:71], v[100:103], v[36:39]
  ds_read_b128 v[52:55], v12 offset:9216
  s_waitcnt lgkmcnt(6)
  v_mfma_f32_16x16x32_bf16 v[40:43], v[72:75], v[100:103], v[40:43]
  ds_read_b128 v[56:59], v12 offset:10240
  v_mfma_f32_16x16x32_bf16 v[44:47], v[76:79], v[100:103], v[44:47]
  ds_read_b128 v[60:63], v12 offset:11264
  s_waitcnt vmcnt(13)
  s_waitcnt lgkmcnt(6)
  v_mfma_f32_16x16x32_bf16 v[32:35], v[80:83], v[104:107], v[32:35]
  ds_read_b128 v[64:67], v12 offset:12288
  v_mfma_f32_16x16x32_bf16 v[36:39], v[84:87], v[104:107], v[36:39]
  ds_read_b128 v[68:71], v12 offset:13312
  s_waitcnt lgkmcnt(6)
  v_mfma_f32_16x16x32_bf16 v[40:43], v[88:91], v[104:107], v[40:43]
  ds_read_b128 v[72:75], v12 offset:14336
  v_mfma_f32_16x16x32_bf16 v[44:47], v[92:95], v[104:107], v[44:47]
  ds_read_b128 v[76:79], v12 offset:15360
  s_waitcnt vmcnt(12)
  s_waitcnt lgkmcnt(6)
  v_mfma_f32_16x16x32_bf16 v[32:35], v[48:51], v[108:111], v[32:35]
  ds_read_b128 v[80:83], v12 offset:16384
  v_mfma_f32_16x16x32_bf16 v[36:39], v[52:55], v[108:111], v[36:39]
  ds_read_b128 v[84:87], v12 offset:17408
  s_waitcnt lgkmcnt(6)
  v_mfma_f32_16x16x32_bf16 v[40:43], v[56:59], v[108:111], v[40:43]
  ds_read_b128 v[88:91], v12 offset:18432
  v_mfma_f32_16x16x32_bf16 v[44:47], v[60:63], v[108:111], v[44:47]
  ds_read_b128 v[92:95], v12 offset:19456
  s_waitcnt vmcnt(11)
  s_waitcnt lgkmcnt(6)
  v_mfma_f32_16x16x32_bf16 v[32:35], v[64:67], v[112:115], v[32:35]
  ds_read_b128 v[48:51], v12 offset:20480
  v_mfma_f32_16x16x32_bf16 v[36:39], v[68:71], v[112:115], v[36:39]
  ds_read_b128 v[52:55], v12 offset:21504
  s_waitcnt lgkmcnt(6)
  v_mfma_f32_16x16x32_bf16 v[40:43], v[72:75], v[112:115], v[40:43]
  ds_read_b128 v[56:59], v12 offset:22528
  v_mfma_f32_16x16x32_bf16 v[44:47], v[76:79], v[112:115], v[44:47]
  ds_read_b128 v[60:63], v12 offset:23552
  s_add_u32 s6, s15, 11
  s_mov_b64 exec, 1
  v_mov_b32 v232, s6
  ds_write_b32 v233, v232
  s_mov_b64 exec, -1
  s_waitcnt vmcnt(10)
  s_waitcnt lgkmcnt(6)
  v_mfma_f32_16x16x32_bf16 v[32:35], v[80:83], v[116:119], v[32:35]
  ds_read_b128 v[64:67], v12 offset:24576
  v_mfma_f32_16x16x32_bf16 v[36:39], v[84:87], v[116:119], v[36:39]
  ds_read_b128 v[68:71], v12 offset:25600
  s_waitcnt lgkmcnt(6)
  v_mfma_f32_16x16x32_bf16 v[40:43], v[88:91], v[116:119], v[40:43]
  ds_read_b128 v[72:75], v12 offset:26624
  v_mfma_f32_16x16x32_bf16 v[44:47], v[92:95], v[116:119], v[44:47]
  ds_read_b128 v[76:79], v12 offset:27648
  s_waitcnt vmcnt(9)
  s_waitcnt lgkmcnt(6)
  v_mfma_f32_16x16x32_bf16 v[32:35], v[48:51], v[120:123], v[32:35]
  ds_read_b128 v[80:83], v12 offset:28672
  v_mfma_f32_16x16x32_bf16 v[36:39], v[52:55], v[120:123], v[36:39]
  ds_read_b128 v[84:87], v12 offset:29696
  s_waitcnt lgkmcnt(6)
  v_mfma_f32_16x16x32_bf16 v[40:43], v[56:59], v[120:123], v[40:43]
  ds_read_b128 v[88:91], v12 offset:30720
  v_mfma_f32_16x16x32_bf16 v[44:47], v[60:63], v[120:123], v[44:47]
  ds_read_b128 v[92:95], v12 offset:31744
  s_waitcnt vmcnt(8)
  s_waitcnt lgkmcnt(6)
  v_mfma_f32_16x16x32_bf16 v[32:35], v[64:67], v[124:127], v[32:35]
  ds_read_b128 v[48:51], v12 offset:32768
  v_mfma_f32_16x16x32_bf16 v[36:39], v[68:71], v[124:127], v[36:39]
  ds_read_b128 v[52:55], v12 offset:33792
  s_waitcnt lgkmcnt(6)
  v_mfma_f32_16x16x32_bf16 v[40:43], v[72:75], v[124:127], v[40:43]
  ds_read_b128 v[56:59], v12 offset:34816
  v_mfma_f32_16x16x32_bf16 v[44:47], v[76:79], v[124:127], v[44:47]
  ds_read_b128 v[60:63], v12 offset:35840
  s_waitcnt vmcnt(7)
  s_waitcnt lgkmcnt(6)
  v_mfma_f32_16x16x32_bf16 v[32:35], v[80:83], v[128:131], v[32:35]
  ds_read_b128 v[64:67], v12 offset:36864
  v_mfma_f32_16x16x32_bf16 v[36:39], v[84:87], v[128:131], v[36:39]
  ds_read_b128 v[68:71], v12 offset:37888
  s_waitcnt lgkmcnt(6)
  v_mfma_f32_16x16x32_bf16 v[40:43], v[88:91], v[128:131], v[40:43]
  ds_read_b128 v[72:75], v12 offset:38912
  v_mfma_f32_16x16x32_bf16 v[44:47], v[92:95], v[128:131], v[44:47]
  ds_read_b128 v[76:79], v12 offset:39936
  s_waitcnt vmcnt(6)
  s_waitcnt lgkmcnt(6)
  v_mfma_f32_16x16x32_bf16 v[32:35], v[48:51], v[132:135], v[32:35]
  ds_read_b128 v[80:83], v12 offset:40960
  v_mfma_f32_16x16x32_bf16 v[36:39], v[52:55], v[132:135], v[36:39]
  ds_read_b128 v[84:87], v12 offset:41984
  s_waitcnt lgkmcnt(6)
  v_mfma_f32_16x16x32_bf16 v[40:43], v[56:59], v[132:135], v[40:43]
  ds_read_b128 v[88:91], v12 offset:43008
  v_mfma_f32_16x16x32_bf16 v[44:47], v[60:63], v[132:135], v[44:47]
  ds_read_b128 v[92:95], v12 offset:44032
  s_waitcnt vmcnt(5)
  s_waitcnt lgkmcnt(6)
  v_mfma_f32_16x16x32_bf16 v[32:35], v[64:67], v[136:139], v[32:35]
  v_add_u32 v12, 94208, v12
  ds_read_b128 v[48:51], v12 offset:20480
  v_mfma_f32_16x16x32_bf16 v[36:39], v[68:71], v[136:139], v[36:39]
  ds_read_b128 v[52:55], v12 offset:21504
  s_waitcnt lgkmcnt(6)
  v_mfma_f32_16x16x32_bf16 v[40:43], v[72:75], v[136:139], v[40:43]
  ds_read_b128 v[56:59], v12 offset:22528
  v_mfma_f32_16x16x32_bf16 v[44:47], v[76:79], v[136:139], v[44:47]
  ds_read_b128 v[60:63], v12 offset:23552
  s_waitcnt vmcnt(4)
  s_waitcnt lgkmcnt(6)
  v_mfma_f32_16x16x32_bf16 v[32:35], v[80:83], v[140:143], v[32:35]
  ds_read_b128 v[64:67], v12 offset:24576
  v_mfma_f32_16x16x32_bf16 v[36:39], v[84:87], v[140:143], v[36:39]
  ds_read_b128 v[68:71], v12 offset:25600
  s_waitcnt lgkmcnt(6)
  v_mfma_f32_16x16x32_bf16 v[40:43], v[88:91], v[140:143], v[40:43]
  ds_read_b128 v[72:75], v12 offset:26624
  v_mfma_f32_16x16x32_bf16 v[44:47], v[92:95], v[140:143], v[44:47]
  ds_read_b128 v[76:79], v12 offset:27648
  s_waitcnt vmcnt(3)
  s_waitcnt lgkmcnt(6)
  v_mfma_f32_16x16x32_bf16 v[32:35], v[48:51], v[144:147], v[32:35]
  ds_read_b128 v[80:83], v12 offset:28672
  v_mfma_f32_16x16x32_bf16 v[36:39], v[52:55], v[144:147], v[36:39]
  ds_read_b128 v[84:87], v12 offset:29696
  s_waitcnt lgkmcnt(6)
  v_mfma_f32_16x16x32_bf16 v[40:43], v[56:59], v[144:147], v[40:43]
  ds_read_b128 v[88:91], v12 offset:30720
  v_mfma_f32_16x16x32_bf16 v[44:47], v[60:63], v[144:147], v[44:47]
  ds_read_b128 v[92:95], v12 offset:31744
  s_waitcnt vmcnt(2)
  s_waitcnt lgkmcnt(6)
  v_mfma_f32_16x16x32_bf16 v[32:35], v[64:67], v[148:151], v[32:35]
  ds_read_b128 v[48:51], v12 offset:32768
  v_mfma_f32_16x16x32_bf16 v[36:39], v[68:71], v[148:151], v[36:39]
  ds_read_b128 v[52:55], v12 offset:33792
  s_waitcnt lgkmcnt(6)
  v_mfma_f32_16x16x32_bf16 v[40:43], v[72:75], v[148:151], v[40:43]
  ds_read_b128 v[56:59], v12 offset:34816
  v_mfma_f32_16x16x32_bf16 v[44:47], v[76:79], v[148:151], v[44:47]
  ds_read_b128 v[60:63], v12 offset:35840
  s_waitcnt vmcnt(1)
  s_waitcnt lgkmcnt(6)
  v_mfma_f32_16x16x32_bf16 v[32:35], v[80:83], v[152:155], v[32:35]
  v_mfma_f32_16x16x32_bf16 v[36:39], v[84:87], v[152:155], v[36:39]
  s_waitcnt lgkmcnt(4)
  v_mfma_f32_16x16x32_bf16 v[40:43], v[88:91], v[152:155], v[40:43]
  v_mfma_f32_16x16x32_bf16 v[44:47], v[92:95], v[152:155], v[44:47]
  s_waitcnt vmcnt(0)
  s_waitcnt lgkmcnt(2)
  v_mfma_f32_16x16x32_bf16 v[32:35], v[48:51], v[156:159], v[32:35]
  v_mfma_f32_16x16x32_bf16 v[36:39], v[52:55], v[156:159], v[36:39]
  s_waitcnt lgkmcnt(0)
  v_mfma_f32_16x16x32_bf16 v[40:43], v[56:59], v[156:159], v[40:43]
  v_mfma_f32_16x16x32_bf16 v[44:47], v[60:63], v[156:159], v[44:47]
  s_nop 3
  v_cvt_pk_bf16_f32 v100, v32, v33
  v_cvt_pk_bf16_f32 v108, v36, v37
  s_nop 0
  v_cvt_pk_bf16_f32 v116, v40, v41
  v_cvt_pk_bf16_f32 v124, v44, v45
  v_cvt_pk_bf16_f32 v101, v34, v35
  v_cvt_pk_bf16_f32 v109, v38, v39
  v_cvt_pk_bf16_f32 v117, v42, v43
  v_cvt_pk_bf16_f32 v125, v46, v47
  v_lshlrev_b32 v32, 16, v100
  v_lshlrev_b32 v36, 16, v108
  v_lshlrev_b32 v40, 16, v116
  v_lshlrev_b32 v44, 16, v124
  v_and_b32 v33, 0xffff0000, v100
  v_and_b32 v37, 0xffff0000, v108
  v_and_b32 v41, 0xffff0000, v116
  v_and_b32 v45, 0xffff0000, v124
  v_lshlrev_b32 v34, 16, v101
  v_lshlrev_b32 v38, 16, v109
  v_lshlrev_b32 v42, 16, v117
  v_lshlrev_b32 v46, 16, v125
  v_and_b32 v35, 0xffff0000, v101
  v_and_b32 v39, 0xffff0000, v109
  v_and_b32 v43, 0xffff0000, v117
  v_and_b32 v47, 0xffff0000, v125
  v_lshlrev_b32 v96, 16, v248
  v_lshlrev_b32 v104, 16, v250
  v_lshlrev_b32 v112, 16, v252
  v_lshlrev_b32 v120, 16, v254
  v_and_b32 v97, 0xffff0000, v248
  v_and_b32 v105, 0xffff0000, v250
  v_and_b32 v113, 0xffff0000, v252
  v_and_b32 v121, 0xffff0000, v254
  v_lshlrev_b32 v98, 16, v249
  v_lshlrev_b32 v106, 16, v251
  v_lshlrev_b32 v114, 16, v253
  v_lshlrev_b32 v122, 16, v255
  v_and_b32 v99, 0xffff0000, v249
  v_and_b32 v107, 0xffff0000, v251
  v_and_b32 v115, 0xffff0000, v253
  v_and_b32 v123, 0xffff0000, v255
  v_pk_add_f32 v[32:33], v[32:33], v[96:97]
  v_pk_add_f32 v[36:37], v[36:37], v[104:105]
  v_pk_add_f32 v[40:41], v[40:41], v[112:113]
  v_pk_add_f32 v[44:45], v[44:45], v[120:121]
  v_pk_add_f32 v[34:35], v[34:35], v[98:99]
  v_pk_add_f32 v[38:39], v[38:39], v[106:107]
  v_pk_add_f32 v[42:43], v[42:43], v[114:115]
  v_pk_add_f32 v[46:47], v[46:47], v[122:123]
  v_cvt_pk_bf16_f32 v248, v32, v33
  v_cvt_pk_bf16_f32 v250, v36, v37
  v_cvt_pk_bf16_f32 v252, v40, v41
  v_cvt_pk_bf16_f32 v254, v44, v45
  v_cvt_pk_bf16_f32 v249, v34, v35
  v_cvt_pk_bf16_f32 v251, v38, v39
  v_cvt_pk_bf16_f32 v253, v42, v43
  v_cvt_pk_bf16_f32 v255, v46, v47
  v_mov_b32 v48, v248
  v_mov_b32 v49, v249
  v_mov_b32 v50, v250
  v_mov_b32 v51, v251
  v_mov_b32 v52, v252
  v_mov_b32 v53, v253
  v_mov_b32 v54, v254
  v_mov_b32 v55, v255
  v_permlane16_swap_b32 v48, v50
  v_permlane16_swap_b32 v49, v51
  buffer_store_dwordx4 v[48:51], v8, s[56:59], s9 offen offset:0
  v_permlane16_swap_b32 v52, v54
  v_permlane16_swap_b32 v53, v55
  buffer_store_dwordx4 v[52:55], v8, s[56:59], s9 offen offset:1024
  v_dot2_f32_bf16 v24, v248, v10, 0
  v_dot2_f32_bf16 v26, v248, v248, 0
  v_dot2_f32_bf16 v25, v249, v10, 0
  v_dot2_f32_bf16 v27, v249, v249, 0
  v_dot2_f32_bf16 v24, v250, v10, v24
  v_dot2_f32_bf16 v26, v250, v250, v26
  v_dot2_f32_bf16 v25, v251, v10, v25
  v_dot2_f32_bf16 v27, v251, v251, v27
  v_dot2_f32_bf16 v24, v252, v10, v24
  v_dot2_f32_bf16 v26, v252, v252, v26
  v_dot2_f32_bf16 v25, v253, v10, v25
  v_dot2_f32_bf16 v27, v253, v253, v27
  v_dot2_f32_bf16 v24, v254, v10, v24
  v_dot2_f32_bf16 v26, v254, v254, v26
  v_dot2_f32_bf16 v25, v255, v10, v25
  v_dot2_f32_bf16 v27, v255, v255, v27
  s_nop 1
  v_add_f32 v24, v24, v25
  v_add_f32 v26, v26, v27
  s_nop 1
  v_permlane16_swap_b32 v24, v26
  v_add_f32 v24, v24, v26
  v_mov_b32 v26, v24
  s_nop 1
  v_permlane32_swap_b32 v24, v26
  v_add_f32 v24, v24, v26
  s_mov_b32 exec_hi, 0
  buffer_store_dword v24, v9, s[56:59], s10 offen
  s_mov_b32 exec_hi, -1
LS4c_fin:
LS4c_skip:
  s_and_b32 s6, s2, 7
  s_lshr_b32 s7, s2, 3
  s_lshl_b32 s6, s6, 1
  s_and_b32 s8, s7, 1
  s_add_u32 s3, s6, s8
  s_lshr_b32 s4, s7, 1
  s_cmp_lt_u32 s2, 240
  s_cbranch_scc1 LS5c_go
  s_waitcnt vmcnt(0)
  s_mov_b64 exec, 1
  buffer_store_dword v236, v237, s[56:59], s1 offen offset:128
  s_mov_b64 exec, -1
  s_mov_b64 s[62:63], 0
  s_lshl_b32 s7, s5, 2
  s_add_u32 s6, s15, 17
  s_add_u32 s7, s7, 161808
  v_mov_b32 v232, s6
  v_mov_b32 v233, s7
  s_mov_b64 exec, 1
  ds_write_b32 v233, v232
  s_mov_b64 exec, -1
  s_branch LS5c_skip
LS5c_go:
  s_lshl_b32 s8, s3, 3
  s_lshl_b32 s6, s5, 1
  s_add_u32 s8, s8, s6
  s_mul_i32 s9, s8, 62464
  s_mul_i32 s6, s24, -16384
  s_add_u32 s9, s9, s6
  s_add_u32 s9, s9, 50348032
  s_mul_i32 s6, s4, 3072
  s_add_u32 s9, s9, s6
  s_add_u32 s12, s9, 62464
  v_and_b32 v24, 1, v3
  v_lshlrev_b32 v8, 4, v2
  v_lshl_add_u32 v8, v24, 9, v8
  v_lshrrev_b32 v24, 1, v3
  v_lshl_add_u32 v8, v24, 8, v8
  s_mov_b64 s[62:63], 3
  v_lshlrev_b32 v22, 4, v3
  v_add_u32 v22, 159744, v22
  v_mov_b32 v4, 0xc0135761
  v_mov_b32 v5, 0xc0135761
  v_mov_b32 v6, 0xbdd2d3e8
  v_mov_b32 v7, 0xbdd2d3e8
  s_and_b32 s6, s2, 7
  s_lshl_b32 s6, s6, 5
  s_and_b32 s7, s3, 1
  s_lshl_b32 s7, s7, 3
  s_add_u32 s6, s6, s7
  s_lshl_b32 s7, s5, 1
  s_add_u32 s6, s6, s7
  v_lshrrev_b32 v230, 3, v1
  v_and_b32 v230, 1, v230
  s_add_u32 s6, s6, 1
  v_add_u32 v230, s6, v230
  v_and_b32 v231, 7, v1
  v_lshlrev_b32 v231, 2, v231
  v_lshl_add_u32 v230, v230, 7, v231
  v_add_u32 v230, 21626880, v230
  s_lshl_b32 s7, s5, 2
  s_add_u32 s7, s7, 161808
  v_mov_b32 v233, s7
  v_lshlrev_b32 v224, 4, v1
  v_lshlrev_b32 v15, 4, v1
  s_mul_i32 s11, s8, 62464
  s_mul_i32 s6, s24, 44032
  s_add_u32 s11, s11, s6
  s_add_u32 s11, s11, 50331648
  s_mul_i32 s10, s8, 62464
  s_mul_i32 s6, s24, 1024
  s_add_u32 s10, s10, s6
  s_add_u32 s10, s10, 50392064
  v_lshlrev_b32 v235, 6, v2
  v_lshl_add_u32 v235, v3, 4, v235
  s_waitcnt vmcnt(0)
  s_mov_b64 exec, 1
  buffer_store_dword v236, v237, s[56:59], s1 offen offset:128
  s_mov_b64 exec, -1
  buffer_load_dword v231, v230, s[56:59], 0 offen sc1
  s_and_b32 s1, s2, 7
  s_lshl_b32 s1, s1, 5
  s_and_b32 s6, s3, 1
  s_lshl_b32 s6, s6, 3
  s_add_u32 s1, s1, s6
  s_lshl_b32 s6, s5, 1
  s_add_u32 s1, s1, s6
  s_lshl_b32 s1, s1, 7
  s_lshl_b32 s6, s4, 2
  s_add_u32 s1, s1, s6
  s_add_u32 s1, s1, 21626880
  s_add_u32 s6, s25, 5
  v_mov_b32 v236, s6
  v_lshlrev_b32 v237, 7, v1
  v_mov_b32 v234, 161824
  s_add_u32 s7, s15, 5
LS5c_pw22:
  ds_read_b128 v[226:229], v234
  s_waitcnt lgkmcnt(0)
  v_min_u32 v226, v226, v227
  v_min3_u32 v226, v226, v228, v229
  s_nop 0
  v_readfirstlane_b32 s6, v226
  s_cmp_ge_u32 s6, s7
  s_cbranch_scc1 LS5c_pw22_ok
  s_sleep 1
  s_sub_u32 s0, s0, 1
  s_cbranch_scc0 LS5c_pw22
  s_mov_b32 s0, 0
LS5c_pw22_ok:
  ds_read_b128 v[80:83], v224 offset:45056
  ds_read_b128 v[84:87], v224 offset:46080
  ds_read_b128 v[88:91], v224 offset:49152
  ds_read_b128 v[92:95], v224 offset:50176
  ds_read_b128 v[96:99], v224 offset:53248
  ds_read_b128 v[100:103], v224 offset:54272
  s_add_u32 s6, s25, 4
LS5c_poll23:
  s_waitcnt vmcnt(0)
  v_cmp_gt_u32 vcc, s6, v231
  s_cmp_eq_u64 vcc, 0
  s_cbranch_scc1 LS5c_poll23_ok
  buffer_load_dword v231, v230, s[56:59], 0 offen sc1
  s_sub_u32 s0, s0, 1
  s_cbranch_scc0 LS5c_poll23
  s_mov_b32 s0, 0
  s_waitcnt vmcnt(0)
LS5c_poll23_ok:
  buffer_load_dwordx4 v[24:27], v235, s[56:59], s10 offen sc1
  s_add_u32 s10, s10, 62464
  buffer_load_dwordx4 v[28:31], v235, s[56:59], s10 offen sc1
  buffer_load_dwordx4 v[128:131], v15, s[56:59], s11 offen offset:0 sc1
  s_add_u32 s7, s11, 61440
  buffer_load_dwordx4 v[132:135], v15, s[56:59], s7 offen offset:1024 sc1
  buffer_load_dwordx4 v[136:139], v15, s[56:59], s11 offen offset:1024 sc1
  s_add_u32 s7, s11, 61440
  buffer_load_dwordx4 v[140:143], v15, s[56:59], s7 offen offset:2048 sc1
  buffer_load_dwordx4 v[144:147], v15, s[56:59], s11 offen offset:2048 sc1
  s_add_u32 s7, s11, 61440
  buffer_load_dwordx4 v[148:151], v15, s[56:59], s7 offen offset:3072 sc1
  s_waitcnt vmcnt(4)
  s_waitcnt lgkmcnt(4)
  v_mfma_f32_16x16x32_bf16 v[32:35], v[80:83], v[128:131], 0
  ds_read_b128 v[104:107], v224 offset:47104
  v_mfma_f32_16x16x32_bf16 v[56:59], v[80:83], v[132:135], 0
  ds_read_b128 v[108:111], v224 offset:48128
  v_mfma_f32_16x16x32_bf16 v[36:39], v[84:87], v[128:131], 0
  ds_read_b128 v[112:115], v224 offset:51200
  v_mfma_f32_16x16x32_bf16 v[60:63], v[84:87], v[132:135], 0
  ds_read_b128 v[116:119], v224 offset:52224
  s_waitcnt lgkmcnt(6)
  v_mfma_f32_16x16x32_bf16 v[40:43], v[88:91], v[128:131], 0
  ds_read_b128 v[120:123], v224 offset:55296
  v_mfma_f32_16x16x32_bf16 v[64:67], v[88:91], v[132:135], 0
  ds_read_b128 v[124:127], v224 offset:56320
  v_mfma_f32_16x16x32_bf16 v[44:47], v[92:95], v[128:131], 0
  v_mfma_f32_16x16x32_bf16 v[68:71], v[92:95], v[132:135], 0
  s_waitcnt lgkmcnt(6)
  v_mfma_f32_16x16x32_bf16 v[48:51], v[96:99], v[128:131], 0
  v_mfma_f32_16x16x32_bf16 v[72:75], v[96:99], v[132:135], 0
  v_mfma_f32_16x16x32_bf16 v[52:55], v[100:103], v[128:131], 0
  v_mfma_f32_16x16x32_bf16 v[76:79], v[100:103], v[132:135], 0
  buffer_load_dwordx4 v[152:155], v15, s[56:59], s11 offen offset:3072 sc1
  s_add_u32 s7, s11, 65536
  buffer_load_dwordx4 v[156:159], v15, s[56:59], s7 offen offset:0 sc1
  s_add_u32 s7, s11, 4096
  buffer_load_dwordx4 v[160:163], v15, s[56:59], s7 offen offset:0 sc1
  s_add_u32 s7, s11, 65536
  buffer_load_dwordx4 v[164:167], v15, s[56:59], s7 offen offset:1024 sc1
  s_add_u32 s7, s11, 4096
  buffer_load_dwordx4 v[168:171], v15, s[56:59], s7 offen offset:1024 sc1
  s_add_u32 s7, s11, 65536
  buffer_load_dwordx4 v[172:175], v15, s[56:59], s7 offen offset:2048 sc1
  s_waitcnt vmcnt(8)
  s_waitcnt lgkmcnt(4)
  v_mfma_f32_16x16x32_bf16 v[32:35], v[104:107], v[136:139], v[32:35]
  ds_read_b128 v[80:83], v224 offset:57344
  v_pk_add_f32 v[24:25], v[24:25], v[26:27]
  v_mfma_f32_16x16x32_bf16 v[56:59], v[104:107], v[140:143], v[56:59]
  ds_read_b128 v[84:87], v224 offset:58368
  v_pk_add_f32 v[28:29], v[28:29], v[30:31]
  v_mfma_f32_16x16x32_bf16 v[36:39], v[108:111], v[136:139], v[36:39]
  ds_read_b128 v[88:91], v224 offset:61440
  v_mov_b32 v26, v24
  v_mfma_f32_16x16x32_bf16 v[60:63], v[108:111], v[140:143], v[60:63]
  ds_read_b128 v[92:95], v224 offset:62464
  v_mov_b32 v30, v28
  s_waitcnt lgkmcnt(6)
  v_mfma_f32_16x16x32_bf16 v[40:43], v[112:115], v[136:139], v[40:43]
  v_add_u32 v224, 65536, v224
  ds_read_b128 v[96:99], v224 offset:0
  v_mov_b32 v27, v25
  v_mfma_f32_16x16x32_bf16 v[64:67], v[112:115], v[140:143], v[64:67]
  ds_read_b128 v[100:103], v224 offset:1024
  v_mov_b32 v31, v29
  v_mfma_f32_16x16x32_bf16 v[44:47], v[116:119], v[136:139], v[44:47]
  v_permlane16_swap_b32 v24, v26
  v_mfma_f32_16x16x32_bf16 v[68:71], v[116:119], v[140:143], v[68:71]
  v_permlane16_swap_b32 v28, v30
  s_waitcnt lgkmcnt(6)
  v_mfma_f32_16x16x32_bf16 v[48:51], v[120:123], v[136:139], v[48:51]
  v_permlane16_swap_b32 v25, v27
  v_mfma_f32_16x16x32_bf16 v[72:75], v[120:123], v[140:143], v[72:75]
  v_permlane16_swap_b32 v29, v31
  v_mfma_f32_16x16x32_bf16 v[52:55], v[124:127], v[136:139], v[52:55]
  v_pk_add_f32 v[24:25], v[24:25], v[26:27]
  v_mfma_f32_16x16x32_bf16 v[76:79], v[124:127], v[140:143], v[76:79]
  v_pk_add_f32 v[28:29], v[28:29], v[30:31]
  s_add_u32 s7, s11, 4096
  buffer_load_dwordx4 v[176:179], v15, s[56:59], s7 offen offset:2048 sc1
  s_add_u32 s7, s11, 65536
  buffer_load_dwordx4 v[180:183], v15, s[56:59], s7 offen offset:3072 sc1
  s_add_u32 s7, s11, 4096
  buffer_load_dwordx4 v[184:187], v15, s[56:59], s7 offen offset:3072 sc1
  s_add_u32 s7, s11, 69632
  buffer_load_dwordx4 v[188:191], v15, s[56:59], s7 offen offset:0 sc1
  s_add_u32 s7, s11, 8192
  buffer_load_dwordx4 v[192:195], v15, s[56:59], s7 offen offset:0 sc1
  s_add_u32 s7, s11, 69632
  buffer_load_dwordx4 v[196:199], v15, s[56:59], s7 offen offset:1024 sc1
  s_waitcnt vmcnt(12)
  s_waitcnt lgkmcnt(4)
  v_mfma_f32_16x16x32_bf16 v[32:35], v[80:83], v[144:147], v[32:35]
  v_add_u32 v224, 4294959104, v224
  ds_read_b128 v[104:107], v224 offset:2048
  v_mov_b32 v26, v24
  v_mfma_f32_16x16x32_bf16 v[56:59], v[80:83], v[148:151], v[56:59]
  ds_read_b128 v[108:111], v224 offset:3072
  v_mov_b32 v30, v28
  v_mfma_f32_16x16x32_bf16 v[36:39], v[84:87], v[144:147], v[36:39]
  ds_read_b128 v[112:115], v224 offset:6144
  v_mov_b32 v27, v25
  v_mfma_f32_16x16x32_bf16 v[60:63], v[84:87], v[148:151], v[60:63]
  ds_read_b128 v[116:119], v224 offset:7168
  v_mov_b32 v31, v29
  s_waitcnt lgkmcnt(6)
  v_mfma_f32_16x16x32_bf16 v[40:43], v[88:91], v[144:147], v[40:43]
  ds_read_b128 v[120:123], v224 offset:10240
  v_permlane32_swap_b32 v24, v26
  v_mfma_f32_16x16x32_bf16 v[64:67], v[88:91], v[148:151], v[64:67]
  ds_read_b128 v[124:127], v224 offset:11264
  v_permlane32_swap_b32 v28, v30
  v_mfma_f32_16x16x32_bf16 v[44:47], v[92:95], v[144:147], v[44:47]
  v_permlane32_swap_b32 v25, v27
  v_mfma_f32_16x16x32_bf16 v[68:71], v[92:95], v[148:151], v[68:71]
  v_permlane32_swap_b32 v29, v31
  s_waitcnt lgkmcnt(6)
  v_mfma_f32_16x16x32_bf16 v[48:51], v[96:99], v[144:147], v[48:51]
  v_pk_add_f32 v[24:25], v[24:25], v[26:27]
  v_mfma_f32_16x16x32_bf16 v[72:75], v[96:99], v[148:151], v[72:75]
  v_pk_add_f32 v[28:29], v[28:29], v[30:31]
  v_mfma_f32_16x16x32_bf16 v[52:55], v[100:103], v[144:147], v[52:55]
  v_mul_f32 v16, 0x3b000000, v24
  v_mfma_f32_16x16x32_bf16 v[76:79], v[100:103], v[148:151], v[76:79]
  v_mul_f32 v18, 0x3b000000, v28
  s_add_u32 s7, s11, 8192
  buffer_load_dwordx4 v[200:203], v15, s[56:59], s7 offen offset:1024 sc1
  s_add_u32 s7, s11, 69632
  buffer_load_dwordx4 v[204:207], v15, s[56:59], s7 offen offset:2048 sc1
  s_add_u32 s7, s11, 8192
  buffer_load_dwordx4 v[208:211], v15, s[56:59], s7 offen offset:2048 sc1
  s_add_u32 s7, s11, 69632
  buffer_load_dwordx4 v[212:215], v15, s[56:59], s7 offen offset:3072 sc1
  s_add_u32 s7, s11, 8192
  buffer_load_dwordx4 v[216:219], v15, s[56:59], s7 offen offset:3072 sc1
  s_add_u32 s7, s11, 73728
  buffer_load_dwordx4 v[220:223], v15, s[56:59], s7 offen offset:0 sc1
  s_waitcnt vmcnt(16)
  s_waitcnt lgkmcnt(4)
  v_mfma_f32_16x16x32_bf16 v[32:35], v[104:107], v[152:155], v[32:35]
  ds_read_b128 v[80:83], v224 offset:12288
  v_mul_f32 v17, 0x3b000000, v25
  v_mfma_f32_16x16x32_bf16 v[56:59], v[104:107], v[156:159], v[56:59]
  ds_read_b128 v[84:87], v224 offset:13312
  v_mul_f32 v19, 0x3b000000, v29
  v_mfma_f32_16x16x32_bf16 v[36:39], v[108:111], v[152:155], v[36:39]
  ds_read_b128 v[88:91], v224 offset:16384
  v_fma_f32 v17, -v16, v16, v17
  v_mfma_f32_16x16x32_bf16 v[60:63], v[108:111], v[156:159], v[60:63]
  ds_read_b128 v[92:95], v224 offset:17408
  v_fma_f32 v19, -v18, v18, v19
  s_waitcnt lgkmcnt(6)
  v_mfma_f32_16x16x32_bf16 v[40:43], v[112:115], v[152:155], v[40:43]
  ds_read_b128 v[96:99], v224 offset:20480
  v_max_f32 v17, 0, v17
  v_mfma_f32_16x16x32_bf16 v[64:67], v[112:115], v[156:159], v[64:67]
  ds_read_b128 v[100:103], v224 offset:21504
  v_max_f32 v19, 0, v19
  v_mfma_f32_16x16x32_bf16 v[44:47], v[116:119], v[152:155], v[44:47]
  v_cvt_pk_bf16_f32 v24, v16, v16
  v_mfma_f32_16x16x32_bf16 v[68:71], v[116:119], v[156:159], v[68:71]
  v_cvt_pk_bf16_f32 v28, v18, v18
  s_waitcnt lgkmcnt(6)
  v_mfma_f32_16x16x32_bf16 v[48:51], v[120:123], v[152:155], v[48:51]
  v_lshlrev_b32 v16, 16, v24
  v_mfma_f32_16x16x32_bf16 v[72:75], v[120:123], v[156:159], v[72:75]
  v_lshlrev_b32 v18, 16, v28
  v_mfma_f32_16x16x32_bf16 v[52:55], v[124:127], v[152:155], v[52:55]
  v_cvt_pk_bf16_f32 v25, v17, v17
  v_mfma_f32_16x16x32_bf16 v[76:79], v[124:127], v[156:159], v[76:79]
  v_cvt_pk_bf16_f32 v29, v19, v19
  s_add_u32 s7, s11, 12288
  buffer_load_dwordx4 v[128:131], v15, s[56:59], s7 offen offset:0 sc1
  s_add_u32 s7, s11, 73728
  buffer_load_dwordx4 v[132:135], v15, s[56:59], s7 offen offset:1024 sc1
  s_add_u32 s7, s11, 12288
  buffer_load_dwordx4 v[136:139], v15, s[56:59], s7 offen offset:1024 sc1
  s_add_u32 s7, s11, 73728
  buffer_load_dwordx4 v[140:143], v15, s[56:59], s7 offen offset:2048 sc1
  s_add_u32 s7, s11, 12288
  buffer_load_dwordx4 v[144:147], v15, s[56:59], s7 offen offset:2048 sc1
  s_add_u32 s7, s11, 73728
  buffer_load_dwordx4 v[148:151], v15, s[56:59], s7 offen offset:3072 sc1
  s_waitcnt vmcnt(20)
  s_waitcnt lgkmcnt(4)
  v_mfma_f32_16x16x32_bf16 v[32:35], v[80:83], v[160:163], v[32:35]
  ds_read_b128 v[104:107], v224 offset:14336
  v_lshlrev_b32 v17, 16, v25
  v_mfma_f32_16x16x32_bf16 v[56:59], v[80:83], v[164:167], v[56:59]
  ds_read_b128 v[108:111], v224 offset:15360
  v_lshlrev_b32 v19, 16, v29
  v_mfma_f32_16x16x32_bf16 v[36:39], v[84:87], v[160:163], v[36:39]
  ds_read_b128 v[112:115], v224 offset:18432
  v_add_f32 v17, 0x3727c5ac, v17
  v_mfma_f32_16x16x32_bf16 v[60:63], v[84:87], v[164:167], v[60:63]
  ds_read_b128 v[116:119], v224 offset:19456
  v_add_f32 v19, 0x3727c5ac, v19
  s_waitcnt lgkmcnt(6)
  v_mfma_f32_16x16x32_bf16 v[40:43], v[88:91], v[160:163], v[40:43]
  ds_read_b128 v[120:123], v224 offset:22528
  v_cvt_pk_bf16_f32 v25, v17, v17
  v_mfma_f32_16x16x32_bf16 v[64:67], v[88:91], v[164:167], v[64:67]
  ds_read_b128 v[124:127], v224 offset:23552
  v_cvt_pk_bf16_f32 v29, v19, v19
  v_mfma_f32_16x16x32_bf16 v[44:47], v[92:95], v[160:163], v[44:47]
  v_lshlrev_b32 v17, 16, v25
  v_mfma_f32_16x16x32_bf16 v[68:71], v[92:95], v[164:167], v[68:71]
  v_lshlrev_b32 v19, 16, v29
  s_waitcnt lgkmcnt(6)
  v_mfma_f32_16x16x32_bf16 v[48:51], v[96:99], v[160:163], v[48:51]
  v_sqrt_f32 v17, v17
  v_mfma_f32_16x16x32_bf16 v[72:75], v[96:99], v[164:167], v[72:75]
  v_sqrt_f32 v19, v19
  v_mfma_f32_16x16x32_bf16 v[52:55], v[100:103], v[160:163], v[52:55]
  v_cvt_pk_bf16_f32 v25, v17, v17
  v_mfma_f32_16x16x32_bf16 v[76:79], v[100:103], v[164:167], v[76:79]
  v_cvt_pk_bf16_f32 v29, v19, v19
  s_add_u32 s7, s11, 12288
  buffer_load_dwordx4 v[152:155], v15, s[56:59], s7 offen offset:3072 sc1
  s_add_u32 s7, s11, 77824
  buffer_load_dwordx4 v[156:159], v15, s[56:59], s7 offen offset:0 sc1
  s_add_u32 s6, s15, 13
  s_mov_b64 exec, 1
  v_mov_b32 v232, s6
  ds_write_b32 v233, v232
  s_mov_b64 exec, -1
  s_waitcnt vmcnt(20)
  s_waitcnt lgkmcnt(4)
  v_mfma_f32_16x16x32_bf16 v[32:35], v[104:107], v[168:171], v[32:35]
  ds_read_b128 v[80:83], v224 offset:24576
  v_lshlrev_b32 v17, 16, v25
  v_mfma_f32_16x16x32_bf16 v[56:59], v[104:107], v[172:175], v[56:59]
  ds_read_b128 v[84:87], v224 offset:25600
  v_lshlrev_b32 v19, 16, v29
  v_mfma_f32_16x16x32_bf16 v[36:39], v[108:111], v[168:171], v[36:39]
  ds_read_b128 v[88:91], v224 offset:28672
  v_rcp_f32 v17, v17
  v_mfma_f32_16x16x32_bf16 v[60:63], v[108:111], v[172:175], v[60:63]
  ds_read_b128 v[92:95], v224 offset:29696
  v_rcp_f32 v19, v19
  s_waitcnt lgkmcnt(6)
  v_mfma_f32_16x16x32_bf16 v[40:43], v[112:115], v[168:171], v[40:43]
  ds_read_b128 v[96:99], v224 offset:32768
  v_mul_f32 v16, -v16, v17
  v_mfma_f32_16x16x32_bf16 v[64:67], v[112:115], v[172:175], v[64:67]
  ds_read_b128 v[100:103], v224 offset:33792
  v_mul_f32 v18, -v18, v19
  v_mfma_f32_16x16x32_bf16 v[44:47], v[116:119], v[168:171], v[44:47]
  v_mfma_f32_16x16x32_bf16 v[68:71], v[116:119], v[172:175], v[68:71]
  s_waitcnt lgkmcnt(6)
  v_mfma_f32_16x16x32_bf16 v[48:51], v[120:123], v[168:171], v[48:51]
  v_mfma_f32_16x16x32_bf16 v[72:75], v[120:123], v[172:175], v[72:75]
  v_mfma_f32_16x16x32_bf16 v[52:55], v[124:127], v[168:171], v[52:55]
  v_mfma_f32_16x16x32_bf16 v[76:79], v[124:127], v[172:175], v[76:79]
  s_add_u32 s6, s15, 14
  s_mov_b64 exec, 1
  v_mov_b32 v232, s6
  ds_write_b32 v233, v232
  s_mov_b64 exec, -1
  s_waitcnt vmcnt(18)
  s_waitcnt lgkmcnt(4)
  v_mfma_f32_16x16x32_bf16 v[32:35], v[80:83], v[176:179], v[32:35]
  ds_read_b128 v[104:107], v224 offset:26624
  v_mfma_f32_16x16x32_bf16 v[56:59], v[80:83], v[180:183], v[56:59]
  ds_read_b128 v[108:111], v224 offset:27648
  v_mfma_f32_16x16x32_bf16 v[36:39], v[84:87], v[176:179], v[36:39]
  ds_read_b128 v[112:115], v224 offset:30720
  v_mfma_f32_16x16x32_bf16 v[60:63], v[84:87], v[180:183], v[60:63]
  ds_read_b128 v[116:119], v224 offset:31744
  s_waitcnt lgkmcnt(6)
  v_mfma_f32_16x16x32_bf16 v[40:43], v[88:91], v[176:179], v[40:43]
  ds_read_b128 v[120:123], v224 offset:34816
  v_mfma_f32_16x16x32_bf16 v[64:67], v[88:91], v[180:183], v[64:67]
  ds_read_b128 v[124:127], v224 offset:35840
  v_mfma_f32_16x16x32_bf16 v[44:47], v[92:95], v[176:179], v[44:47]
  v_mfma_f32_16x16x32_bf16 v[68:71], v[92:95], v[180:183], v[68:71]
  s_waitcnt lgkmcnt(6)
  v_mfma_f32_16x16x32_bf16 v[48:51], v[96:99], v[176:179], v[48:51]
  v_mfma_f32_16x16x32_bf16 v[72:75], v[96:99], v[180:183], v[72:75]
  v_mfma_f32_16x16x32_bf16 v[52:55], v[100:103], v[176:179], v[52:55]
  v_mfma_f32_16x16x32_bf16 v[76:79], v[100:103], v[180:183], v[76:79]
  s_waitcnt vmcnt(16)
  s_waitcnt lgkmcnt(4)
  v_mfma_f32_16x16x32_bf16 v[32:35], v[104:107], v[184:187], v[32:35]
  ds_read_b128 v[80:83], v224 offset:36864
  v_mfma_f32_16x16x32_bf16 v[56:59], v[104:107], v[188:191], v[56:59]
  ds_read_b128 v[84:87], v224 offset:37888
  v_mfma_f32_16x16x32_bf16 v[36:39], v[108:111], v[184:187], v[36:39]
  ds_read_b128 v[88:91], v224 offset:40960
  v_mfma_f32_16x16x32_bf16 v[60:63], v[108:111], v[188:191], v[60:63]
  ds_read_b128 v[92:95], v224 offset:41984
  s_waitcnt lgkmcnt(6)
  v_mfma_f32_16x16x32_bf16 v[40:43], v[112:115], v[184:187], v[40:43]
  ds_read_b128 v[96:99], v224 offset:45056
  v_mfma_f32_16x16x32_bf16 v[64:67], v[112:115], v[188:191], v[64:67]
  ds_read_b128 v[100:103], v224 offset:46080
  v_mfma_f32_16x16x32_bf16 v[44:47], v[116:119], v[184:187], v[44:47]
  v_mfma_f32_16x16x32_bf16 v[68:71], v[116:119], v[188:191], v[68:71]
  s_waitcnt lgkmcnt(6)
  v_mfma_f32_16x16x32_bf16 v[48:51], v[120:123], v[184:187], v[48:51]
  v_mfma_f32_16x16x32_bf16 v[72:75], v[120:123], v[188:191], v[72:75]
  v_mfma_f32_16x16x32_bf16 v[52:55], v[124:127], v[184:187], v[52:55]
  v_mfma_f32_16x16x32_bf16 v[76:79], v[124:127], v[188:191], v[76:79]
  s_add_u32 s6, s15, 15
  s_mov_b64 exec, 1
  v_mov_b32 v232, s6
  ds_write_b32 v233, v232
  s_mov_b64 exec, -1
  s_waitcnt vmcnt(14)
  s_waitcnt lgkmcnt(4)
  v_mfma_f32_16x16x32_bf16 v[32:35], v[80:83], v[192:195], v[32:35]
  ds_read_b128 v[104:107], v224 offset:38912
  v_mfma_f32_16x16x32_bf16 v[56:59], v[80:83], v[196:199], v[56:59]
  ds_read_b128 v[108:111], v224 offset:39936
  v_mfma_f32_16x16x32_bf16 v[36:39], v[84:87], v[192:195], v[36:39]
  ds_read_b128 v[112:115], v224 offset:43008
  v_mfma_f32_16x16x32_bf16 v[60:63], v[84:87], v[196:199], v[60:63]
  ds_read_b128 v[116:119], v224 offset:44032
  s_waitcnt lgkmcnt(6)
  v_mfma_f32_16x16x32_bf16 v[40:43], v[88:91], v[192:195], v[40:43]
  ds_read_b128 v[120:123], v224 offset:47104
  v_mfma_f32_16x16x32_bf16 v[64:67], v[88:91], v[196:199], v[64:67]
  ds_read_b128 v[124:127], v224 offset:48128
  v_mfma_f32_16x16x32_bf16 v[44:47], v[92:95], v[192:195], v[44:47]
  v_mfma_f32_16x16x32_bf16 v[68:71], v[92:95], v[196:199], v[68:71]
  s_waitcnt lgkmcnt(6)
  v_mfma_f32_16x16x32_bf16 v[48:51], v[96:99], v[192:195], v[48:51]
  v_mfma_f32_16x16x32_bf16 v[72:75], v[96:99], v[196:199], v[72:75]
  v_mfma_f32_16x16x32_bf16 v[52:55], v[100:103], v[192:195], v[52:55]
  v_mfma_f32_16x16x32_bf16 v[76:79], v[100:103], v[196:199], v[76:79]
  s_waitcnt vmcnt(12)
  s_waitcnt lgkmcnt(4)
  v_mfma_f32_16x16x32_bf16 v[32:35], v[104:107], v[200:203], v[32:35]
  ds_read_b128 v[80:83], v224 offset:49152
  v_mfma_f32_16x16x32_bf16 v[56:59], v[104:107], v[204:207], v[56:59]
  ds_read_b128 v[84:87], v224 offset:50176
  v_mfma_f32_16x16x32_bf16 v[36:39], v[108:111], v[200:203], v[36:39]
  ds_read_b128 v[88:91], v224 offset:53248
  v_mfma_f32_16x16x32_bf16 v[60:63], v[108:111], v[204:207], v[60:63]
  ds_read_b128 v[92:95], v224 offset:54272
  s_waitcnt lgkmcnt(6)
  v_mfma_f32_16x16x32_bf16 v[40:43], v[112:115], v[200:203], v[40:43]
  v_add_u32 v224, 36864, v224
  ds_read_b128 v[96:99], v224 offset:36864
  v_mfma_f32_16x16x32_bf16 v[64:67], v[112:115], v[204:207], v[64:67]
  ds_read_b128 v[100:103], v224 offset:37888
  v_mfma_f32_16x16x32_bf16 v[44:47], v[116:119], v[200:203], v[44:47]
  v_mfma_f32_16x16x32_bf16 v[68:71], v[116:119], v[204:207], v[68:71]
  s_waitcnt lgkmcnt(6)
  v_mfma_f32_16x16x32_bf16 v[48:51], v[120:123], v[200:203], v[48:51]
  v_mfma_f32_16x16x32_bf16 v[72:75], v[120:123], v[204:207], v[72:75]
  v_mfma_f32_16x16x32_bf16 v[52:55], v[124:127], v[200:203], v[52:55]
  v_mfma_f32_16x16x32_bf16 v[76:79], v[124:127], v[204:207], v[76:79]
  s_waitcnt vmcnt(10)
  s_waitcnt lgkmcnt(4)
  v_mfma_f32_16x16x32_bf16 v[32:35], v[80:83], v[208:211], v[32:35]
  ds_read_b128 v[160:163], v22 offset:0
  ds_read_b128 v[184:187], v22 offset:1024
  v_mfma_f32_16x16x32_bf16 v[56:59], v[80:83], v[212:215], v[56:59]
  ds_read_b128 v[164:167], v22 offset:64
  ds_read_b128 v[188:191], v22 offset:1088
  v_mfma_f32_16x16x32_bf16 v[36:39], v[84:87], v[208:211], v[36:39]
  ds_read_b128 v[168:171], v22 offset:128
  ds_read_b128 v[192:195], v22 offset:1152
  v_mfma_f32_16x16x32_bf16 v[60:63], v[84:87], v[212:215], v[60:63]
  ds_read_b128 v[172:175], v22 offset:192
  ds_read_b128 v[196:199], v22 offset:1216
  s_waitcnt lgkmcnt(10)
  v_mfma_f32_16x16x32_bf16 v[40:43], v[88:91], v[208:211], v[40:43]
  ds_read_b128 v[176:179], v22 offset:256
  ds_read_b128 v[200:203], v22 offset:1280
  v_mfma_f32_16x16x32_bf16 v[64:67], v[88:91], v[212:215], v[64:67]
  ds_read_b128 v[180:183], v22 offset:320
  ds_read_b128 v[204:207], v22 offset:1344
  v_mfma_f32_16x16x32_bf16 v[44:47], v[92:95], v[208:211], v[44:47]
  ds_read_b128 v[104:107], v224 offset:14336
  ds_read_b128 v[108:111], v224 offset:15360
  v_mfma_f32_16x16x32_bf16 v[68:71], v[92:95], v[212:215], v[68:71]
  ds_read_b128 v[112:115], v224 offset:18432
  ds_read_b128 v[116:119], v224 offset:19456
  s_waitcnt lgkmcnt(15)
  v_mfma_f32_16x16x32_bf16 v[48:51], v[96:99], v[208:211], v[48:51]
  ds_read_b128 v[120:123], v224 offset:38912
  ds_read_b128 v[124:127], v224 offset:39936
  v_mfma_f32_16x16x32_bf16 v[72:75], v[96:99], v[212:215], v[72:75]
  v_mfma_f32_16x16x32_bf16 v[52:55], v[100:103], v[208:211], v[52:55]
  v_mfma_f32_16x16x32_bf16 v[76:79], v[100:103], v[212:215], v[76:79]
  s_waitcnt vmcnt(8)
  s_waitcnt lgkmcnt(4)
  v_mfma_f32_16x16x32_bf16 v[32:35], v[104:107], v[216:219], v[32:35]
  ds_read_b128 v[80:83], v224 offset:40960
  v_mfma_f32_16x16x32_bf16 v[56:59], v[104:107], v[220:223], v[56:59]
  ds_read_b128 v[84:87], v224 offset:41984
  v_mfma_f32_16x16x32_bf16 v[36:39], v[108:111], v[216:219], v[36:39]
  ds_read_b128 v[88:91], v224 offset:45056
  v_mfma_f32_16x16x32_bf16 v[60:63], v[108:111], v[220:223], v[60:63]
  ds_read_b128 v[92:95], v224 offset:46080
  s_waitcnt lgkmcnt(6)
  v_mfma_f32_16x16x32_bf16 v[40:43], v[112:115], v[216:219], v[40:43]
  ds_read_b128 v[96:99], v224 offset:49152
  v_mfma_f32_16x16x32_bf16 v[64:67], v[112:115], v[220:223], v[64:67]
  ds_read_b128 v[100:103], v224 offset:50176
  v_mfma_f32_16x16x32_bf16 v[44:47], v[116:119], v[216:219], v[44:47]
  v_mfma_f32_16x16x32_bf16 v[68:71], v[116:119], v[220:223], v[68:71]
  s_waitcnt lgkmcnt(6)
  v_mfma_f32_16x16x32_bf16 v[48:51], v[120:123], v[216:219], v[48:51]
  v_mfma_f32_16x16x32_bf16 v[72:75], v[120:123], v[220:223], v[72:75]
  v_mfma_f32_16x16x32_bf16 v[52:55], v[124:127], v[216:219], v[52:55]
  v_mfma_f32_16x16x32_bf16 v[76:79], v[124:127], v[220:223], v[76:79]
  s_add_u32 s6, s15, 16
  s_mov_b64 exec, 1
  v_mov_b32 v232, s6
  ds_write_b32 v233, v232
  s_mov_b64 exec, -1
  s_waitcnt vmcnt(6)
  s_waitcnt lgkmcnt(4)
  v_mfma_f32_16x16x32_bf16 v[32:35], v[80:83], v[128:131], v[32:35]
  ds_read_b128 v[104:107], v224 offset:43008
  v_add_f32 v160, v160, v184
  v_add_f32 v161, v161, v185
  v_mfma_f32_16x16x32_bf16 v[56:59], v[80:83], v[132:135], v[56:59]
  ds_read_b128 v[108:111], v224 offset:44032
  v_add_f32 v162, v162, v186
  v_add_f32 v163, v163, v187
  v_mfma_f32_16x16x32_bf16 v[36:39], v[84:87], v[128:131], v[36:39]
  ds_read_b128 v[112:115], v224 offset:47104
  v_add_f32 v164, v164, v188
  v_add_f32 v165, v165, v189
  v_mfma_f32_16x16x32_bf16 v[60:63], v[84:87], v[132:135], v[60:63]
  ds_read_b128 v[116:119], v224 offset:48128
  v_add_f32 v166, v166, v190
  v_add_f32 v167, v167, v191
  s_waitcnt lgkmcnt(6)
  v_mfma_f32_16x16x32_bf16 v[40:43], v[88:91], v[128:131], v[40:43]
  ds_read_b128 v[120:123], v224 offset:51200
  v_add_f32 v168, v168, v192
  v_add_f32 v169, v169, v193
  v_mfma_f32_16x16x32_bf16 v[64:67], v[88:91], v[132:135], v[64:67]
  ds_read_b128 v[124:127], v224 offset:52224
  v_add_f32 v170, v170, v194
  v_add_f32 v171, v171, v195
  v_mfma_f32_16x16x32_bf16 v[44:47], v[92:95], v[128:131], v[44:47]
  v_add_f32 v172, v172, v196
  v_add_f32 v173, v173, v197
  v_mfma_f32_16x16x32_bf16 v[68:71], v[92:95], v[132:135], v[68:71]
  v_add_f32 v174, v174, v198
  v_add_f32 v175, v175, v199
  s_waitcnt lgkmcnt(6)
  v_mfma_f32_16x16x32_bf16 v[48:51], v[96:99], v[128:131], v[48:51]
  v_add_f32 v176, v176, v200
  v_add_f32 v177, v177, v201
  v_mfma_f32_16x16x32_bf16 v[72:75], v[96:99], v[132:135], v[72:75]
  v_add_f32 v178, v178, v202
  v_add_f32 v179, v179, v203
  v_mfma_f32_16x16x32_bf16 v[52:55], v[100:103], v[128:131], v[52:55]
  v_add_f32 v180, v180, v204
  v_add_f32 v181, v181, v205
  v_mfma_f32_16x16x32_bf16 v[76:79], v[100:103], v[132:135], v[76:79]
  v_add_f32 v182, v182, v206
  v_add_f32 v183, v183, v207
  s_waitcnt vmcnt(4)
  s_waitcnt lgkmcnt(4)
  v_mfma_f32_16x16x32_bf16 v[32:35], v[104:107], v[136:139], v[32:35]
  ds_read_b128 v[80:83], v224 offset:53248
  v_mul_f32 v184, v160, v18
  v_mul_f32 v185, v161, v18
  v_mfma_f32_16x16x32_bf16 v[56:59], v[104:107], v[140:143], v[56:59]
  ds_read_b128 v[84:87], v224 offset:54272
  v_mul_f32 v186, v162, v18
  v_mul_f32 v187, v163, v18
  v_mfma_f32_16x16x32_bf16 v[36:39], v[108:111], v[136:139], v[36:39]
  ds_read_b128 v[88:91], v224 offset:57344
  v_mul_f32 v188, v164, v18
  v_mul_f32 v189, v165, v18
  v_mfma_f32_16x16x32_bf16 v[60:63], v[108:111], v[140:143], v[60:63]
  ds_read_b128 v[92:95], v224 offset:58368
  v_mul_f32 v190, v166, v18
  v_mul_f32 v191, v167, v18
  s_waitcnt lgkmcnt(6)
  v_mfma_f32_16x16x32_bf16 v[40:43], v[112:115], v[136:139], v[40:43]
  ds_read_b128 v[96:99], v224 offset:61440
  v_mul_f32 v192, v168, v18
  v_mul_f32 v193, v169, v18
  v_mfma_f32_16x16x32_bf16 v[64:67], v[112:115], v[140:143], v[64:67]
  ds_read_b128 v[100:103], v224 offset:62464
  v_mul_f32 v194, v170, v18
  v_mul_f32 v195, v171, v18
  v_mfma_f32_16x16x32_bf16 v[44:47], v[116:119], v[136:139], v[44:47]
  v_mul_f32 v196, v172, v18
  v_mul_f32 v197, v173, v18
  v_mfma_f32_16x16x32_bf16 v[68:71], v[116:119], v[140:143], v[68:71]
  v_mul_f32 v198, v174, v18
  v_mul_f32 v199, v175, v18
  s_waitcnt lgkmcnt(6)
  v_mfma_f32_16x16x32_bf16 v[48:51], v[120:123], v[136:139], v[48:51]
  v_mul_f32 v200, v176, v18
  v_mul_f32 v201, v177, v18
  v_mfma_f32_16x16x32_bf16 v[72:75], v[120:123], v[140:143], v[72:75]
  v_mul_f32 v202, v178, v18
  v_mul_f32 v203, v179, v18
  v_mfma_f32_16x16x32_bf16 v[52:55], v[124:127], v[136:139], v[52:55]
  v_mul_f32 v204, v180, v18
  v_mul_f32 v205, v181, v18
  v_mfma_f32_16x16x32_bf16 v[76:79], v[124:127], v[140:143], v[76:79]
  v_mul_f32 v206, v182, v18
  v_mul_f32 v207, v183, v18
  s_waitcnt vmcnt(2)
  s_waitcnt lgkmcnt(4)
  v_mfma_f32_16x16x32_bf16 v[32:35], v[80:83], v[144:147], v[32:35]
  ds_read_b128 v[104:107], v224 offset:55296
  v_mul_f32 v160, v160, v16
  v_mul_f32 v161, v161, v16
  v_mfma_f32_16x16x32_bf16 v[56:59], v[80:83], v[148:151], v[56:59]
  ds_read_b128 v[108:111], v224 offset:56320
  v_mul_f32 v162, v162, v16
  v_mul_f32 v163, v163, v16
  v_mfma_f32_16x16x32_bf16 v[36:39], v[84:87], v[144:147], v[36:39]
  ds_read_b128 v[112:115], v224 offset:59392
  v_mul_f32 v164, v164, v16
  v_mul_f32 v165, v165, v16
  v_mfma_f32_16x16x32_bf16 v[60:63], v[84:87], v[148:151], v[60:63]
  ds_read_b128 v[116:119], v224 offset:60416
  v_mul_f32 v166, v166, v16
  v_mul_f32 v167, v167, v16
  s_waitcnt lgkmcnt(6)
  v_mfma_f32_16x16x32_bf16 v[40:43], v[88:91], v[144:147], v[40:43]
  ds_read_b128 v[120:123], v224 offset:63488
  v_mul_f32 v168, v168, v16
  v_mul_f32 v169, v169, v16
  v_mfma_f32_16x16x32_bf16 v[64:67], v[88:91], v[148:151], v[64:67]
  ds_read_b128 v[124:127], v224 offset:64512
  v_mul_f32 v170, v170, v16
  v_mul_f32 v171, v171, v16
  v_mfma_f32_16x16x32_bf16 v[44:47], v[92:95], v[144:147], v[44:47]
  v_mul_f32 v172, v172, v16
  v_mul_f32 v173, v173, v16
  v_mfma_f32_16x16x32_bf16 v[68:71], v[92:95], v[148:151], v[68:71]
  v_mul_f32 v174, v174, v16
  v_mul_f32 v175, v175, v16
  s_waitcnt lgkmcnt(6)
  v_mfma_f32_16x16x32_bf16 v[48:51], v[96:99], v[144:147], v[48:51]
  v_mul_f32 v176, v176, v16
  v_mul_f32 v177, v177, v16
  v_mfma_f32_16x16x32_bf16 v[72:75], v[96:99], v[148:151], v[72:75]
  v_mul_f32 v178, v178, v16
  v_mul_f32 v179, v179, v16
  v_mfma_f32_16x16x32_bf16 v[52:55], v[100:103], v[144:147], v[52:55]
  v_mul_f32 v180, v180, v16
  v_mul_f32 v181, v181, v16
  v_mfma_f32_16x16x32_bf16 v[76:79], v[100:103], v[148:151], v[76:79]
  v_mul_f32 v182, v182, v16
  v_mul_f32 v183, v183, v16
  s_waitcnt vmcnt(0)
  s_waitcnt lgkmcnt(4)
  v_mfma_f32_16x16x32_bf16 v[32:35], v[104:107], v[152:155], v[32:35]
  v_mfma_f32_16x16x32_bf16 v[56:59], v[104:107], v[156:159], v[56:59]
  v_mfma_f32_16x16x32_bf16 v[36:39], v[108:111], v[152:155], v[36:39]
  v_mfma_f32_16x16x32_bf16 v[60:63], v[108:111], v[156:159], v[60:63]
  s_waitcnt lgkmcnt(2)
  v_mfma_f32_16x16x32_bf16 v[40:43], v[112:115], v[152:155], v[40:43]
  v_mfma_f32_16x16x32_bf16 v[64:67], v[112:115], v[156:159], v[64:67]
  v_mfma_f32_16x16x32_bf16 v[44:47], v[116:119], v[152:155], v[44:47]
  v_mfma_f32_16x16x32_bf16 v[68:71], v[116:119], v[156:159], v[68:71]
  s_waitcnt lgkmcnt(0)
  v_mfma_f32_16x16x32_bf16 v[48:51], v[120:123], v[152:155], v[48:51]
  v_mfma_f32_16x16x32_bf16 v[72:75], v[120:123], v[156:159], v[72:75]
  v_mfma_f32_16x16x32_bf16 v[52:55], v[124:127], v[152:155], v[52:55]
  v_mfma_f32_16x16x32_bf16 v[76:79], v[124:127], v[156:159], v[76:79]
  s_add_u32 s6, s15, 17
  s_mov_b64 exec, 1
  v_mov_b32 v232, s6
  ds_write_b32 v233, v232
  s_mov_b64 exec, -1
  v_pk_fma_f32 v[32:33], v[32:33], v[16:17], v[160:161] op_sel:[0,1,0] op_sel_hi:[1,1,1]
  v_pk_fma_f32 v[36:37], v[36:37], v[16:17], v[164:165] op_sel:[0,1,0] op_sel_hi:[1,1,1]
  v_pk_fma_f32 v[56:57], v[56:57], v[18:19], v[184:185] op_sel:[0,1,0] op_sel_hi:[1,1,1]
  v_pk_fma_f32 v[60:61], v[60:61], v[18:19], v[188:189] op_sel:[0,1,0] op_sel_hi:[1,1,1]
  v_pk_fma_f32 v[34:35], v[34:35], v[16:17], v[162:163] op_sel:[0,1,0] op_sel_hi:[1,1,1]
  v_pk_fma_f32 v[38:39], v[38:39], v[16:17], v[166:167] op_sel:[0,1,0] op_sel_hi:[1,1,1]
  v_pk_fma_f32 v[58:59], v[58:59], v[18:19], v[186:187] op_sel:[0,1,0] op_sel_hi:[1,1,1]
  v_pk_fma_f32 v[62:63], v[62:63], v[18:19], v[190:191] op_sel:[0,1,0] op_sel_hi:[1,1,1]
  v_cvt_pk_bf16_f32 v24, v32, v33
  v_cvt_pk_bf16_f32 v26, v36, v37
  v_cvt_pk_bf16_f32 v28, v56, v57
  v_cvt_pk_bf16_f32 v30, v60, v61
  v_cvt_pk_bf16_f32 v25, v34, v35
  v_cvt_pk_bf16_f32 v27, v38, v39
  v_cvt_pk_bf16_f32 v29, v58, v59
  v_cvt_pk_bf16_f32 v31, v62, v63
  v_lshlrev_b32 v32, 16, v24
  v_lshlrev_b32 v36, 16, v26
  v_lshlrev_b32 v56, 16, v28
  v_lshlrev_b32 v60, 16, v30
  v_and_b32 v33, 0xffff0000, v24
  v_and_b32 v37, 0xffff0000, v26
  v_and_b32 v57, 0xffff0000, v28
  v_and_b32 v61, 0xffff0000, v30
  v_lshlrev_b32 v34, 16, v25
  v_lshlrev_b32 v38, 16, v27
  v_lshlrev_b32 v58, 16, v29
  v_lshlrev_b32 v62, 16, v31
  v_and_b32 v35, 0xffff0000, v25
  v_and_b32 v39, 0xffff0000, v27
  v_and_b32 v59, 0xffff0000, v29
  v_and_b32 v63, 0xffff0000, v31
  v_pk_mul_f32 v[96:97], v[32:33], v[32:33]
  v_pk_mul_f32 v[100:101], v[36:37], v[36:37]
  v_pk_mul_f32 v[104:105], v[56:57], v[56:57]
  v_pk_mul_f32 v[108:109], v[60:61], v[60:61]
  v_pk_mul_f32 v[98:99], v[34:35], v[34:35]
  v_pk_mul_f32 v[102:103], v[38:39], v[38:39]
  v_pk_mul_f32 v[106:107], v[58:59], v[58:59]
  v_pk_mul_f32 v[110:111], v[62:63], v[62:63]
  v_pk_fma_f32 v[96:97], v[96:97], v[6:7], v[4:5]
  v_pk_fma_f32 v[100:101], v[100:101], v[6:7], v[4:5]
  v_pk_fma_f32 v[104:105], v[104:105], v[6:7], v[4:5]
  v_pk_fma_f32 v[108:109], v[108:109], v[6:7], v[4:5]
  v_pk_fma_f32 v[98:99], v[98:99], v[6:7], v[4:5]
  v_pk_fma_f32 v[102:103], v[102:103], v[6:7], v[4:5]
  v_pk_fma_f32 v[106:107], v[106:107], v[6:7], v[4:5]
  v_pk_fma_f32 v[110:111], v[110:111], v[6:7], v[4:5]
  v_pk_mul_f32 v[96:97], v[96:97], v[32:33]
  v_pk_mul_f32 v[100:101], v[100:101], v[36:37]
  v_pk_mul_f32 v[104:105], v[104:105], v[56:57]
  v_pk_mul_f32 v[108:109], v[108:109], v[60:61]
  v_pk_mul_f32 v[98:99], v[98:99], v[34:35]
  v_pk_mul_f32 v[102:103], v[102:103], v[38:39]
  v_pk_mul_f32 v[106:107], v[106:107], v[58:59]
  v_pk_mul_f32 v[110:111], v[110:111], v[62:63]
  v_exp_f32 v96, v96
  v_exp_f32 v100, v100
  v_exp_f32 v104, v104
  v_exp_f32 v108, v108
  v_exp_f32 v97, v97
  v_exp_f32 v101, v101
  v_exp_f32 v105, v105
  v_exp_f32 v109, v109
  v_exp_f32 v98, v98
  v_exp_f32 v102, v102
  v_exp_f32 v106, v106
  v_exp_f32 v110, v110
  v_exp_f32 v99, v99
  v_exp_f32 v103, v103
  v_exp_f32 v107, v107
  v_exp_f32 v111, v111
  v_pk_add_f32 v[96:97], v[96:97], 1.0 op_sel_hi:[1,0]
  v_pk_add_f32 v[100:101], v[100:101], 1.0 op_sel_hi:[1,0]
  v_pk_add_f32 v[104:105], v[104:105], 1.0 op_sel_hi:[1,0]
  v_pk_add_f32 v[108:109], v[108:109], 1.0 op_sel_hi:[1,0]
  v_pk_add_f32 v[98:99], v[98:99], 1.0 op_sel_hi:[1,0]
  v_pk_add_f32 v[102:103], v[102:103], 1.0 op_sel_hi:[1,0]
  v_pk_add_f32 v[106:107], v[106:107], 1.0 op_sel_hi:[1,0]
  v_pk_add_f32 v[110:111], v[110:111], 1.0 op_sel_hi:[1,0]
  v_rcp_f32 v96, v96
  v_rcp_f32 v100, v100
  v_rcp_f32 v104, v104
  v_rcp_f32 v108, v108
  v_rcp_f32 v97, v97
  v_rcp_f32 v101, v101
  v_rcp_f32 v105, v105
  v_rcp_f32 v109, v109
  v_rcp_f32 v98, v98
  v_rcp_f32 v102, v102
  v_rcp_f32 v106, v106
  v_rcp_f32 v110, v110
  v_rcp_f32 v99, v99
  v_rcp_f32 v103, v103
  v_rcp_f32 v107, v107
  v_rcp_f32 v111, v111
  v_pk_mul_f32 v[32:33], v[32:33], v[96:97]
  v_pk_mul_f32 v[36:37], v[36:37], v[100:101]
  v_pk_mul_f32 v[56:57], v[56:57], v[104:105]
  v_pk_mul_f32 v[60:61], v[60:61], v[108:109]
  v_pk_mul_f32 v[34:35], v[34:35], v[98:99]
  v_pk_mul_f32 v[38:39], v[38:39], v[102:103]
  v_pk_mul_f32 v[58:59], v[58:59], v[106:107]
  v_pk_mul_f32 v[62:63], v[62:63], v[110:111]
  v_cvt_pk_bf16_f32 v112, v32, v33
  v_cvt_pk_bf16_f32 v114, v36, v37
  v_cvt_pk_bf16_f32 v116, v56, v57
  v_cvt_pk_bf16_f32 v118, v60, v61
  v_cvt_pk_bf16_f32 v113, v34, v35
  v_cvt_pk_bf16_f32 v115, v38, v39
  v_cvt_pk_bf16_f32 v117, v58, v59
  v_cvt_pk_bf16_f32 v119, v62, v63
  v_permlane16_swap_b32 v112, v114
  v_permlane16_swap_b32 v113, v115
  buffer_store_dwordx4 v[112:115], v8, s[56:59], s9 offen offset:0
  v_permlane16_swap_b32 v116, v118
  v_permlane16_swap_b32 v117, v119
  buffer_store_dwordx4 v[116:119], v8, s[56:59], s12 offen offset:0
  s_cmp_eq_u32 s4, 14
  s_cbranch_scc1 LS5c_sig
  v_pk_fma_f32 v[40:41], v[40:41], v[16:17], v[168:169] op_sel:[0,1,0] op_sel_hi:[1,1,1]
  v_pk_fma_f32 v[44:45], v[44:45], v[16:17], v[172:173] op_sel:[0,1,0] op_sel_hi:[1,1,1]
  v_pk_fma_f32 v[64:65], v[64:65], v[18:19], v[192:193] op_sel:[0,1,0] op_sel_hi:[1,1,1]
  v_pk_fma_f32 v[68:69], v[68:69], v[18:19], v[196:197] op_sel:[0,1,0] op_sel_hi:[1,1,1]
  v_pk_fma_f32 v[42:43], v[42:43], v[16:17], v[170:171] op_sel:[0,1,0] op_sel_hi:[1,1,1]
  v_pk_fma_f32 v[46:47], v[46:47], v[16:17], v[174:175] op_sel:[0,1,0] op_sel_hi:[1,1,1]
  v_pk_fma_f32 v[66:67], v[66:67], v[18:19], v[194:195] op_sel:[0,1,0] op_sel_hi:[1,1,1]
  v_pk_fma_f32 v[70:71], v[70:71], v[18:19], v[198:199] op_sel:[0,1,0] op_sel_hi:[1,1,1]
  v_cvt_pk_bf16_f32 v24, v40, v41
  v_cvt_pk_bf16_f32 v26, v44, v45
  v_cvt_pk_bf16_f32 v28, v64, v65
  v_cvt_pk_bf16_f32 v30, v68, v69
  v_cvt_pk_bf16_f32 v25, v42, v43
  v_cvt_pk_bf16_f32 v27, v46, v47
  v_cvt_pk_bf16_f32 v29, v66, v67
  v_cvt_pk_bf16_f32 v31, v70, v71
  v_lshlrev_b32 v40, 16, v24
  v_lshlrev_b32 v44, 16, v26
  v_lshlrev_b32 v64, 16, v28
  v_lshlrev_b32 v68, 16, v30
  v_and_b32 v41, 0xffff0000, v24
  v_and_b32 v45, 0xffff0000, v26
  v_and_b32 v65, 0xffff0000, v28
  v_and_b32 v69, 0xffff0000, v30
  v_lshlrev_b32 v42, 16, v25
  v_lshlrev_b32 v46, 16, v27
  v_lshlrev_b32 v66, 16, v29
  v_lshlrev_b32 v70, 16, v31
  v_and_b32 v43, 0xffff0000, v25
  v_and_b32 v47, 0xffff0000, v27
  v_and_b32 v67, 0xffff0000, v29
  v_and_b32 v71, 0xffff0000, v31
  v_pk_mul_f32 v[96:97], v[40:41], v[40:41]
  v_pk_mul_f32 v[100:101], v[44:45], v[44:45]
  v_pk_mul_f32 v[104:105], v[64:65], v[64:65]
  v_pk_mul_f32 v[108:109], v[68:69], v[68:69]
  v_pk_mul_f32 v[98:99], v[42:43], v[42:43]
  v_pk_mul_f32 v[102:103], v[46:47], v[46:47]
  v_pk_mul_f32 v[106:107], v[66:67], v[66:67]
  v_pk_mul_f32 v[110:111], v[70:71], v[70:71]
  v_pk_fma_f32 v[96:97], v[96:97], v[6:7], v[4:5]
  v_pk_fma_f32 v[100:101], v[100:101], v[6:7], v[4:5]
  v_pk_fma_f32 v[104:105], v[104:105], v[6:7], v[4:5]
  v_pk_fma_f32 v[108:109], v[108:109], v[6:7], v[4:5]
  v_pk_fma_f32 v[98:99], v[98:99], v[6:7], v[4:5]
  v_pk_fma_f32 v[102:103], v[102:103], v[6:7], v[4:5]
  v_pk_fma_f32 v[106:107], v[106:107], v[6:7], v[4:5]
  v_pk_fma_f32 v[110:111], v[110:111], v[6:7], v[4:5]
  v_pk_mul_f32 v[96:97], v[96:97], v[40:41]
  v_pk_mul_f32 v[100:101], v[100:101], v[44:45]
  v_pk_mul_f32 v[104:105], v[104:105], v[64:65]
  v_pk_mul_f32 v[108:109], v[108:109], v[68:69]
  v_pk_mul_f32 v[98:99], v[98:99], v[42:43]
  v_pk_mul_f32 v[102:103], v[102:103], v[46:47]
  v_pk_mul_f32 v[106:107], v[106:107], v[66:67]
  v_pk_mul_f32 v[110:111], v[110:111], v[70:71]
  v_exp_f32 v96, v96
  v_exp_f32 v100, v100
  v_exp_f32 v104, v104
  v_exp_f32 v108, v108
  v_exp_f32 v97, v97
  v_exp_f32 v101, v101
  v_exp_f32 v105, v105
  v_exp_f32 v109, v109
  v_exp_f32 v98, v98
  v_exp_f32 v102, v102
  v_exp_f32 v106, v106
  v_exp_f32 v110, v110
  v_exp_f32 v99, v99
  v_exp_f32 v103, v103
  v_exp_f32 v107, v107
  v_exp_f32 v111, v111
  v_pk_add_f32 v[96:97], v[96:97], 1.0 op_sel_hi:[1,0]
  v_pk_add_f32 v[100:101], v[100:101], 1.0 op_sel_hi:[1,0]
  v_pk_add_f32 v[104:105], v[104:105], 1.0 op_sel_hi:[1,0]
  v_pk_add_f32 v[108:109], v[108:109], 1.0 op_sel_hi:[1,0]
  v_pk_add_f32 v[98:99], v[98:99], 1.0 op_sel_hi:[1,0]
  v_pk_add_f32 v[102:103], v[102:103], 1.0 op_sel_hi:[1,0]
  v_pk_add_f32 v[106:107], v[106:107], 1.0 op_sel_hi:[1,0]
  v_pk_add_f32 v[110:111], v[110:111], 1.0 op_sel_hi:[1,0]
  v_rcp_f32 v96, v96
  v_rcp_f32 v100, v100
  v_rcp_f32 v104, v104
  v_rcp_f32 v108, v108
  v_rcp_f32 v97, v97
  v_rcp_f32 v101, v101
  v_rcp_f32 v105, v105
  v_rcp_f32 v109, v109
  v_rcp_f32 v98, v98
  v_rcp_f32 v102, v102
  v_rcp_f32 v106, v106
  v_rcp_f32 v110, v110
  v_rcp_f32 v99, v99
  v_rcp_f32 v103, v103
  v_rcp_f32 v107, v107
  v_rcp_f32 v111, v111
  v_pk_mul_f32 v[40:41], v[40:41], v[96:97]
  v_pk_mul_f32 v[44:45], v[44:45], v[100:101]
  v_pk_mul_f32 v[64:65], v[64:65], v[104:105]
  v_pk_mul_f32 v[68:69], v[68:69], v[108:109]
  v_pk_mul_f32 v[42:43], v[42:43], v[98:99]
  v_pk_mul_f32 v[46:47], v[46:47], v[102:103]
  v_pk_mul_f32 v[66:67], v[66:67], v[106:107]
  v_pk_mul_f32 v[70:71], v[70:71], v[110:111]
  v_cvt_pk_bf16_f32 v120, v40, v41
  v_cvt_pk_bf16_f32 v122, v44, v45
  v_cvt_pk_bf16_f32 v124, v64, v65
  v_cvt_pk_bf16_f32 v126, v68, v69
  v_cvt_pk_bf16_f32 v121, v42, v43
  v_cvt_pk_bf16_f32 v123, v46, v47
  v_cvt_pk_bf16_f32 v125, v66, v67
  v_cvt_pk_bf16_f32 v127, v70, v71
  v_permlane16_swap_b32 v120, v122
  v_permlane16_swap_b32 v121, v123
  buffer_store_dwordx4 v[120:123], v8, s[56:59], s9 offen offset:1024
  v_permlane16_swap_b32 v124, v126
  v_permlane16_swap_b32 v125, v127
  buffer_store_dwordx4 v[124:127], v8, s[56:59], s12 offen offset:1024
  v_pk_fma_f32 v[48:49], v[48:49], v[16:17], v[176:177] op_sel:[0,1,0] op_sel_hi:[1,1,1]
  v_pk_fma_f32 v[52:53], v[52:53], v[16:17], v[180:181] op_sel:[0,1,0] op_sel_hi:[1,1,1]
  v_pk_fma_f32 v[72:73], v[72:73], v[18:19], v[200:201] op_sel:[0,1,0] op_sel_hi:[1,1,1]
  v_pk_fma_f32 v[76:77], v[76:77], v[18:19], v[204:205] op_sel:[0,1,0] op_sel_hi:[1,1,1]
  v_pk_fma_f32 v[50:51], v[50:51], v[16:17], v[178:179] op_sel:[0,1,0] op_sel_hi:[1,1,1]
  v_pk_fma_f32 v[54:55], v[54:55], v[16:17], v[182:183] op_sel:[0,1,0] op_sel_hi:[1,1,1]
  v_pk_fma_f32 v[74:75], v[74:75], v[18:19], v[202:203] op_sel:[0,1,0] op_sel_hi:[1,1,1]
  v_pk_fma_f32 v[78:79], v[78:79], v[18:19], v[206:207] op_sel:[0,1,0] op_sel_hi:[1,1,1]
  v_cvt_pk_bf16_f32 v24, v48, v49
  v_cvt_pk_bf16_f32 v26, v52, v53
  v_cvt_pk_bf16_f32 v28, v72, v73
  v_cvt_pk_bf16_f32 v30, v76, v77
  v_cvt_pk_bf16_f32 v25, v50, v51
  v_cvt_pk_bf16_f32 v27, v54, v55
  v_cvt_pk_bf16_f32 v29, v74, v75
  v_cvt_pk_bf16_f32 v31, v78, v79
  v_lshlrev_b32 v48, 16, v24
  v_lshlrev_b32 v52, 16, v26
  v_lshlrev_b32 v72, 16, v28
  v_lshlrev_b32 v76, 16, v30
  v_and_b32 v49, 0xffff0000, v24
  v_and_b32 v53, 0xffff0000, v26
  v_and_b32 v73, 0xffff0000, v28
  v_and_b32 v77, 0xffff0000, v30
  v_lshlrev_b32 v50, 16, v25
  v_lshlrev_b32 v54, 16, v27
  v_lshlrev_b32 v74, 16, v29
  v_lshlrev_b32 v78, 16, v31
  v_and_b32 v51, 0xffff0000, v25
  v_and_b32 v55, 0xffff0000, v27
  v_and_b32 v75, 0xffff0000, v29
  v_and_b32 v79, 0xffff0000, v31
  v_pk_mul_f32 v[96:97], v[48:49], v[48:49]
  v_pk_mul_f32 v[100:101], v[52:53], v[52:53]
  v_pk_mul_f32 v[104:105], v[72:73], v[72:73]
  v_pk_mul_f32 v[108:109], v[76:77], v[76:77]
  v_pk_mul_f32 v[98:99], v[50:51], v[50:51]
  v_pk_mul_f32 v[102:103], v[54:55], v[54:55]
  v_pk_mul_f32 v[106:107], v[74:75], v[74:75]
  v_pk_mul_f32 v[110:111], v[78:79], v[78:79]
  v_pk_fma_f32 v[96:97], v[96:97], v[6:7], v[4:5]
  v_pk_fma_f32 v[100:101], v[100:101], v[6:7], v[4:5]
  v_pk_fma_f32 v[104:105], v[104:105], v[6:7], v[4:5]
  v_pk_fma_f32 v[108:109], v[108:109], v[6:7], v[4:5]
  v_pk_fma_f32 v[98:99], v[98:99], v[6:7], v[4:5]
  v_pk_fma_f32 v[102:103], v[102:103], v[6:7], v[4:5]
  v_pk_fma_f32 v[106:107], v[106:107], v[6:7], v[4:5]
  v_pk_fma_f32 v[110:111], v[110:111], v[6:7], v[4:5]
  v_pk_mul_f32 v[96:97], v[96:97], v[48:49]
  v_pk_mul_f32 v[100:101], v[100:101], v[52:53]
  v_pk_mul_f32 v[104:105], v[104:105], v[72:73]
  v_pk_mul_f32 v[108:109], v[108:109], v[76:77]
  v_pk_mul_f32 v[98:99], v[98:99], v[50:51]
  v_pk_mul_f32 v[102:103], v[102:103], v[54:55]
  v_pk_mul_f32 v[106:107], v[106:107], v[74:75]
  v_pk_mul_f32 v[110:111], v[110:111], v[78:79]
  v_exp_f32 v96, v96
  v_exp_f32 v100, v100
  v_exp_f32 v104, v104
  v_exp_f32 v108, v108
  v_exp_f32 v97, v97
  v_exp_f32 v101, v101
  v_exp_f32 v105, v105
  v_exp_f32 v109, v109
  v_exp_f32 v98, v98
  v_exp_f32 v102, v102
  v_exp_f32 v106, v106
  v_exp_f32 v110, v110
  v_exp_f32 v99, v99
  v_exp_f32 v103, v103
  v_exp_f32 v107, v107
  v_exp_f32 v111, v111
  v_pk_add_f32 v[96:97], v[96:97], 1.0 op_sel_hi:[1,0]
  v_pk_add_f32 v[100:101], v[100:101], 1.0 op_sel_hi:[1,0]
  v_pk_add_f32 v[104:105], v[104:105], 1.0 op_sel_hi:[1,0]
  v_pk_add_f32 v[108:109], v[108:109], 1.0 op_sel_hi:[1,0]
  v_pk_add_f32 v[98:99], v[98:99], 1.0 op_sel_hi:[1,0]
  v_pk_add_f32 v[102:103], v[102:103], 1.0 op_sel_hi:[1,0]
  v_pk_add_f32 v[106:107], v[106:107], 1.0 op_sel_hi:[1,0]
  v_pk_add_f32 v[110:111], v[110:111], 1.0 op_sel_hi:[1,0]
  v_rcp_f32 v96, v96
  v_rcp_f32 v100, v100
  v_rcp_f32 v104, v104
  v_rcp_f32 v108, v108
  v_rcp_f32 v97, v97
  v_rcp_f32 v101, v101
  v_rcp_f32 v105, v105
  v_rcp_f32 v109, v109
  v_rcp_f32 v98, v98
  v_rcp_f32 v102, v102
  v_rcp_f32 v106, v106
  v_rcp_f32 v110, v110
  v_rcp_f32 v99, v99
  v_rcp_f32 v103, v103
  v_rcp_f32 v107, v107
  v_rcp_f32 v111, v111
  v_pk_mul_f32 v[48:49], v[48:49], v[96:97]
  v_pk_mul_f32 v[52:53], v[52:53], v[100:101]
  v_pk_mul_f32 v[72:73], v[72:73], v[104:105]
  v_pk_mul_f32 v[76:77], v[76:77], v[108:109]
  v_pk_mul_f32 v[50:51], v[50:51], v[98:99]
  v_pk_mul_f32 v[54:55], v[54:55], v[102:103]
  v_pk_mul_f32 v[74:75], v[74:75], v[106:107]
  v_pk_mul_f32 v[78:79], v[78:79], v[110:111]
  v_cvt_pk_bf16_f32 v112, v48, v49
  v_cvt_pk_bf16_f32 v114, v52, v53
  v_cvt_pk_bf16_f32 v116, v72, v73
  v_cvt_pk_bf16_f32 v118, v76, v77
  v_cvt_pk_bf16_f32 v113, v50, v51
  v_cvt_pk_bf16_f32 v115, v54, v55
  v_cvt_pk_bf16_f32 v117, v74, v75
  v_cvt_pk_bf16_f32 v119, v78, v79
  v_permlane16_swap_b32 v112, v114
  v_permlane16_swap_b32 v113, v115
  buffer_store_dwordx4 v[112:115], v8, s[56:59], s9 offen offset:2048
  v_permlane16_swap_b32 v116, v118
  v_permlane16_swap_b32 v117, v119
  buffer_store_dwordx4 v[116:119], v8, s[56:59], s12 offen offset:2048
LS5c_sig:
LS5c_fin:
LS5c_skip:
  s_and_b32 s6, s2, 7
  s_lshr_b32 s7, s2, 3
  s_lshl_b32 s6, s6, 2
  s_and_b32 s8, s7, 3
  s_add_u32 s3, s6, s8
  s_lshr_b32 s4, s7, 2
  s_lshl_b32 s8, s3, 2
  s_add_u32 s8, s8, s5
  s_mul_i32 s9, s8, 62464
  s_mul_i32 s6, s24, 44032
  s_add_u32 s9, s9, s6
  s_add_u32 s9, s9, 50331648
  s_lshl_b32 s6, s4, 11
  s_add_u32 s9, s9, s6
  v_and_b32 v24, 1, v3
  v_lshlrev_b32 v8, 4, v2
  v_lshl_add_u32 v8, v24, 9, v8
  v_lshrrev_b32 v24, 1, v3
  v_lshl_add_u32 v8, v24, 8, v8
  s_mul_i32 s10, s8, 62464
  s_mul_i32 s6, s24, 1024
  s_add_u32 s10, s10, s6
  s_add_u32 s10, s10, 50392064
  s_lshl_b32 s6, s4, 3
  s_add_u32 s10, s10, s6
  v_lshlrev_b32 v9, 6, v2
  v_lshl_add_u32 v9, v3, 2, v9
  v_mov_b32 v10, 0x3f803f80
  s_and_b32 s6, s2, 7
  s_lshl_b32 s6, s6, 5
  s_and_b32 s7, s3, 3
  s_lshl_b32 s7, s7, 2
  s_add_u32 s6, s6, s7
  s_add_u32 s6, s6, s5
  s_add_u32 s6, s6, 1
  s_lshl_b32 s6, s6, 7
  v_min_u32 v230, 14, v1
  v_lshlrev_b32 v230, 2, v230
  v_add_u32 v230, s6, v230
  v_add_u32 v230, 21626880, v230
  s_lshl_b32 s7, s5, 2
  s_add_u32 s7, s7, 161808
  v_mov_b32 v233, s7
  v_lshlrev_b32 v12, 4, v1
  v_lshlrev_b32 v4, 4, v1
  s_mul_i32 s11, s8, 62464
  s_mul_i32 s6, s24, -16384
  s_add_u32 s11, s11, s6
  s_add_u32 s11, s11, 50348032
  s_mov_b32 s48, s34
  s_mov_b32 s49, s35
  s_mov_b32 s50, 2097152
  s_mov_b32 s51, 0x00020000
  v_and_b32 v24, 1, v3
  v_lshlrev_b32 v5, 10, v2
  v_lshl_add_u32 v5, v24, 5, v5
  v_lshrrev_b32 v24, 1, v3
  v_lshl_add_u32 v5, v24, 4, v5
  s_lshl_b32 s12, s8, 14
  s_lshl_b32 s6, s4, 7
  s_add_u32 s12, s12, s6
  s_mov_b64 exec, s[62:63]
  s_waitcnt vmcnt(0)
  buffer_store_dword v236, v237, s[56:59], s1 offen offset:128
  s_mov_b64 exec, -1
  buffer_load_dword v231, v230, s[56:59], 0 offen sc1
  s_and_b32 s1, s2, 7
  s_lshl_b32 s1, s1, 5
  s_and_b32 s6, s3, 3
  s_lshl_b32 s6, s6, 2
  s_add_u32 s1, s1, s6
  s_add_u32 s1, s1, s5
  s_lshl_b32 s1, s1, 7
  s_lshl_b32 s6, s4, 2
  s_add_u32 s1, s1, s6
  s_add_u32 s1, s1, 21626880
  s_add_u32 s6, s25, 6
  v_mov_b32 v236, s6
  v_lshlrev_b32 v237, 7, v1
  v_mov_b32 v234, 161824
  s_add_u32 s7, s15, 6
LS6c_pw29:
  ds_read_b128 v[226:229], v234
  s_waitcnt lgkmcnt(0)
  v_min_u32 v226, v226, v227
  v_min3_u32 v226, v226, v228, v229
  s_nop 0
  v_readfirstlane_b32 s6, v226
  s_cmp_ge_u32 s6, s7
  s_cbranch_scc1 LS6c_pw29_ok
  s_sleep 1
  s_sub_u32 s0, s0, 1
  s_cbranch_scc0 LS6c_pw29
  s_mov_b32 s0, 0
LS6c_pw29_ok:
  ds_read_b128 v[48:51], v12 offset:0
  ds_read_b128 v[52:55], v12 offset:1024
  ds_read_b128 v[56:59], v12 offset:2048
  ds_read_b128 v[60:63], v12 offset:3072
  ds_read_b128 v[64:67], v12 offset:4096
  ds_read_b128 v[68:71], v12 offset:5120
  ds_read_b128 v[72:75], v12 offset:6144
  ds_read_b128 v[76:79], v12 offset:7168
  s_add_u32 s6, s25, 5
LS6c_poll30:
  s_waitcnt vmcnt(0)
  v_cmp_gt_u32 vcc, s6, v231
  s_cmp_eq_u64 vcc, 0
  s_cbranch_scc1 LS6c_poll30_ok
  buffer_load_dword v231, v230, s[56:59], 0 offen sc1
  s_sub_u32 s0, s0, 1
  s_cbranch_scc0 LS6c_poll30
  s_mov_b32 s0, 0
  s_waitcnt vmcnt(0)
LS6c_poll30_ok:
  buffer_load_dwordx4 v[96:99], v4, s[56:59], s11 offen offset:0 sc1
  buffer_load_dwordx4 v[100:103], v4, s[56:59], s11 offen offset:1024 sc1
  buffer_load_dwordx4 v[104:107], v4, s[56:59], s11 offen offset:2048 sc1
  buffer_load_dwordx4 v[108:111], v4, s[56:59], s11 offen offset:3072 sc1
  s_add_u32 s7, s11, 4096
  buffer_load_dwordx4 v[112:115], v4, s[56:59], s7 offen offset:0 sc1
  s_add_u32 s7, s11, 4096
  buffer_load_dwordx4 v[116:119], v4, s[56:59], s7 offen offset:1024 sc1
  s_add_u32 s7, s11, 4096
  buffer_load_dwordx4 v[120:123], v4, s[56:59], s7 offen offset:2048 sc1
  s_add_u32 s7, s11, 4096
  buffer_load_dwordx4 v[124:127], v4, s[56:59], s7 offen offset:3072 sc1
  s_add_u32 s7, s11, 8192
  buffer_load_dwordx4 v[128:131], v4, s[56:59], s7 offen offset:0 sc1
  s_add_u32 s7, s11, 8192
  buffer_load_dwordx4 v[132:135], v4, s[56:59], s7 offen offset:1024 sc1
  s_add_u32 s7, s11, 8192
  buffer_load_dwordx4 v[136:139], v4, s[56:59], s7 offen offset:2048 sc1
  s_add_u32 s7, s11, 8192
  buffer_load_dwordx4 v[140:143], v4, s[56:59], s7 offen offset:3072 sc1
  s_waitcnt vmcnt(11)
  s_waitcnt lgkmcnt(6)
  v_mfma_f32_16x16x32_bf16 v[32:35], v[48:51], v[96:99], 0
  ds_read_b128 v[80:83], v12 offset:8192
  v_mfma_f32_16x16x32_bf16 v[36:39], v[52:55], v[96:99], 0
  ds_read_b128 v[84:87], v12 offset:9216
  s_waitcnt lgkmcnt(6)
  v_mfma_f32_16x16x32_bf16 v[40:43], v[56:59], v[96:99], 0
  ds_read_b128 v[88:91], v12 offset:10240
  v_mfma_f32_16x16x32_bf16 v[44:47], v[60:63], v[96:99], 0
  ds_read_b128 v[92:95], v12 offset:11264
  s_add_u32 s7, s11, 12288
  buffer_load_dwordx4 v[144:147], v4, s[56:59], s7 offen offset:0 sc1
  s_waitcnt vmcnt(11)
  s_waitcnt lgkmcnt(6)
  v_mfma_f32_16x16x32_bf16 v[32:35], v[64:67], v[100:103], v[32:35]
  ds_read_b128 v[48:51], v12 offset:12288
  v_mfma_f32_16x16x32_bf16 v[36:39], v[68:71], v[100:103], v[36:39]
  ds_read_b128 v[52:55], v12 offset:13312
  s_waitcnt lgkmcnt(6)
  v_mfma_f32_16x16x32_bf16 v[40:43], v[72:75], v[100:103], v[40:43]
  ds_read_b128 v[56:59], v12 offset:14336
  v_mfma_f32_16x16x32_bf16 v[44:47], v[76:79], v[100:103], v[44:47]
  ds_read_b128 v[60:63], v12 offset:15360
  s_add_u32 s7, s11, 12288
  buffer_load_dwordx4 v[148:151], v4, s[56:59], s7 offen offset:1024 sc1
  s_waitcnt vmcnt(11)
  s_waitcnt lgkmcnt(6)
  v_mfma_f32_16x16x32_bf16 v[32:35], v[80:83], v[104:107], v[32:35]
  ds_read_b128 v[64:67], v12 offset:16384
  v_mfma_f32_16x16x32_bf16 v[36:39], v[84:87], v[104:107], v[36:39]
  ds_read_b128 v[68:71], v12 offset:17408
  s_waitcnt lgkmcnt(6)
  v_mfma_f32_16x16x32_bf16 v[40:43], v[88:91], v[104:107], v[40:43]
  ds_read_b128 v[72:75], v12 offset:18432
  v_mfma_f32_16x16x32_bf16 v[44:47], v[92:95], v[104:107], v[44:47]
  ds_read_b128 v[76:79], v12 offset:19456
  s_add_u32 s7, s11, 12288
  buffer_load_dwordx4 v[152:155], v4, s[56:59], s7 offen offset:2048 sc1
  s_waitcnt vmcnt(11)
  s_waitcnt lgkmcnt(6)
  v_mfma_f32_16x16x32_bf16 v[32:35], v[48:51], v[108:111], v[32:35]
  ds_read_b128 v[80:83], v12 offset:20480
  v_mfma_f32_16x16x32_bf16 v[36:39], v[52:55], v[108:111], v[36:39]
  ds_read_b128 v[84:87], v12 offset:21504
  s_waitcnt lgkmcnt(6)
  v_mfma_f32_16x16x32_bf16 v[40:43], v[56:59], v[108:111], v[40:43]
  ds_read_b128 v[88:91], v12 offset:22528
  v_mfma_f32_16x16x32_bf16 v[44:47], v[60:63], v[108:111], v[44:47]
  ds_read_b128 v[92:95], v12 offset:23552
  s_add_u32 s7, s11, 12288
  buffer_load_dwordx4 v[156:159], v4, s[56:59], s7 offen offset:3072 sc1
  s_add_u32 s6, s15, 19
  s_mov_b64 exec, 1
  v_mov_b32 v232, s6
  ds_write_b32 v233, v232
  s_mov_b64 exec, -1
  s_waitcnt vmcnt(11)
  s_waitcnt lgkmcnt(6)
  v_mfma_f32_16x16x32_bf16 v[32:35], v[64:67], v[112:115], v[32:35]
  ds_read_b128 v[48:51], v12 offset:24576
  v_mfma_f32_16x16x32_bf16 v[36:39], v[68:71], v[112:115], v[36:39]
  ds_read_b128 v[52:55], v12 offset:25600
  s_waitcnt lgkmcnt(6)
  v_mfma_f32_16x16x32_bf16 v[40:43], v[72:75], v[112:115], v[40:43]
  ds_read_b128 v[56:59], v12 offset:26624
  v_mfma_f32_16x16x32_bf16 v[44:47], v[76:79], v[112:115], v[44:47]
  ds_read_b128 v[60:63], v12 offset:27648
  s_add_u32 s7, s11, 16384
  buffer_load_dwordx4 v[160:163], v4, s[56:59], s7 offen offset:0 sc1
  s_waitcnt vmcnt(11)
  s_waitcnt lgkmcnt(6)
  v_mfma_f32_16x16x32_bf16 v[32:35], v[80:83], v[116:119], v[32:35]
  ds_read_b128 v[64:67], v12 offset:28672
  v_mfma_f32_16x16x32_bf16 v[36:39], v[84:87], v[116:119], v[36:39]
  ds_read_b128 v[68:71], v12 offset:29696
  s_waitcnt lgkmcnt(6)
  v_mfma_f32_16x16x32_bf16 v[40:43], v[88:91], v[116:119], v[40:43]
  ds_read_b128 v[72:75], v12 offset:30720
  v_mfma_f32_16x16x32_bf16 v[44:47], v[92:95], v[116:119], v[44:47]
  ds_read_b128 v[76:79], v12 offset:31744
  s_add_u32 s7, s11, 16384
  buffer_load_dwordx4 v[164:167], v4, s[56:59], s7 offen offset:1024 sc1
  s_waitcnt vmcnt(11)
  s_waitcnt lgkmcnt(6)
  v_mfma_f32_16x16x32_bf16 v[32:35], v[48:51], v[120:123], v[32:35]
  ds_read_b128 v[80:83], v12 offset:32768
  v_mfma_f32_16x16x32_bf16 v[36:39], v[52:55], v[120:123], v[36:39]
  ds_read_b128 v[84:87], v12 offset:33792
  s_waitcnt lgkmcnt(6)
  v_mfma_f32_16x16x32_bf16 v[40:43], v[56:59], v[120:123], v[40:43]
  ds_read_b128 v[88:91], v12 offset:34816
  v_mfma_f32_16x16x32_bf16 v[44:47], v[60:63], v[120:123], v[44:47]
  ds_read_b128 v[92:95], v12 offset:35840
  s_add_u32 s7, s11, 16384
  buffer_load_dwordx4 v[168:171], v4, s[56:59], s7 offen offset:2048 sc1
  s_waitcnt vmcnt(11)
  s_waitcnt lgkmcnt(6)
  v_mfma_f32_16x16x32_bf16 v[32:35], v[64:67], v[124:127], v[32:35]
  ds_read_b128 v[48:51], v12 offset:36864
  v_mfma_f32_16x16x32_bf16 v[36:39], v[68:71], v[124:127], v[36:39]
  ds_read_b128 v[52:55], v12 offset:37888
  s_waitcnt lgkmcnt(6)
  v_mfma_f32_16x16x32_bf16 v[40:43], v[72:75], v[124:127], v[40:43]
  ds_read_b128 v[56:59], v12 offset:38912
  v_mfma_f32_16x16x32_bf16 v[44:47], v[76:79], v[124:127], v[44:47]
  ds_read_b128 v[60:63], v12 offset:39936
  s_add_u32 s7, s11, 16384
  buffer_load_dwordx4 v[172:175], v4, s[56:59], s7 offen offset:3072 sc1
  s_waitcnt vmcnt(11)
  s_waitcnt lgkmcnt(6)
  v_mfma_f32_16x16x32_bf16 v[32:35], v[80:83], v[128:131], v[32:35]
  ds_read_b128 v[64:67], v12 offset:40960
  v_mfma_f32_16x16x32_bf16 v[36:39], v[84:87], v[128:131], v[36:39]
  ds_read_b128 v[68:71], v12 offset:41984
  s_waitcnt lgkmcnt(6)
  v_mfma_f32_16x16x32_bf16 v[40:43], v[88:91], v[128:131], v[40:43]
  ds_read_b128 v[72:75], v12 offset:43008
  v_mfma_f32_16x16x32_bf16 v[44:47], v[92:95], v[128:131], v[44:47]
  ds_read_b128 v[76:79], v12 offset:44032
  s_add_u32 s7, s11, 20480
  buffer_load_dwordx4 v[176:179], v4, s[56:59], s7 offen offset:0 sc1
  s_waitcnt vmcnt(11)
  s_waitcnt lgkmcnt(6)
  v_mfma_f32_16x16x32_bf16 v[32:35], v[48:51], v[132:135], v[32:35]
  ds_read_b128 v[80:83], v12 offset:45056
  v_mfma_f32_16x16x32_bf16 v[36:39], v[52:55], v[132:135], v[36:39]
  ds_read_b128 v[84:87], v12 offset:46080
  s_waitcnt lgkmcnt(6)
  v_mfma_f32_16x16x32_bf16 v[40:43], v[56:59], v[132:135], v[40:43]
  ds_read_b128 v[88:91], v12 offset:47104
  v_mfma_f32_16x16x32_bf16 v[44:47], v[60:63], v[132:135], v[44:47]
  ds_read_b128 v[92:95], v12 offset:48128
  s_add_u32 s7, s11, 20480
  buffer_load_dwordx4 v[180:183], v4, s[56:59], s7 offen offset:1024 sc1
  s_waitcnt vmcnt(11)
  s_waitcnt lgkmcnt(6)
  v_mfma_f32_16x16x32_bf16 v[32:35], v[64:67], v[136:139], v[32:35]
  ds_read_b128 v[48:51], v12 offset:49152
  v_mfma_f32_16x16x32_bf16 v[36:39], v[68:71], v[136:139], v[36:39]
  ds_read_b128 v[52:55], v12 offset:50176
  s_waitcnt lgkmcnt(6)
  v_mfma_f32_16x16x32_bf16 v[40:43], v[72:75], v[136:139], v[40:43]
  ds_read_b128 v[56:59], v12 offset:51200
  v_mfma_f32_16x16x32_bf16 v[44:47], v[76:79], v[136:139], v[44:47]
  ds_read_b128 v[60:63], v12 offset:52224
  s_add_u32 s7, s11, 20480
  buffer_load_dwordx4 v[184:187], v4, s[56:59], s7 offen offset:2048 sc1
  s_waitcnt vmcnt(11)
  s_waitcnt lgkmcnt(6)
  v_mfma_f32_16x16x32_bf16 v[32:35], v[80:83], v[140:143], v[32:35]
  ds_read_b128 v[64:67], v12 offset:53248
  v_mfma_f32_16x16x32_bf16 v[36:39], v[84:87], v[140:143], v[36:39]
  ds_read_b128 v[68:71], v12 offset:54272
  s_waitcnt lgkmcnt(6)
  v_mfma_f32_16x16x32_bf16 v[40:43], v[88:91], v[140:143], v[40:43]
  ds_read_b128 v[72:75], v12 offset:55296
  v_mfma_f32_16x16x32_bf16 v[44:47], v[92:95], v[140:143], v[44:47]
  ds_read_b128 v[76:79], v12 offset:56320
  s_add_u32 s7, s11, 20480
  buffer_load_dwordx4 v[188:191], v4, s[56:59], s7 offen offset:3072 sc1
  s_add_u32 s6, s15, 20
  s_mov_b64 exec, 1
  v_mov_b32 v232, s6
  ds_write_b32 v233, v232
  s_mov_b64 exec, -1
  s_waitcnt vmcnt(11)
  s_waitcnt lgkmcnt(6)
  v_mfma_f32_16x16x32_bf16 v[32:35], v[48:51], v[144:147], v[32:35]
  ds_read_b128 v[80:83], v12 offset:57344
  v_mfma_f32_16x16x32_bf16 v[36:39], v[52:55], v[144:147], v[36:39]
  ds_read_b128 v[84:87], v12 offset:58368
  s_waitcnt lgkmcnt(6)
  v_mfma_f32_16x16x32_bf16 v[40:43], v[56:59], v[144:147], v[40:43]
  ds_read_b128 v[88:91], v12 offset:59392
  v_mfma_f32_16x16x32_bf16 v[44:47], v[60:63], v[144:147], v[44:47]
  ds_read_b128 v[92:95], v12 offset:60416
  s_add_u32 s7, s11, 24576
  buffer_load_dwordx4 v[192:195], v4, s[56:59], s7 offen offset:0 sc1
  s_waitcnt vmcnt(11)
  s_waitcnt lgkmcnt(6)
  v_mfma_f32_16x16x32_bf16 v[32:35], v[64:67], v[148:151], v[32:35]
  ds_read_b128 v[48:51], v12 offset:61440
  v_mfma_f32_16x16x32_bf16 v[36:39], v[68:71], v[148:151], v[36:39]
  ds_read_b128 v[52:55], v12 offset:62464
  s_waitcnt lgkmcnt(6)
  v_mfma_f32_16x16x32_bf16 v[40:43], v[72:75], v[148:151], v[40:43]
  ds_read_b128 v[56:59], v12 offset:63488
  v_mfma_f32_16x16x32_bf16 v[44:47], v[76:79], v[148:151], v[44:47]
  ds_read_b128 v[60:63], v12 offset:64512
  s_add_u32 s7, s11, 24576
  buffer_load_dwordx4 v[196:199], v4, s[56:59], s7 offen offset:1024 sc1
  s_waitcnt vmcnt(11)
  s_waitcnt lgkmcnt(6)
  v_mfma_f32_16x16x32_bf16 v[32:35], v[80:83], v[152:155], v[32:35]
  v_add_u32 v12, 65536, v12
  ds_read_b128 v[64:67], v12 offset:0
  v_mfma_f32_16x16x32_bf16 v[36:39], v[84:87], v[152:155], v[36:39]
  ds_read_b128 v[68:71], v12 offset:1024
  s_waitcnt lgkmcnt(6)
  v_mfma_f32_16x16x32_bf16 v[40:43], v[88:91], v[152:155], v[40:43]
  ds_read_b128 v[72:75], v12 offset:2048
  v_mfma_f32_16x16x32_bf16 v[44:47], v[92:95], v[152:155], v[44:47]
  ds_read_b128 v[76:79], v12 offset:3072
  s_add_u32 s7, s11, 24576
  buffer_load_dwordx4 v[200:203], v4, s[56:59], s7 offen offset:2048 sc1
  s_waitcnt vmcnt(11)
  s_waitcnt lgkmcnt(6)
  v_mfma_f32_16x16x32_bf16 v[32:35], v[48:51], v[156:159], v[32:35]
  ds_read_b128 v[80:83], v12 offset:4096
  v_mfma_f32_16x16x32_bf16 v[36:39], v[52:55], v[156:159], v[36:39]
  ds_read_b128 v[84:87], v12 offset:5120
  s_waitcnt lgkmcnt(6)
  v_mfma_f32_16x16x32_bf16 v[40:43], v[56:59], v[156:159], v[40:43]
  ds_read_b128 v[88:91], v12 offset:6144
  v_mfma_f32_16x16x32_bf16 v[44:47], v[60:63], v[156:159], v[44:47]
  ds_read_b128 v[92:95], v12 offset:7168
  s_add_u32 s7, s11, 24576
  buffer_load_dwordx4 v[204:207], v4, s[56:59], s7 offen offset:3072 sc1
  s_waitcnt vmcnt(11)
  s_waitcnt lgkmcnt(6)
  v_mfma_f32_16x16x32_bf16 v[32:35], v[64:67], v[160:163], v[32:35]
  ds_read_b128 v[48:51], v12 offset:8192
  v_mfma_f32_16x16x32_bf16 v[36:39], v[68:71], v[160:163], v[36:39]
  ds_read_b128 v[52:55], v12 offset:9216
  s_waitcnt lgkmcnt(6)
  v_mfma_f32_16x16x32_bf16 v[40:43], v[72:75], v[160:163], v[40:43]
  ds_read_b128 v[56:59], v12 offset:10240
  v_mfma_f32_16x16x32_bf16 v[44:47], v[76:79], v[160:163], v[44:47]
  ds_read_b128 v[60:63], v12 offset:11264
  s_add_u32 s7, s11, 28672
  buffer_load_dwordx4 v[208:211], v4, s[56:59], s7 offen offset:0 sc1
  s_waitcnt vmcnt(11)
  s_waitcnt lgkmcnt(6)
  v_mfma_f32_16x16x32_bf16 v[32:35], v[80:83], v[164:167], v[32:35]
  ds_read_b128 v[64:67], v12 offset:12288
  v_mfma_f32_16x16x32_bf16 v[36:39], v[84:87], v[164:167], v[36:39]
  ds_read_b128 v[68:71], v12 offset:13312
  s_waitcnt lgkmcnt(6)
  v_mfma_f32_16x16x32_bf16 v[40:43], v[88:91], v[164:167], v[40:43]
  ds_read_b128 v[72:75], v12 offset:14336
  v_mfma_f32_16x16x32_bf16 v[44:47], v[92:95], v[164:167], v[44:47]
  ds_read_b128 v[76:79], v12 offset:15360
  s_add_u32 s7, s11, 28672
  buffer_load_dwordx4 v[212:215], v4, s[56:59], s7 offen offset:1024 sc1
  s_waitcnt vmcnt(11)
  s_waitcnt lgkmcnt(6)
  v_mfma_f32_16x16x32_bf16 v[32:35], v[48:51], v[168:171], v[32:35]
  ds_read_b128 v[80:83], v12 offset:16384
  v_mfma_f32_16x16x32_bf16 v[36:39], v[52:55], v[168:171], v[36:39]
  ds_read_b128 v[84:87], v12 offset:17408
  s_waitcnt lgkmcnt(6)
  v_mfma_f32_16x16x32_bf16 v[40:43], v[56:59], v[168:171], v[40:43]
  ds_read_b128 v[88:91], v12 offset:18432
  v_mfma_f32_16x16x32_bf16 v[44:47], v[60:63], v[168:171], v[44:47]
  ds_read_b128 v[92:95], v12 offset:19456
  s_add_u32 s7, s11, 28672
  buffer_load_dwordx4 v[216:219], v4, s[56:59], s7 offen offset:2048 sc1
  s_waitcnt vmcnt(11)
  s_waitcnt lgkmcnt(6)
  v_mfma_f32_16x16x32_bf16 v[32:35], v[64:67], v[172:175], v[32:35]
  ds_read_b128 v[48:51], v12 offset:20480
  v_mfma_f32_16x16x32_bf16 v[36:39], v[68:71], v[172:175], v[36:39]
  ds_read_b128 v[52:55], v12 offset:21504
  s_waitcnt lgkmcnt(6)
  v_mfma_f32_16x16x32_bf16 v[40:43], v[72:75], v[172:175], v[40:43]
  ds_read_b128 v[56:59], v12 offset:22528
  v_mfma_f32_16x16x32_bf16 v[44:47], v[76:79], v[172:175], v[44:47]
  ds_read_b128 v[60:63], v12 offset:23552
  s_add_u32 s7, s11, 28672
  buffer_load_dwordx4 v[220:223], v4, s[56:59], s7 offen offset:3072 sc1
  s_add_u32 s6, s15, 21
  s_mov_b64 exec, 1
  v_mov_b32 v232, s6
  ds_write_b32 v233, v232
  s_mov_b64 exec, -1
  s_waitcnt vmcnt(11)
  s_waitcnt lgkmcnt(6)
  v_mfma_f32_16x16x32_bf16 v[32:35], v[80:83], v[176:179], v[32:35]
  ds_read_b128 v[64:67], v12 offset:24576
  v_mfma_f32_16x16x32_bf16 v[36:39], v[84:87], v[176:179], v[36:39]
  ds_read_b128 v[68:71], v12 offset:25600
  s_waitcnt lgkmcnt(6)
  v_mfma_f32_16x16x32_bf16 v[40:43], v[88:91], v[176:179], v[40:43]
  ds_read_b128 v[72:75], v12 offset:26624
  v_mfma_f32_16x16x32_bf16 v[44:47], v[92:95], v[176:179], v[44:47]
  ds_read_b128 v[76:79], v12 offset:27648
  s_add_u32 s7, s11, 32768
  buffer_load_dwordx4 v[96:99], v4, s[56:59], s7 offen offset:0 sc1
  s_waitcnt vmcnt(11)
  s_waitcnt lgkmcnt(6)
  v_mfma_f32_16x16x32_bf16 v[32:35], v[48:51], v[180:183], v[32:35]
  ds_read_b128 v[80:83], v12 offset:28672
  v_mfma_f32_16x16x32_bf16 v[36:39], v[52:55], v[180:183], v[36:39]
  ds_read_b128 v[84:87], v12 offset:29696
  s_waitcnt lgkmcnt(6)
  v_mfma_f32_16x16x32_bf16 v[40:43], v[56:59], v[180:183], v[40:43]
  ds_read_b128 v[88:91], v12 offset:30720
  v_mfma_f32_16x16x32_bf16 v[44:47], v[60:63], v[180:183], v[44:47]
  ds_read_b128 v[92:95], v12 offset:31744
  s_add_u32 s7, s11, 32768
  buffer_load_dwordx4 v[100:103], v4, s[56:59], s7 offen offset:1024 sc1
  s_waitcnt vmcnt(11)
  s_waitcnt lgkmcnt(6)
  v_mfma_f32_16x16x32_bf16 v[32:35], v[64:67], v[184:187], v[32:35]
  ds_read_b128 v[48:51], v12 offset:32768
  v_mfma_f32_16x16x32_bf16 v[36:39], v[68:71], v[184:187], v[36:39]
  ds_read_b128 v[52:55], v12 offset:33792
  s_waitcnt lgkmcnt(6)
  v_mfma_f32_16x16x32_bf16 v[40:43], v[72:75], v[184:187], v[40:43]
  ds_read_b128 v[56:59], v12 offset:34816
  v_mfma_f32_16x16x32_bf16 v[44:47], v[76:79], v[184:187], v[44:47]
  ds_read_b128 v[60:63], v12 offset:35840
  s_add_u32 s7, s11, 32768
  buffer_load_dwordx4 v[104:107], v4, s[56:59], s7 offen offset:2048 sc1
  s_waitcnt vmcnt(11)
  s_waitcnt lgkmcnt(6)
  v_mfma_f32_16x16x32_bf16 v[32:35], v[80:83], v[188:191], v[32:35]
  ds_read_b128 v[64:67], v12 offset:36864
  v_mfma_f32_16x16x32_bf16 v[36:39], v[84:87], v[188:191], v[36:39]
  ds_read_b128 v[68:71], v12 offset:37888
  s_waitcnt lgkmcnt(6)
  v_mfma_f32_16x16x32_bf16 v[40:43], v[88:91], v[188:191], v[40:43]
  ds_read_b128 v[72:75], v12 offset:38912
  v_mfma_f32_16x16x32_bf16 v[44:47], v[92:95], v[188:191], v[44:47]
  ds_read_b128 v[76:79], v12 offset:39936
  s_add_u32 s7, s11, 32768
  buffer_load_dwordx4 v[108:111], v4, s[56:59], s7 offen offset:3072 sc1
  s_waitcnt vmcnt(11)
  s_waitcnt lgkmcnt(6)
  v_mfma_f32_16x16x32_bf16 v[32:35], v[48:51], v[192:195], v[32:35]
  ds_read_b128 v[80:83], v12 offset:40960
  v_mfma_f32_16x16x32_bf16 v[36:39], v[52:55], v[192:195], v[36:39]
  ds_read_b128 v[84:87], v12 offset:41984
  s_waitcnt lgkmcnt(6)
  v_mfma_f32_16x16x32_bf16 v[40:43], v[56:59], v[192:195], v[40:43]
  ds_read_b128 v[88:91], v12 offset:43008
  v_mfma_f32_16x16x32_bf16 v[44:47], v[60:63], v[192:195], v[44:47]
  ds_read_b128 v[92:95], v12 offset:44032
  s_add_u32 s7, s11, 36864
  buffer_load_dwordx4 v[112:115], v4, s[56:59], s7 offen offset:0 sc1
  s_waitcnt vmcnt(11)
  s_waitcnt lgkmcnt(6)
  v_mfma_f32_16x16x32_bf16 v[32:35], v[64:67], v[196:199], v[32:35]
  ds_read_b128 v[48:51], v12 offset:45056
  v_mfma_f32_16x16x32_bf16 v[36:39], v[68:71], v[196:199], v[36:39]
  ds_read_b128 v[52:55], v12 offset:46080
  s_waitcnt lgkmcnt(6)
  v_mfma_f32_16x16x32_bf16 v[40:43], v[72:75], v[196:199], v[40:43]
  ds_read_b128 v[56:59], v12 offset:47104
  v_mfma_f32_16x16x32_bf16 v[44:47], v[76:79], v[196:199], v[44:47]
  ds_read_b128 v[60:63], v12 offset:48128
  s_add_u32 s7, s11, 36864
  buffer_load_dwordx4 v[116:119], v4, s[56:59], s7 offen offset:1024 sc1
  s_waitcnt vmcnt(11)
  s_waitcnt lgkmcnt(6)
  v_mfma_f32_16x16x32_bf16 v[32:35], v[80:83], v[200:203], v[32:35]
  ds_read_b128 v[64:67], v12 offset:49152
  v_mfma_f32_16x16x32_bf16 v[36:39], v[84:87], v[200:203], v[36:39]
  ds_read_b128 v[68:71], v12 offset:50176
  s_waitcnt lgkmcnt(6)
  v_mfma_f32_16x16x32_bf16 v[40:43], v[88:91], v[200:203], v[40:43]
  ds_read_b128 v[72:75], v12 offset:51200
  v_mfma_f32_16x16x32_bf16 v[44:47], v[92:95], v[200:203], v[44:47]
  ds_read_b128 v[76:79], v12 offset:52224
  s_add_u32 s7, s11, 36864
  buffer_load_dwordx4 v[120:123], v4, s[56:59], s7 offen offset:2048 sc1
  s_waitcnt vmcnt(11)
  s_waitcnt lgkmcnt(6)
  v_mfma_f32_16x16x32_bf16 v[32:35], v[48:51], v[204:207], v[32:35]
  ds_read_b128 v[80:83], v12 offset:53248
  v_mfma_f32_16x16x32_bf16 v[36:39], v[52:55], v[204:207], v[36:39]
  ds_read_b128 v[84:87], v12 offset:54272
  s_waitcnt lgkmcnt(6)
  v_mfma_f32_16x16x32_bf16 v[40:43], v[56:59], v[204:207], v[40:43]
  ds_read_b128 v[88:91], v12 offset:55296
  v_mfma_f32_16x16x32_bf16 v[44:47], v[60:63], v[204:207], v[44:47]
  ds_read_b128 v[92:95], v12 offset:56320
  s_add_u32 s7, s11, 36864
  buffer_load_dwordx4 v[124:127], v4, s[56:59], s7 offen offset:3072 sc1
  s_add_u32 s6, s15, 22
  s_mov_b64 exec, 1
  v_mov_b32 v232, s6
  ds_write_b32 v233, v232
  s_mov_b64 exec, -1
  s_waitcnt vmcnt(11)
  s_waitcnt lgkmcnt(6)
  v_mfma_f32_16x16x32_bf16 v[32:35], v[64:67], v[208:211], v[32:35]
  ds_read_b128 v[48:51], v12 offset:57344
  v_mfma_f32_16x16x32_bf16 v[36:39], v[68:71], v[208:211], v[36:39]
  ds_read_b128 v[52:55], v12 offset:58368
  s_waitcnt lgkmcnt(6)
  v_mfma_f32_16x16x32_bf16 v[40:43], v[72:75], v[208:211], v[40:43]
  ds_read_b128 v[56:59], v12 offset:59392
  v_mfma_f32_16x16x32_bf16 v[44:47], v[76:79], v[208:211], v[44:47]
  ds_read_b128 v[60:63], v12 offset:60416
  s_add_u32 s7, s11, 40960
  buffer_load_dwordx4 v[128:131], v4, s[56:59], s7 offen offset:0 sc1
  s_waitcnt vmcnt(11)
  s_waitcnt lgkmcnt(6)
  v_mfma_f32_16x16x32_bf16 v[32:35], v[80:83], v[212:215], v[32:35]
  ds_read_b128 v[64:67], v12 offset:61440
  v_mfma_f32_16x16x32_bf16 v[36:39], v[84:87], v[212:215], v[36:39]
  ds_read_b128 v[68:71], v12 offset:62464
  s_waitcnt lgkmcnt(6)
  v_mfma_f32_16x16x32_bf16 v[40:43], v[88:91], v[212:215], v[40:43]
  ds_read_b128 v[72:75], v12 offset:63488
  v_mfma_f32_16x16x32_bf16 v[44:47], v[92:95], v[212:215], v[44:47]
  ds_read_b128 v[76:79], v12 offset:64512
  s_add_u32 s7, s11, 40960
  buffer_load_dwordx4 v[132:135], v4, s[56:59], s7 offen offset:1024 sc1
  s_waitcnt vmcnt(11)
  s_waitcnt lgkmcnt(6)
  v_mfma_f32_16x16x32_bf16 v[32:35], v[48:51], v[216:219], v[32:35]
  v_add_u32 v12, 28672, v12
  ds_read_b128 v[80:83], v12 offset:36864
  v_mfma_f32_16x16x32_bf16 v[36:39], v[52:55], v[216:219], v[36:39]
  ds_read_b128 v[84:87], v12 offset:37888
  s_waitcnt lgkmcnt(6)
  v_mfma_f32_16x16x32_bf16 v[40:43], v[56:59], v[216:219], v[40:43]
  ds_read_b128 v[88:91], v12 offset:38912
  v_mfma_f32_16x16x32_bf16 v[44:47], v[60:63], v[216:219], v[44:47]
  ds_read_b128 v[92:95], v12 offset:39936
  s_add_u32 s7, s11, 40960
  buffer_load_dwordx4 v[136:139], v4, s[56:59], s7 offen offset:2048 sc1
  s_waitcnt vmcnt(11)
  s_waitcnt lgkmcnt(6)
  v_mfma_f32_16x16x32_bf16 v[32:35], v[64:67], v[220:223], v[32:35]
  v_mfma_f32_16x16x32_bf16 v[36:39], v[68:71], v[220:223], v[36:39]
  s_waitcnt lgkmcnt(4)
  v_mfma_f32_16x16x32_bf16 v[40:43], v[72:75], v[220:223], v[40:43]
  v_mfma_f32_16x16x32_bf16 v[44:47], v[76:79], v[220:223], v[44:47]
  v_mov_b32 v234, 161824
  s_add_u32 s7, s15, 8
LS6c_pw31:
  ds_read_b128 v[226:229], v234
  s_waitcnt lgkmcnt(0)
  v_min_u32 v226, v226, v227
  v_min3_u32 v226, v226, v228, v229
  s_nop 0
  v_readfirstlane_b32 s6, v226
  s_cmp_ge_u32 s6, s7
  s_cbranch_scc1 LS6c_pw31_ok
  s_sub_u32 s0, s0, 1
  s_cbranch_scc0 LS6c_pw31
  s_mov_b32 s0, 0
LS6c_pw31_ok:
  ds_read_b128 v[48:51], v12 offset:40960
  ds_read_b128 v[52:55], v12 offset:41984
  ds_read_b128 v[56:59], v12 offset:43008
  ds_read_b128 v[60:63], v12 offset:44032
  s_waitcnt vmcnt(10)
  s_waitcnt lgkmcnt(6)
  v_mfma_f32_16x16x32_bf16 v[32:35], v[80:83], v[96:99], v[32:35]
  ds_read_b128 v[64:67], v12 offset:45056
  v_mfma_f32_16x16x32_bf16 v[36:39], v[84:87], v[96:99], v[36:39]
  ds_read_b128 v[68:71], v12 offset:46080
  s_waitcnt lgkmcnt(6)
  v_mfma_f32_16x16x32_bf16 v[40:43], v[88:91], v[96:99], v[40:43]
  ds_read_b128 v[72:75], v12 offset:47104
  v_mfma_f32_16x16x32_bf16 v[44:47], v[92:95], v[96:99], v[44:47]
  ds_read_b128 v[76:79], v12 offset:48128
  s_waitcnt vmcnt(9)
  s_waitcnt lgkmcnt(6)
  v_mfma_f32_16x16x32_bf16 v[32:35], v[48:51], v[100:103], v[32:35]
  ds_read_b128 v[80:83], v12 offset:49152
  v_mfma_f32_16x16x32_bf16 v[36:39], v[52:55], v[100:103], v[36:39]
  ds_read_b128 v[84:87], v12 offset:50176
  s_waitcnt lgkmcnt(6)
  v_mfma_f32_16x16x32_bf16 v[40:43], v[56:59], v[100:103], v[40:43]
  ds_read_b128 v[88:91], v12 offset:51200
  v_mfma_f32_16x16x32_bf16 v[44:47], v[60:63], v[100:103], v[44:47]
  ds_read_b128 v[92:95], v12 offset:52224
  s_waitcnt vmcnt(8)
  s_waitcnt lgkmcnt(6)
  v_mfma_f32_16x16x32_bf16 v[32:35], v[64:67], v[104:107], v[32:35]
  ds_read_b128 v[48:51], v12 offset:53248
  v_mfma_f32_16x16x32_bf16 v[36:39], v[68:71], v[104:107], v[36:39]
  ds_read_b128 v[52:55], v12 offset:54272
  s_waitcnt lgkmcnt(6)
  v_mfma_f32_16x16x32_bf16 v[40:43], v[72:75], v[104:107], v[40:43]
  ds_read_b128 v[56:59], v12 offset:55296
  v_mfma_f32_16x16x32_bf16 v[44:47], v[76:79], v[104:107], v[44:47]
  ds_read_b128 v[60:63], v12 offset:56320
  s_waitcnt vmcnt(7)
  s_waitcnt lgkmcnt(6)
  v_mfma_f32_16x16x32_bf16 v[32:35], v[80:83], v[108:111], v[32:35]
  ds_read_b128 v[64:67], v12 offset:57344
  v_mfma_f32_16x16x32_bf16 v[36:39], v[84:87], v[108:111], v[36:39]
  ds_read_b128 v[68:71], v12 offset:58368
  s_waitcnt lgkmcnt(6)
  v_mfma_f32_16x16x32_bf16 v[40:43], v[88:91], v[108:111], v[40:43]
  ds_read_b128 v[72:75], v12 offset:59392
  v_mfma_f32_16x16x32_bf16 v[44:47], v[92:95], v[108:111], v[44:47]
  ds_read_b128 v[76:79], v12 offset:60416
  s_waitcnt vmcnt(6)
  s_waitcnt lgkmcnt(6)
  v_mfma_f32_16x16x32_bf16 v[32:35], v[48:51], v[112:115], v[32:35]
  ds_read_b128 v[80:83], v12 offset:61440
  v_mfma_f32_16x16x32_bf16 v[36:39], v[52:55], v[112:115], v[36:39]
  ds_read_b128 v[84:87], v12 offset:62464
  s_waitcnt lgkmcnt(6)
  v_mfma_f32_16x16x32_bf16 v[40:43], v[56:59], v[112:115], v[40:43]
  ds_read_b128 v[88:91], v12 offset:63488
  v_mfma_f32_16x16x32_bf16 v[44:47], v[60:63], v[112:115], v[44:47]
  ds_read_b128 v[92:95], v12 offset:64512
  s_waitcnt vmcnt(5)
  s_waitcnt lgkmcnt(6)
  v_mfma_f32_16x16x32_bf16 v[32:35], v[64:67], v[116:119], v[32:35]
  v_add_u32 v12, 4294873088, v12
  ds_read_b128 v[48:51], v12 offset:0
  v_mfma_f32_16x16x32_bf16 v[36:39], v[68:71], v[116:119], v[36:39]
  ds_read_b128 v[52:55], v12 offset:1024
  s_waitcnt lgkmcnt(6)
  v_mfma_f32_16x16x32_bf16 v[40:43], v[72:75], v[116:119], v[40:43]
  ds_read_b128 v[56:59], v12 offset:2048
  v_mfma_f32_16x16x32_bf16 v[44:47], v[76:79], v[116:119], v[44:47]
  ds_read_b128 v[60:63], v12 offset:3072
  s_waitcnt vmcnt(4)
  s_waitcnt lgkmcnt(6)
  v_mfma_f32_16x16x32_bf16 v[32:35], v[80:83], v[120:123], v[32:35]
  ds_read_b128 v[64:67], v12 offset:4096
  v_mfma_f32_16x16x32_bf16 v[36:39], v[84:87], v[120:123], v[36:39]
  ds_read_b128 v[68:71], v12 offset:5120
  s_waitcnt lgkmcnt(6)
  v_mfma_f32_16x16x32_bf16 v[40:43], v[88:91], v[120:123], v[40:43]
  ds_read_b128 v[72:75], v12 offset:6144
  v_mfma_f32_16x16x32_bf16 v[44:47], v[92:95], v[120:123], v[44:47]
  ds_read_b128 v[76:79], v12 offset:7168
  s_waitcnt vmcnt(3)
  s_waitcnt lgkmcnt(6)
  v_mfma_f32_16x16x32_bf16 v[32:35], v[48:51], v[124:127], v[32:35]
  ds_read_b128 v[80:83], v12 offset:8192
  v_mfma_f32_16x16x32_bf16 v[36:39], v[52:55], v[124:127], v[36:39]
  ds_read_b128 v[84:87], v12 offset:9216
  s_waitcnt lgkmcnt(6)
  v_mfma_f32_16x16x32_bf16 v[40:43], v[56:59], v[124:127], v[40:43]
  ds_read_b128 v[88:91], v12 offset:10240
  v_mfma_f32_16x16x32_bf16 v[44:47], v[60:63], v[124:127], v[44:47]
  ds_read_b128 v[92:95], v12 offset:11264
  s_waitcnt vmcnt(2)
  s_waitcnt lgkmcnt(6)
  v_mfma_f32_16x16x32_bf16 v[32:35], v[64:67], v[128:131], v[32:35]
  ds_read_b128 v[48:51], v12 offset:12288
  v_mfma_f32_16x16x32_bf16 v[36:39], v[68:71], v[128:131], v[36:39]
  ds_read_b128 v[52:55], v12 offset:13312
  s_waitcnt lgkmcnt(6)
  v_mfma_f32_16x16x32_bf16 v[40:43], v[72:75], v[128:131], v[40:43]
  ds_read_b128 v[56:59], v12 offset:14336
  v_mfma_f32_16x16x32_bf16 v[44:47], v[76:79], v[128:131], v[44:47]
  ds_read_b128 v[60:63], v12 offset:15360
  s_waitcnt vmcnt(1)
  s_waitcnt lgkmcnt(6)
  v_mfma_f32_16x16x32_bf16 v[32:35], v[80:83], v[132:135], v[32:35]
  v_mfma_f32_16x16x32_bf16 v[36:39], v[84:87], v[132:135], v[36:39]
  s_waitcnt lgkmcnt(4)
  v_mfma_f32_16x16x32_bf16 v[40:43], v[88:91], v[132:135], v[40:43]
  v_mfma_f32_16x16x32_bf16 v[44:47], v[92:95], v[132:135], v[44:47]
  s_waitcnt vmcnt(0)
  s_waitcnt lgkmcnt(2)
  v_mfma_f32_16x16x32_bf16 v[32:35], v[48:51], v[136:139], v[32:35]
  v_mfma_f32_16x16x32_bf16 v[36:39], v[52:55], v[136:139], v[36:39]
  s_waitcnt lgkmcnt(0)
  v_mfma_f32_16x16x32_bf16 v[40:43], v[56:59], v[136:139], v[40:43]
  v_mfma_f32_16x16x32_bf16 v[44:47], v[60:63], v[136:139], v[44:47]
  s_nop 3
  v_cvt_pk_bf16_f32 v100, v32, v33
  v_cvt_pk_bf16_f32 v108, v36, v37
  s_nop 0
  v_cvt_pk_bf16_f32 v116, v40, v41
  v_cvt_pk_bf16_f32 v124, v44, v45
  v_cvt_pk_bf16_f32 v101, v34, v35
  v_cvt_pk_bf16_f32 v109, v38, v39
  v_cvt_pk_bf16_f32 v117, v42, v43
  v_cvt_pk_bf16_f32 v125, v46, v47
  v_lshlrev_b32 v32, 16, v100
  v_lshlrev_b32 v36, 16, v108
  v_lshlrev_b32 v40, 16, v116
  v_lshlrev_b32 v44, 16, v124
  v_and_b32 v33, 0xffff0000, v100
  v_and_b32 v37, 0xffff0000, v108
  v_and_b32 v41, 0xffff0000, v116
  v_and_b32 v45, 0xffff0000, v124
  v_lshlrev_b32 v34, 16, v101
  v_lshlrev_b32 v38, 16, v109
  v_lshlrev_b32 v42, 16, v117
  v_lshlrev_b32 v46, 16, v125
  v_and_b32 v35, 0xffff0000, v101
  v_and_b32 v39, 0xffff0000, v109
  v_and_b32 v43, 0xffff0000, v117
  v_and_b32 v47, 0xffff0000, v125
  v_lshlrev_b32 v96, 16, v248
  v_lshlrev_b32 v104, 16, v250
  v_lshlrev_b32 v112, 16, v252
  v_lshlrev_b32 v120, 16, v254
  v_and_b32 v97, 0xffff0000, v248
  v_and_b32 v105, 0xffff0000, v250
  v_and_b32 v113, 0xffff0000, v252
  v_and_b32 v121, 0xffff0000, v254
  v_lshlrev_b32 v98, 16, v249
  v_lshlrev_b32 v106, 16, v251
  v_lshlrev_b32 v114, 16, v253
  v_lshlrev_b32 v122, 16, v255
  v_and_b32 v99, 0xffff0000, v249
  v_and_b32 v107, 0xffff0000, v251
  v_and_b32 v115, 0xffff0000, v253
  v_and_b32 v123, 0xffff0000, v255
  v_pk_add_f32 v[32:33], v[32:33], v[96:97]
  v_pk_add_f32 v[36:37], v[36:37], v[104:105]
  v_pk_add_f32 v[40:41], v[40:41], v[112:113]
  v_pk_add_f32 v[44:45], v[44:45], v[120:121]
  v_pk_add_f32 v[34:35], v[34:35], v[98:99]
  v_pk_add_f32 v[38:39], v[38:39], v[106:107]
  v_pk_add_f32 v[42:43], v[42:43], v[114:115]
  v_pk_add_f32 v[46:47], v[46:47], v[122:123]
  v_cvt_pk_bf16_f32 v100, v32, v33
  v_cvt_pk_bf16_f32 v108, v36, v37
  v_cvt_pk_bf16_f32 v116, v40, v41
  v_cvt_pk_bf16_f32 v124, v44, v45
  v_cvt_pk_bf16_f32 v101, v34, v35
  v_cvt_pk_bf16_f32 v109, v38, v39
  v_cvt_pk_bf16_f32 v117, v42, v43
  v_cvt_pk_bf16_f32 v125, v46, v47
  v_lshlrev_b32 v32, 16, v100
  v_lshlrev_b32 v36, 16, v108
  v_lshlrev_b32 v40, 16, v116
  v_lshlrev_b32 v44, 16, v124
  v_and_b32 v33, 0xffff0000, v100
  v_and_b32 v37, 0xffff0000, v108
  v_and_b32 v41, 0xffff0000, v116
  v_and_b32 v45, 0xffff0000, v124
  v_lshlrev_b32 v34, 16, v101
  v_lshlrev_b32 v38, 16, v109
  v_lshlrev_b32 v42, 16, v117
  v_lshlrev_b32 v46, 16, v125
  v_and_b32 v35, 0xffff0000, v101
  v_and_b32 v39, 0xffff0000, v109
  v_and_b32 v43, 0xffff0000, v117
  v_and_b32 v47, 0xffff0000, v125
  v_lshlrev_b32 v96, 16, v240
  v_lshlrev_b32 v104, 16, v242
  v_lshlrev_b32 v112, 16, v244
  v_lshlrev_b32 v120, 16, v246
  v_and_b32 v97, 0xffff0000, v240
  v_and_b32 v105, 0xffff0000, v242
  v_and_b32 v113, 0xffff0000, v244
  v_and_b32 v121, 0xffff0000, v246
  v_lshlrev_b32 v98, 16, v241
  v_lshlrev_b32 v106, 16, v243
  v_lshlrev_b32 v114, 16, v245
  v_lshlrev_b32 v122, 16, v247
  v_and_b32 v99, 0xffff0000, v241
  v_and_b32 v107, 0xffff0000, v243
  v_and_b32 v115, 0xffff0000, v245
  v_and_b32 v123, 0xffff0000, v247
  v_pk_add_f32 v[32:33], v[32:33], v[96:97]
  v_pk_add_f32 v[36:37], v[36:37], v[104:105]
  v_pk_add_f32 v[40:41], v[40:41], v[112:113]
  v_pk_add_f32 v[44:45], v[44:45], v[120:121]
  v_pk_add_f32 v[34:35], v[34:35], v[98:99]
  v_pk_add_f32 v[38:39], v[38:39], v[106:107]
  v_pk_add_f32 v[42:43], v[42:43], v[114:115]
  v_pk_add_f32 v[46:47], v[46:47], v[122:123]
  v_cvt_pk_bf16_f32 v240, v32, v33
  v_cvt_pk_bf16_f32 v242, v36, v37
  v_cvt_pk_bf16_f32 v244, v40, v41
  v_cvt_pk_bf16_f32 v246, v44, v45
  v_cvt_pk_bf16_f32 v241, v34, v35
  v_cvt_pk_bf16_f32 v243, v38, v39
  v_cvt_pk_bf16_f32 v245, v42, v43
  v_cvt_pk_bf16_f32 v247, v46, v47
  s_cmp_eq_u32 s24, 0
  s_cbranch_scc1 LS6c_l0
  v_permlane16_swap_b32 v240, v242
  v_permlane16_swap_b32 v241, v243
  buffer_store_dwordx4 v[240:243], v5, s[48:51], s12 offen offset:0
  v_permlane16_swap_b32 v244, v246
  v_permlane16_swap_b32 v245, v247
  buffer_store_dwordx4 v[244:247], v5, s[48:51], s12 offen offset:64
  s_branch LS6c_fin
LS6c_l0:
  v_mov_b32 v48, v240
  v_mov_b32 v49, v241
  v_mov_b32 v50, v242
  v_mov_b32 v51, v243
  v_mov_b32 v52, v244
  v_mov_b32 v53, v245
  v_mov_b32 v54, v246
  v_mov_b32 v55, v247
  v_permlane16_swap_b32 v48, v50
  v_permlane16_swap_b32 v49, v51
  buffer_store_dwordx4 v[48:51], v8, s[56:59], s9 offen offset:0
  v_permlane16_swap_b32 v52, v54
  v_permlane16_swap_b32 v53, v55
  buffer_store_dwordx4 v[52:55], v8, s[56:59], s9 offen offset:1024
  v_dot2_f32_bf16 v24, v240, v10, 0
  v_dot2_f32_bf16 v26, v240, v240, 0
  v_dot2_f32_bf16 v25, v241, v10, 0
  v_dot2_f32_bf16 v27, v241, v241, 0
  v_dot2_f32_bf16 v24, v242, v10, v24
  v_dot2_f32_bf16 v26, v242, v242, v26
  v_dot2_f32_bf16 v25, v243, v10, v25
  v_dot2_f32_bf16 v27, v243, v243, v27
  v_dot2_f32_bf16 v24, v244, v10, v24
  v_dot2_f32_bf16 v26, v244, v244, v26
  v_dot2_f32_bf16 v25, v245, v10, v25
  v_dot2_f32_bf16 v27, v245, v245, v27
  v_dot2_f32_bf16 v24, v246, v10, v24
  v_dot2_f32_bf16 v26, v246, v246, v26
  v_dot2_f32_bf16 v25, v247, v10, v25
  v_dot2_f32_bf16 v27, v247, v247, v27
  s_nop 1
  v_add_f32 v24, v24, v25
  v_add_f32 v26, v26, v27
  s_nop 1
  v_permlane16_swap_b32 v24, v26
  v_add_f32 v24, v24, v26
  v_mov_b32 v26, v24
  s_nop 1
  v_permlane32_swap_b32 v24, v26
  v_add_f32 v24, v24, v26
  s_mov_b32 exec_hi, 0
  buffer_store_dword v24, v9, s[56:59], s10 offen
  s_mov_b32 exec_hi, -1
LS6c_fin:
LS6c_skip:
  s_cmp_lg_u32 s24, 0
  s_cbranch_scc1 LX_end
  s_mov_b32 s24, 1
  s_mov_b32 s25, 6
  s_mov_b32 s15, 64
  s_and_b32 s6, s2, 7
  s_lshr_b32 s7, s2, 3
  s_lshl_b32 s6, s6, 1
  s_and_b32 s8, s7, 1
  s_add_u32 s3, s6, s8
  s_lshr_b32 s4, s7, 1
  v_mov_b32 v8, 0x3f803f80
  v_mov_b32 v9, 0x3f803f80
  v_mov_b32 v10, 0x3f803f80
  v_mov_b32 v11, 0x3f803f80
  v_lshlrev_b32 v4, 2, v3
  v_add_u32 v5, 0, v4
  v_cmp_eq_u32 s[64:65], v5, v2
  v_add_u32 v5, 1, v4
  v_cmp_eq_u32 s[66:67], v5, v2
  v_add_u32 v5, 2, v4
  v_cmp_eq_u32 s[68:69], v5, v2
  v_add_u32 v5, 3, v4
  v_cmp_eq_u32 s[70:71], v5, v2
  v_mov_b32 v24, 0x3f80
  v_mov_b32 v25, 0x3f800000
  v_cndmask_b32 v22, 0, v24, s[64:65]
  v_cndmask_b32 v26, 0, v25, s[66:67]
  v_or_b32 v22, v22, v26
  v_cndmask_b32 v23, 0, v24, s[68:69]
  v_cndmask_b32 v26, 0, v25, s[70:71]
  v_or_b32 v23, v23, v26
  v_and_b32 v24, 1, v3
  v_lshlrev_b32 v20, 4, v2
  v_lshl_add_u32 v20, v24, 9, v20
  v_lshrrev_b32 v24, 1, v3
  v_lshl_add_u32 v20, v24, 8, v20
  s_lshl_b32 s6, s5, 12
  v_lshlrev_b32 v4, 4, v1
  v_add_u32 v4, s6, v4
  s_lshl_b32 s6, s5, 8
  v_lshlrev_b32 v14, 4, v3
  v_add_u32 v5, s6, v14
  v_mov_b32 v6, 161792
  v_mov_b32 v7, 1
  v_lshlrev_b32 v12, 4, v0
  v_lshlrev_b32 v21, 3, v0
  v_lshl_add_u32 v13, v2, 6, v14
  v_add_u32 v24, 0, v14
  v_add_u32 v25, 4, v14
  v_add_u32 v26, 8, v14
  v_add_u32 v27, 12, v14
  s_lshl_b32 s13, s4, 4
  s_add_u32 s13, s13, s3
  s_mul_i32 s13, s13, 2304
  s_add_u32 s13, s13, 30998528
  s_lshl_b32 s8, s3, 3
  s_lshl_b32 s6, s5, 1
  s_add_u32 s8, s8, s6
  s_mul_i32 s9, s8, 62464
  s_mul_i32 s6, s24, 44032
  s_add_u32 s9, s9, s6
  s_add_u32 s9, s9, 50331648
  s_lshl_b32 s6, s4, 10
  s_add_u32 s9, s9, s6
  s_add_u32 s12, s9, 62464
  s_and_b32 s6, s2, 7
  s_lshl_b32 s6, s6, 5
  s_and_b32 s7, s3, 1
  s_lshl_b32 s7, s7, 3
  s_add_u32 s6, s6, s7
  s_lshl_b32 s7, s5, 1
  s_add_u32 s6, s6, s7
  v_lshrrev_b32 v230, 3, v1
  v_and_b32 v230, 1, v230
  s_add_u32 s6, s6, 1
  v_add_u32 v230, s6, v230
  v_and_b32 v231, 7, v1
  v_lshlrev_b32 v231, 2, v231
  v_lshl_add_u32 v230, v230, 7, v231
  v_add_u32 v230, 21626880, v230
  s_lshl_b32 s7, s5, 2
  s_add_u32 s7, s7, 161808
  v_mov_b32 v233, s7
  v_lshlrev_b32 v224, 4, v1
  v_lshlrev_b32 v15, 4, v1
  s_mul_i32 s11, s8, 62464
  s_mul_i32 s6, s24, -44032
  s_add_u32 s11, s11, s6
  s_add_u32 s11, s11, 50375680
  s_mul_i32 s10, s8, 62464
  s_mul_i32 s6, s24, -1024
  s_add_u32 s10, s10, s6
  s_add_u32 s10, s10, 50393088
  v_lshlrev_b32 v235, 6, v2
  v_lshl_add_u32 v235, v3, 4, v235
  s_waitcnt vmcnt(0)
  s_mov_b64 exec, 1
  buffer_store_dword v236, v237, s[56:59], s1 offen offset:128
  s_mov_b64 exec, -1
  buffer_load_dword v231, v230, s[56:59], 0 offen sc1
  v_mov_b32 v234, 161824
  s_add_u32 s7, s15, 1
LS1bc_pw36:
  ds_read_b128 v[226:229], v234
  s_waitcnt lgkmcnt(0)
  v_min_u32 v226, v226, v227
  v_min3_u32 v226, v226, v228, v229
  s_nop 0
  v_readfirstlane_b32 s6, v226
  s_cmp_ge_u32 s6, s7
  s_cbranch_scc1 LS1bc_pw36_ok
  s_sleep 1
  s_sub_u32 s0, s0, 1
  s_cbranch_scc0 LS1bc_pw36
  s_mov_b32 s0, 0
LS1bc_pw36_ok:
  v_lshrrev_b32 v248, 2, v2
  v_lshl_add_u32 v248, v3, 2, v248
  v_and_b32 v249, 3, v2
  v_lshlrev_b32 v249, 3, v249
  v_lshl_add_u32 v248, v248, 5, v249
  v_add_u32 v248, 160768, v248
  ds_read_b64_tr_b16 v[28:29], v248 offset:0
  ds_read_b64_tr_b16 v[30:31], v248 offset:512
  ds_read_b128 v[80:83], v224 offset:16384
  ds_read_b128 v[84:87], v224 offset:17408
  ds_read_b128 v[88:91], v224 offset:20480
  ds_read_b128 v[92:95], v224 offset:21504
  ds_read_b128 v[96:99], v224 offset:24576
  ds_read_b128 v[100:103], v224 offset:25600
  s_add_u32 s6, s25, 0
LS1bc_poll37:
  s_waitcnt vmcnt(0)
  v_cmp_gt_u32 vcc, s6, v231
  s_cmp_eq_u64 vcc, 0
  s_cbranch_scc1 LS1bc_poll37_ok
  buffer_load_dword v231, v230, s[56:59], 0 offen sc1
  s_sub_u32 s0, s0, 1
  s_cbranch_scc0 LS1bc_poll37
  s_mov_b32 s0, 0
  s_waitcnt vmcnt(0)
LS1bc_poll37_ok:
  buffer_load_dwordx4 v[248:251], v235, s[56:59], s10 offen sc1
  s_add_u32 s10, s10, 62464
  buffer_load_dwordx4 v[252:255], v235, s[56:59], s10 offen sc1
  buffer_load_dwordx4 v[128:131], v15, s[56:59], s11 offen offset:0 sc1
  s_add_u32 s7, s11, 61440
  buffer_load_dwordx4 v[132:135], v15, s[56:59], s7 offen offset:1024 sc1
  buffer_load_dwordx4 v[136:139], v15, s[56:59], s11 offen offset:1024 sc1
  s_add_u32 s7, s11, 61440
  buffer_load_dwordx4 v[140:143], v15, s[56:59], s7 offen offset:2048 sc1
  buffer_load_dwordx4 v[144:147], v15, s[56:59], s11 offen offset:2048 sc1
  s_add_u32 s7, s11, 61440
  buffer_load_dwordx4 v[148:151], v15, s[56:59], s7 offen offset:3072 sc1
  buffer_load_dwordx4 v[152:155], v15, s[56:59], s11 offen offset:3072 sc1
  s_add_u32 s7, s11, 65536
  buffer_load_dwordx4 v[156:159], v15, s[56:59], s7 offen offset:0 sc1
  s_add_u32 s7, s11, 4096
  buffer_load_dwordx4 v[160:163], v15, s[56:59], s7 offen offset:0 sc1
  s_add_u32 s7, s11, 65536
  buffer_load_dwordx4 v[164:167], v15, s[56:59], s7 offen offset:1024 sc1
  s_add_u32 s7, s11, 4096
  buffer_load_dwordx4 v[168:171], v15, s[56:59], s7 offen offset:1024 sc1
  s_add_u32 s7, s11, 65536
  buffer_load_dwordx4 v[172:175], v15, s[56:59], s7 offen offset:2048 sc1
  s_add_u32 s7, s11, 4096
  buffer_load_dwordx4 v[176:179], v15, s[56:59], s7 offen offset:2048 sc1
  s_add_u32 s7, s11, 65536
  buffer_load_dwordx4 v[180:183], v15, s[56:59], s7 offen offset:3072 sc1
  s_add_u32 s7, s11, 4096
  buffer_load_dwordx4 v[184:187], v15, s[56:59], s7 offen offset:3072 sc1
  s_add_u32 s7, s11, 69632
  buffer_load_dwordx4 v[188:191], v15, s[56:59], s7 offen offset:0 sc1
  s_add_u32 s7, s11, 8192
  buffer_load_dwordx4 v[192:195], v15, s[56:59], s7 offen offset:0 sc1
  s_add_u32 s7, s11, 69632
  buffer_load_dwordx4 v[196:199], v15, s[56:59], s7 offen offset:1024 sc1
  s_add_u32 s7, s11, 8192
  buffer_load_dwordx4 v[200:203], v15, s[56:59], s7 offen offset:1024 sc1
  s_add_u32 s7, s11, 69632
  buffer_load_dwordx4 v[204:207], v15, s[56:59], s7 offen offset:2048 sc1
  s_add_u32 s7, s11, 8192
  buffer_load_dwordx4 v[208:211], v15, s[56:59], s7 offen offset:2048 sc1
  s_add_u32 s7, s11, 69632
  buffer_load_dwordx4 v[212:215], v15, s[56:59], s7 offen offset:3072 sc1
  s_add_u32 s7, s11, 8192
  buffer_load_dwordx4 v[216:219], v15, s[56:59], s7 offen offset:3072 sc1
  s_add_u32 s7, s11, 73728
  buffer_load_dwordx4 v[220:223], v15, s[56:59], s7 offen offset:0 sc1
  s_add_u32 s6, s15, 1
  s_mov_b64 exec, 1
  v_mov_b32 v232, s6
  ds_write_b32 v233, v232
  s_mov_b64 exec, -1
  s_waitcnt vmcnt(22)
  s_waitcnt lgkmcnt(4)
  v_mfma_f32_16x16x32_bf16 v[32:35], v[80:83], v[128:131], 0
  ds_read_b128 v[104:107], v224 offset:18432
  v_mfma_f32_16x16x32_bf16 v[56:59], v[80:83], v[132:135], 0
  ds_read_b128 v[108:111], v224 offset:19456
  v_mfma_f32_16x16x32_bf16 v[36:39], v[84:87], v[128:131], 0
  ds_read_b128 v[112:115], v224 offset:22528
  v_mfma_f32_16x16x32_bf16 v[60:63], v[84:87], v[132:135], 0
  ds_read_b128 v[116:119], v224 offset:23552
  s_waitcnt lgkmcnt(6)
  v_mfma_f32_16x16x32_bf16 v[40:43], v[88:91], v[128:131], 0
  ds_read_b128 v[120:123], v224 offset:26624
  v_mfma_f32_16x16x32_bf16 v[64:67], v[88:91], v[132:135], 0
  ds_read_b128 v[124:127], v224 offset:27648
  v_mfma_f32_16x16x32_bf16 v[44:47], v[92:95], v[128:131], 0
  v_mfma_f32_16x16x32_bf16 v[68:71], v[92:95], v[132:135], 0
  s_waitcnt lgkmcnt(6)
  v_mfma_f32_16x16x32_bf16 v[48:51], v[128:131], v[96:99], 0
  v_mfma_f32_16x16x32_bf16 v[72:75], v[132:135], v[96:99], 0
  v_mfma_f32_16x16x32_bf16 v[52:55], v[128:131], v[100:103], 0
  v_mfma_f32_16x16x32_bf16 v[76:79], v[132:135], v[100:103], 0
  s_add_u32 s7, s11, 12288
  buffer_load_dwordx4 v[128:131], v15, s[56:59], s7 offen offset:0 sc1
  s_add_u32 s7, s11, 73728
  buffer_load_dwordx4 v[132:135], v15, s[56:59], s7 offen offset:1024 sc1
  s_waitcnt vmcnt(22)
  s_waitcnt lgkmcnt(4)
  v_mfma_f32_16x16x32_bf16 v[32:35], v[104:107], v[136:139], v[32:35]
  ds_read_b128 v[80:83], v224 offset:28672
  v_pk_add_f32 v[248:249], v[248:249], v[250:251]
  v_mfma_f32_16x16x32_bf16 v[56:59], v[104:107], v[140:143], v[56:59]
  ds_read_b128 v[84:87], v224 offset:29696
  v_pk_add_f32 v[252:253], v[252:253], v[254:255]
  v_mfma_f32_16x16x32_bf16 v[36:39], v[108:111], v[136:139], v[36:39]
  ds_read_b128 v[88:91], v224 offset:32768
  v_mov_b32 v250, v248
  v_mfma_f32_16x16x32_bf16 v[60:63], v[108:111], v[140:143], v[60:63]
  ds_read_b128 v[92:95], v224 offset:33792
  v_mov_b32 v254, v252
  s_waitcnt lgkmcnt(6)
  v_mfma_f32_16x16x32_bf16 v[40:43], v[112:115], v[136:139], v[40:43]
  ds_read_b128 v[96:99], v224 offset:36864
  v_mov_b32 v251, v249
  v_mfma_f32_16x16x32_bf16 v[64:67], v[112:115], v[140:143], v[64:67]
  ds_read_b128 v[100:103], v224 offset:37888
  v_mov_b32 v255, v253
  v_mfma_f32_16x16x32_bf16 v[44:47], v[116:119], v[136:139], v[44:47]
  v_permlane16_swap_b32 v248, v250
  v_mfma_f32_16x16x32_bf16 v[68:71], v[116:119], v[140:143], v[68:71]
  v_permlane16_swap_b32 v252, v254
  s_waitcnt lgkmcnt(6)
  v_mfma_f32_16x16x32_bf16 v[48:51], v[136:139], v[120:123], v[48:51]
  v_permlane16_swap_b32 v249, v251
  v_mfma_f32_16x16x32_bf16 v[72:75], v[140:143], v[120:123], v[72:75]
  v_permlane16_swap_b32 v253, v255
  v_mfma_f32_16x16x32_bf16 v[52:55], v[136:139], v[124:127], v[52:55]
  v_pk_add_f32 v[248:249], v[248:249], v[250:251]
  v_mfma_f32_16x16x32_bf16 v[76:79], v[140:143], v[124:127], v[76:79]
  v_pk_add_f32 v[252:253], v[252:253], v[254:255]
  s_add_u32 s7, s11, 12288
  buffer_load_dwordx4 v[136:139], v15, s[56:59], s7 offen offset:1024 sc1
  s_add_u32 s7, s11, 73728
  buffer_load_dwordx4 v[140:143], v15, s[56:59], s7 offen offset:2048 sc1
  s_waitcnt vmcnt(22)
  s_waitcnt lgkmcnt(4)
  v_mfma_f32_16x16x32_bf16 v[32:35], v[80:83], v[144:147], v[32:35]
  ds_read_b128 v[104:107], v224 offset:30720
  v_mov_b32 v250, v248
  v_mfma_f32_16x16x32_bf16 v[56:59], v[80:83], v[148:151], v[56:59]
  ds_read_b128 v[108:111], v224 offset:31744
  v_mov_b32 v254, v252
  v_mfma_f32_16x16x32_bf16 v[36:39], v[84:87], v[144:147], v[36:39]
  ds_read_b128 v[112:115], v224 offset:34816
  v_mov_b32 v251, v249
  v_mfma_f32_16x16x32_bf16 v[60:63], v[84:87], v[148:151], v[60:63]
  ds_read_b128 v[116:119], v224 offset:35840
  v_mov_b32 v255, v253
  s_waitcnt lgkmcnt(6)
  v_mfma_f32_16x16x32_bf16 v[40:43], v[88:91], v[144:147], v[40:43]
  ds_read_b128 v[120:123], v224 offset:38912
  v_permlane32_swap_b32 v248, v250
  v_mfma_f32_16x16x32_bf16 v[64:67], v[88:91], v[148:151], v[64:67]
  ds_read_b128 v[124:127], v224 offset:39936
  v_permlane32_swap_b32 v252, v254
  v_mfma_f32_16x16x32_bf16 v[44:47], v[92:95], v[144:147], v[44:47]
  v_permlane32_swap_b32 v249, v251
  v_mfma_f32_16x16x32_bf16 v[68:71], v[92:95], v[148:151], v[68:71]
  v_permlane32_swap_b32 v253, v255
  s_waitcnt lgkmcnt(6)
  v_mfma_f32_16x16x32_bf16 v[48:51], v[144:147], v[96:99], v[48:51]
  v_pk_add_f32 v[248:249], v[248:249], v[250:251]
  v_mfma_f32_16x16x32_bf16 v[72:75], v[148:151], v[96:99], v[72:75]
  v_pk_add_f32 v[252:253], v[252:253], v[254:255]
  v_mfma_f32_16x16x32_bf16 v[52:55], v[144:147], v[100:103], v[52:55]
  v_mul_f32 v16, 0x3b000000, v248
  v_mfma_f32_16x16x32_bf16 v[76:79], v[148:151], v[100:103], v[76:79]
  v_mul_f32 v18, 0x3b000000, v252
  s_add_u32 s7, s11, 12288
  buffer_load_dwordx4 v[144:147], v15, s[56:59], s7 offen offset:2048 sc1
  s_add_u32 s7, s11, 73728
  buffer_load_dwordx4 v[148:151], v15, s[56:59], s7 offen offset:3072 sc1
  s_waitcnt vmcnt(22)
  s_waitcnt lgkmcnt(4)
  v_mfma_f32_16x16x32_bf16 v[32:35], v[104:107], v[152:155], v[32:35]
  ds_read_b128 v[80:83], v224 offset:40960
  v_mul_f32 v17, 0x3b000000, v249
  v_mfma_f32_16x16x32_bf16 v[56:59], v[104:107], v[156:159], v[56:59]
  ds_read_b128 v[84:87], v224 offset:41984
  v_mul_f32 v19, 0x3b000000, v253
  v_mfma_f32_16x16x32_bf16 v[36:39], v[108:111], v[152:155], v[36:39]
  ds_read_b128 v[88:91], v224 offset:45056
  v_fma_f32 v17, -v16, v16, v17
  v_mfma_f32_16x16x32_bf16 v[60:63], v[108:111], v[156:159], v[60:63]
  ds_read_b128 v[92:95], v224 offset:46080
  v_fma_f32 v19, -v18, v18, v19
  s_waitcnt lgkmcnt(6)
  v_mfma_f32_16x16x32_bf16 v[40:43], v[112:115], v[152:155], v[40:43]
  ds_read_b128 v[96:99], v224 offset:49152
  v_max_f32 v17, 0, v17
  v_mfma_f32_16x16x32_bf16 v[64:67], v[112:115], v[156:159], v[64:67]
  ds_read_b128 v[100:103], v224 offset:50176
  v_max_f32 v19, 0, v19
  v_mfma_f32_16x16x32_bf16 v[44:47], v[116:119], v[152:155], v[44:47]
  v_cvt_pk_bf16_f32 v248, v16, v16
  v_mfma_f32_16x16x32_bf16 v[68:71], v[116:119], v[156:159], v[68:71]
  v_cvt_pk_bf16_f32 v252, v18, v18
  s_waitcnt lgkmcnt(6)
  v_mfma_f32_16x16x32_bf16 v[48:51], v[152:155], v[120:123], v[48:51]
  v_lshlrev_b32 v16, 16, v248
  v_mfma_f32_16x16x32_bf16 v[72:75], v[156:159], v[120:123], v[72:75]
  v_lshlrev_b32 v18, 16, v252
  v_mfma_f32_16x16x32_bf16 v[52:55], v[152:155], v[124:127], v[52:55]
  v_cvt_pk_bf16_f32 v249, v17, v17
  v_mfma_f32_16x16x32_bf16 v[76:79], v[156:159], v[124:127], v[76:79]
  v_cvt_pk_bf16_f32 v253, v19, v19
  s_add_u32 s7, s11, 12288
  buffer_load_dwordx4 v[152:155], v15, s[56:59], s7 offen offset:3072 sc1
  s_add_u32 s7, s11, 77824
  buffer_load_dwordx4 v[156:159], v15, s[56:59], s7 offen offset:0 sc1
  s_waitcnt vmcnt(22)
  s_waitcnt lgkmcnt(4)
  v_mfma_f32_16x16x32_bf16 v[32:35], v[80:83], v[160:163], v[32:35]
  ds_read_b128 v[104:107], v224 offset:43008
  v_lshlrev_b32 v17, 16, v249
  v_mfma_f32_16x16x32_bf16 v[56:59], v[80:83], v[164:167], v[56:59]
  ds_read_b128 v[108:111], v224 offset:44032
  v_lshlrev_b32 v19, 16, v253
  v_mfma_f32_16x16x32_bf16 v[36:39], v[84:87], v[160:163], v[36:39]
  ds_read_b128 v[112:115], v224 offset:47104
  v_add_f32 v17, 0x3727c5ac, v17
  v_mfma_f32_16x16x32_bf16 v[60:63], v[84:87], v[164:167], v[60:63]
  ds_read_b128 v[116:119], v224 offset:48128
  v_add_f32 v19, 0x3727c5ac, v19
  s_waitcnt lgkmcnt(6)
  v_mfma_f32_16x16x32_bf16 v[40:43], v[88:91], v[160:163], v[40:43]
  ds_read_b128 v[120:123], v224 offset:51200
  v_cvt_pk_bf16_f32 v249, v17, v17
  v_mfma_f32_16x16x32_bf16 v[64:67], v[88:91], v[164:167], v[64:67]
  ds_read_b128 v[124:127], v224 offset:52224
  v_cvt_pk_bf16_f32 v253, v19, v19
  v_mfma_f32_16x16x32_bf16 v[44:47], v[92:95], v[160:163], v[44:47]
  v_lshlrev_b32 v17, 16, v249
  v_mfma_f32_16x16x32_bf16 v[68:71], v[92:95], v[164:167], v[68:71]
  v_lshlrev_b32 v19, 16, v253
  s_waitcnt lgkmcnt(6)
  v_mfma_f32_16x16x32_bf16 v[48:51], v[160:163], v[96:99], v[48:51]
  v_sqrt_f32 v17, v17
  v_mfma_f32_16x16x32_bf16 v[72:75], v[164:167], v[96:99], v[72:75]
  v_sqrt_f32 v19, v19
  v_mfma_f32_16x16x32_bf16 v[52:55], v[160:163], v[100:103], v[52:55]
  v_cvt_pk_bf16_f32 v249, v17, v17
  v_mfma_f32_16x16x32_bf16 v[76:79], v[164:167], v[100:103], v[76:79]
  v_cvt_pk_bf16_f32 v253, v19, v19
  s_waitcnt vmcnt(20)
  s_waitcnt lgkmcnt(4)
  v_mfma_f32_16x16x32_bf16 v[32:35], v[104:107], v[168:171], v[32:35]
  ds_read_b128 v[80:83], v224 offset:53248
  v_lshlrev_b32 v17, 16, v249
  v_mfma_f32_16x16x32_bf16 v[56:59], v[104:107], v[172:175], v[56:59]
  ds_read_b128 v[84:87], v224 offset:54272
  v_lshlrev_b32 v19, 16, v253
  v_mfma_f32_16x16x32_bf16 v[36:39], v[108:111], v[168:171], v[36:39]
  ds_read_b128 v[88:91], v224 offset:57344
  v_rcp_f32 v17, v17
  v_mfma_f32_16x16x32_bf16 v[60:63], v[108:111], v[172:175], v[60:63]
  ds_read_b128 v[92:95], v224 offset:58368
  v_rcp_f32 v19, v19
  s_waitcnt lgkmcnt(6)
  v_mfma_f32_16x16x32_bf16 v[40:43], v[112:115], v[168:171], v[40:43]
  ds_read_b128 v[96:99], v224 offset:61440
  v_sub_f32 v16, 0, v16
  v_mfma_f32_16x16x32_bf16 v[64:67], v[112:115], v[172:175], v[64:67]
  ds_read_b128 v[100:103], v224 offset:62464
  v_sub_f32 v18, 0, v18
  v_mfma_f32_16x16x32_bf16 v[44:47], v[116:119], v[168:171], v[44:47]
  v_mfma_f32_16x16x32_bf16 v[68:71], v[116:119], v[172:175], v[68:71]
  s_waitcnt lgkmcnt(6)
  v_mfma_f32_16x16x32_bf16 v[48:51], v[168:171], v[120:123], v[48:51]
  v_mfma_f32_16x16x32_bf16 v[72:75], v[172:175], v[120:123], v[72:75]
  v_mfma_f32_16x16x32_bf16 v[52:55], v[168:171], v[124:127], v[52:55]
  v_mfma_f32_16x16x32_bf16 v[76:79], v[172:175], v[124:127], v[76:79]
  s_waitcnt vmcnt(18)
  s_waitcnt lgkmcnt(4)
  v_mfma_f32_16x16x32_bf16 v[32:35], v[80:83], v[176:179], v[32:35]
  ds_read_b128 v[104:107], v224 offset:55296
  v_mfma_f32_16x16x32_bf16 v[56:59], v[80:83], v[180:183], v[56:59]
  ds_read_b128 v[108:111], v224 offset:56320
  v_mfma_f32_16x16x32_bf16 v[36:39], v[84:87], v[176:179], v[36:39]
  ds_read_b128 v[112:115], v224 offset:59392
  v_mfma_f32_16x16x32_bf16 v[60:63], v[84:87], v[180:183], v[60:63]
  ds_read_b128 v[116:119], v224 offset:60416
  s_waitcnt lgkmcnt(6)
  v_mfma_f32_16x16x32_bf16 v[40:43], v[88:91], v[176:179], v[40:43]
  ds_read_b128 v[120:123], v224 offset:63488
  v_mfma_f32_16x16x32_bf16 v[64:67], v[88:91], v[180:183], v[64:67]
  ds_read_b128 v[124:127], v224 offset:64512
  v_mfma_f32_16x16x32_bf16 v[44:47], v[92:95], v[176:179], v[44:47]
  v_mfma_f32_16x16x32_bf16 v[68:71], v[92:95], v[180:183], v[68:71]
  s_waitcnt lgkmcnt(6)
  v_mfma_f32_16x16x32_bf16 v[48:51], v[176:179], v[96:99], v[48:51]
  v_mfma_f32_16x16x32_bf16 v[72:75], v[180:183], v[96:99], v[72:75]
  v_mfma_f32_16x16x32_bf16 v[52:55], v[176:179], v[100:103], v[52:55]
  v_mfma_f32_16x16x32_bf16 v[76:79], v[180:183], v[100:103], v[76:79]
  s_waitcnt vmcnt(16)
  s_waitcnt lgkmcnt(4)
  v_mfma_f32_16x16x32_bf16 v[32:35], v[104:107], v[184:187], v[32:35]
  v_add_u32 v224, 65536, v224
  ds_read_b128 v[80:83], v224 offset:0
  v_mfma_f32_16x16x32_bf16 v[56:59], v[104:107], v[188:191], v[56:59]
  ds_read_b128 v[84:87], v224 offset:1024
  v_mfma_f32_16x16x32_bf16 v[36:39], v[108:111], v[184:187], v[36:39]
  ds_read_b128 v[88:91], v224 offset:4096
  v_mfma_f32_16x16x32_bf16 v[60:63], v[108:111], v[188:191], v[60:63]
  ds_read_b128 v[92:95], v224 offset:5120
  s_waitcnt lgkmcnt(6)
  v_mfma_f32_16x16x32_bf16 v[40:43], v[112:115], v[184:187], v[40:43]
  ds_read_b128 v[96:99], v224 offset:8192
  v_mfma_f32_16x16x32_bf16 v[64:67], v[112:115], v[188:191], v[64:67]
  ds_read_b128 v[100:103], v224 offset:9216
  v_mfma_f32_16x16x32_bf16 v[44:47], v[116:119], v[184:187], v[44:47]
  v_mfma_f32_16x16x32_bf16 v[68:71], v[116:119], v[188:191], v[68:71]
  s_waitcnt lgkmcnt(6)
  v_mfma_f32_16x16x32_bf16 v[48:51], v[184:187], v[120:123], v[48:51]
  v_mfma_f32_16x16x32_bf16 v[72:75], v[188:191], v[120:123], v[72:75]
  v_mfma_f32_16x16x32_bf16 v[52:55], v[184:187], v[124:127], v[52:55]
  v_mfma_f32_16x16x32_bf16 v[76:79], v[188:191], v[124:127], v[76:79]
  s_waitcnt vmcnt(14)
  s_waitcnt lgkmcnt(4)
  v_mfma_f32_16x16x32_bf16 v[32:35], v[80:83], v[192:195], v[32:35]
  ds_read_b128 v[104:107], v224 offset:2048
  v_mfma_f32_16x16x32_bf16 v[56:59], v[80:83], v[196:199], v[56:59]
  ds_read_b128 v[108:111], v224 offset:3072
  v_mfma_f32_16x16x32_bf16 v[36:39], v[84:87], v[192:195], v[36:39]
  ds_read_b128 v[112:115], v224 offset:6144
  v_mfma_f32_16x16x32_bf16 v[60:63], v[84:87], v[196:199], v[60:63]
  ds_read_b128 v[116:119], v224 offset:7168
  s_waitcnt lgkmcnt(6)
  v_mfma_f32_16x16x32_bf16 v[40:43], v[88:91], v[192:195], v[40:43]
  ds_read_b128 v[120:123], v224 offset:10240
  v_mfma_f32_16x16x32_bf16 v[64:67], v[88:91], v[196:199], v[64:67]
  ds_read_b128 v[124:127], v224 offset:11264
  v_mfma_f32_16x16x32_bf16 v[44:47], v[92:95], v[192:195], v[44:47]
  v_mfma_f32_16x16x32_bf16 v[68:71], v[92:95], v[196:199], v[68:71]
  s_waitcnt lgkmcnt(6)
  v_mfma_f32_16x16x32_bf16 v[48:51], v[192:195], v[96:99], v[48:51]
  v_mfma_f32_16x16x32_bf16 v[72:75], v[196:199], v[96:99], v[72:75]
  v_mfma_f32_16x16x32_bf16 v[52:55], v[192:195], v[100:103], v[52:55]
  v_mfma_f32_16x16x32_bf16 v[76:79], v[196:199], v[100:103], v[76:79]
  s_waitcnt vmcnt(12)
  s_waitcnt lgkmcnt(4)
  v_mfma_f32_16x16x32_bf16 v[32:35], v[104:107], v[200:203], v[32:35]
  ds_read_b128 v[80:83], v224 offset:12288
  v_mfma_f32_16x16x32_bf16 v[56:59], v[104:107], v[204:207], v[56:59]
  ds_read_b128 v[84:87], v224 offset:13312
  v_mfma_f32_16x16x32_bf16 v[36:39], v[108:111], v[200:203], v[36:39]
  ds_read_b128 v[88:91], v224 offset:16384
  v_mfma_f32_16x16x32_bf16 v[60:63], v[108:111], v[204:207], v[60:63]
  ds_read_b128 v[92:95], v224 offset:17408
  s_waitcnt lgkmcnt(6)
  v_mfma_f32_16x16x32_bf16 v[40:43], v[112:115], v[200:203], v[40:43]
  ds_read_b128 v[96:99], v224 offset:20480
  v_mfma_f32_16x16x32_bf16 v[64:67], v[112:115], v[204:207], v[64:67]
  ds_read_b128 v[100:103], v224 offset:21504
  v_mfma_f32_16x16x32_bf16 v[44:47], v[116:119], v[200:203], v[44:47]
  v_mfma_f32_16x16x32_bf16 v[68:71], v[116:119], v[204:207], v[68:71]
  s_waitcnt lgkmcnt(6)
  v_mfma_f32_16x16x32_bf16 v[48:51], v[200:203], v[120:123], v[48:51]
  v_mfma_f32_16x16x32_bf16 v[72:75], v[204:207], v[120:123], v[72:75]
  v_mfma_f32_16x16x32_bf16 v[52:55], v[200:203], v[124:127], v[52:55]
  v_mfma_f32_16x16x32_bf16 v[76:79], v[204:207], v[124:127], v[76:79]
  s_waitcnt vmcnt(10)
  s_waitcnt lgkmcnt(4)
  v_mfma_f32_16x16x32_bf16 v[32:35], v[80:83], v[208:211], v[32:35]
  ds_read_b128 v[104:107], v224 offset:14336
  v_mfma_f32_16x16x32_bf16 v[56:59], v[80:83], v[212:215], v[56:59]
  ds_read_b128 v[108:111], v224 offset:15360
  v_mfma_f32_16x16x32_bf16 v[36:39], v[84:87], v[208:211], v[36:39]
  ds_read_b128 v[112:115], v224 offset:18432
  v_mfma_f32_16x16x32_bf16 v[60:63], v[84:87], v[212:215], v[60:63]
  ds_read_b128 v[116:119], v224 offset:19456
  s_waitcnt lgkmcnt(6)
  v_mfma_f32_16x16x32_bf16 v[40:43], v[88:91], v[208:211], v[40:43]
  ds_read_b128 v[120:123], v224 offset:22528
  v_mfma_f32_16x16x32_bf16 v[64:67], v[88:91], v[212:215], v[64:67]
  ds_read_b128 v[124:127], v224 offset:23552
  v_mfma_f32_16x16x32_bf16 v[44:47], v[92:95], v[208:211], v[44:47]
  v_mfma_f32_16x16x32_bf16 v[68:71], v[92:95], v[212:215], v[68:71]
  s_waitcnt lgkmcnt(6)
  v_mfma_f32_16x16x32_bf16 v[48:51], v[208:211], v[96:99], v[48:51]
  v_mfma_f32_16x16x32_bf16 v[72:75], v[212:215], v[96:99], v[72:75]
  v_mfma_f32_16x16x32_bf16 v[52:55], v[208:211], v[100:103], v[52:55]
  v_mfma_f32_16x16x32_bf16 v[76:79], v[212:215], v[100:103], v[76:79]
  s_waitcnt vmcnt(8)
  s_waitcnt lgkmcnt(4)
  v_mfma_f32_16x16x32_bf16 v[32:35], v[104:107], v[216:219], v[32:35]
  ds_read_b128 v[80:83], v224 offset:24576
  v_mfma_f32_16x16x32_bf16 v[56:59], v[104:107], v[220:223], v[56:59]
  ds_read_b128 v[84:87], v224 offset:25600
  v_mfma_f32_16x16x32_bf16 v[36:39], v[108:111], v[216:219], v[36:39]
  ds_read_b128 v[88:91], v224 offset:28672
  v_mfma_f32_16x16x32_bf16 v[60:63], v[108:111], v[220:223], v[60:63]
  ds_read_b128 v[92:95], v224 offset:29696
  s_waitcnt lgkmcnt(6)
  v_mfma_f32_16x16x32_bf16 v[40:43], v[112:115], v[216:219], v[40:43]
  ds_read_b128 v[96:99], v224 offset:32768
  v_mfma_f32_16x16x32_bf16 v[64:67], v[112:115], v[220:223], v[64:67]
  ds_read_b128 v[100:103], v224 offset:33792
  v_mfma_f32_16x16x32_bf16 v[44:47], v[116:119], v[216:219], v[44:47]
  v_mfma_f32_16x16x32_bf16 v[68:71], v[116:119], v[220:223], v[68:71]
  s_waitcnt lgkmcnt(6)
  v_mfma_f32_16x16x32_bf16 v[48:51], v[216:219], v[120:123], v[48:51]
  v_mfma_f32_16x16x32_bf16 v[72:75], v[220:223], v[120:123], v[72:75]
  v_mfma_f32_16x16x32_bf16 v[52:55], v[216:219], v[124:127], v[52:55]
  v_mfma_f32_16x16x32_bf16 v[76:79], v[220:223], v[124:127], v[76:79]
  s_waitcnt vmcnt(6)
  s_waitcnt lgkmcnt(4)
  v_mfma_f32_16x16x32_bf16 v[32:35], v[80:83], v[128:131], v[32:35]
  ds_read_b128 v[104:107], v224 offset:26624
  v_mfma_f32_16x16x32_bf16 v[56:59], v[80:83], v[132:135], v[56:59]
  ds_read_b128 v[108:111], v224 offset:27648
  v_mfma_f32_16x16x32_bf16 v[36:39], v[84:87], v[128:131], v[36:39]
  ds_read_b128 v[112:115], v224 offset:30720
  v_mfma_f32_16x16x32_bf16 v[60:63], v[84:87], v[132:135], v[60:63]
  ds_read_b128 v[116:119], v224 offset:31744
  s_waitcnt lgkmcnt(6)
  v_mfma_f32_16x16x32_bf16 v[40:43], v[88:91], v[128:131], v[40:43]
  ds_read_b128 v[120:123], v224 offset:34816
  v_mfma_f32_16x16x32_bf16 v[64:67], v[88:91], v[132:135], v[64:67]
  ds_read_b128 v[124:127], v224 offset:35840
  v_mfma_f32_16x16x32_bf16 v[44:47], v[92:95], v[128:131], v[44:47]
  v_mfma_f32_16x16x32_bf16 v[68:71], v[92:95], v[132:135], v[68:71]
  s_waitcnt lgkmcnt(6)
  v_mfma_f32_16x16x32_bf16 v[48:51], v[128:131], v[96:99], v[48:51]
  v_mfma_f32_16x16x32_bf16 v[72:75], v[132:135], v[96:99], v[72:75]
  v_mfma_f32_16x16x32_bf16 v[52:55], v[128:131], v[100:103], v[52:55]
  v_mfma_f32_16x16x32_bf16 v[76:79], v[132:135], v[100:103], v[76:79]
  s_waitcnt vmcnt(4)
  s_waitcnt lgkmcnt(4)
  v_mfma_f32_16x16x32_bf16 v[32:35], v[104:107], v[136:139], v[32:35]
  ds_read_b128 v[80:83], v224 offset:36864
  v_mfma_f32_16x16x32_bf16 v[56:59], v[104:107], v[140:143], v[56:59]
  ds_read_b128 v[84:87], v224 offset:37888
  v_mfma_f32_16x16x32_bf16 v[36:39], v[108:111], v[136:139], v[36:39]
  ds_read_b128 v[88:91], v224 offset:40960
  v_mfma_f32_16x16x32_bf16 v[60:63], v[108:111], v[140:143], v[60:63]
  ds_read_b128 v[92:95], v224 offset:41984
  s_waitcnt lgkmcnt(6)
  v_mfma_f32_16x16x32_bf16 v[40:43], v[112:115], v[136:139], v[40:43]
  ds_read_b128 v[96:99], v224 offset:45056
  v_mfma_f32_16x16x32_bf16 v[64:67], v[112:115], v[140:143], v[64:67]
  ds_read_b128 v[100:103], v224 offset:46080
  v_mfma_f32_16x16x32_bf16 v[44:47], v[116:119], v[136:139], v[44:47]
  v_mfma_f32_16x16x32_bf16 v[68:71], v[116:119], v[140:143], v[68:71]
  s_waitcnt lgkmcnt(6)
  v_mfma_f32_16x16x32_bf16 v[48:51], v[136:139], v[120:123], v[48:51]
  v_mfma_f32_16x16x32_bf16 v[72:75], v[140:143], v[120:123], v[72:75]
  v_mfma_f32_16x16x32_bf16 v[52:55], v[136:139], v[124:127], v[52:55]
  v_mfma_f32_16x16x32_bf16 v[76:79], v[140:143], v[124:127], v[76:79]
  s_waitcnt vmcnt(2)
  s_waitcnt lgkmcnt(4)
  v_mfma_f32_16x16x32_bf16 v[32:35], v[80:83], v[144:147], v[32:35]
  ds_read_b128 v[104:107], v224 offset:38912
  v_mfma_f32_16x16x32_bf16 v[56:59], v[80:83], v[148:151], v[56:59]
  ds_read_b128 v[108:111], v224 offset:39936
  v_mfma_f32_16x16x32_bf16 v[36:39], v[84:87], v[144:147], v[36:39]
  ds_read_b128 v[112:115], v224 offset:43008
  v_mfma_f32_16x16x32_bf16 v[60:63], v[84:87], v[148:151], v[60:63]
  ds_read_b128 v[116:119], v224 offset:44032
  s_waitcnt lgkmcnt(6)
  v_mfma_f32_16x16x32_bf16 v[40:43], v[88:91], v[144:147], v[40:43]
  ds_read_b128 v[120:123], v224 offset:47104
  v_mfma_f32_16x16x32_bf16 v[64:67], v[88:91], v[148:151], v[64:67]
  ds_read_b128 v[124:127], v224 offset:48128
  v_mfma_f32_16x16x32_bf16 v[44:47], v[92:95], v[144:147], v[44:47]
  v_mfma_f32_16x16x32_bf16 v[68:71], v[92:95], v[148:151], v[68:71]
  s_waitcnt lgkmcnt(6)
  v_mfma_f32_16x16x32_bf16 v[48:51], v[144:147], v[96:99], v[48:51]
  v_mfma_f32_16x16x32_bf16 v[72:75], v[148:151], v[96:99], v[72:75]
  v_mfma_f32_16x16x32_bf16 v[52:55], v[144:147], v[100:103], v[52:55]
  v_mfma_f32_16x16x32_bf16 v[76:79], v[148:151], v[100:103], v[76:79]
  s_waitcnt vmcnt(0)
  s_waitcnt lgkmcnt(4)
  v_mfma_f32_16x16x32_bf16 v[32:35], v[104:107], v[152:155], v[32:35]
  v_lshlrev_b32 v180, 4, v3
  v_lshlrev_b32 v181, 2, v2
  v_add_u32 v180, 159744, v180
  v_add_u32 v181, 159744, v181
  ds_read_b128 v[192:195], v180 offset:128
  ds_read_b128 v[196:199], v180 offset:192
  v_mfma_f32_16x16x32_bf16 v[56:59], v[104:107], v[156:159], v[56:59]
  ds_read_b32 v200, v181 offset:256
  ds_read_b32 v201, v181 offset:320
  v_mfma_f32_16x16x32_bf16 v[36:39], v[108:111], v[152:155], v[36:39]
  ds_read_b128 v[184:187], v180 offset:0
  ds_read_b128 v[188:191], v180 offset:64
  v_mfma_f32_16x16x32_bf16 v[60:63], v[108:111], v[156:159], v[60:63]
  ds_bpermute_b32 v132, v24, v16
  ds_bpermute_b32 v128, v24, v17
  s_waitcnt lgkmcnt(10)
  v_mfma_f32_16x16x32_bf16 v[40:43], v[112:115], v[152:155], v[40:43]
  ds_bpermute_b32 v133, v25, v16
  ds_bpermute_b32 v129, v25, v17
  v_mfma_f32_16x16x32_bf16 v[64:67], v[112:115], v[156:159], v[64:67]
  ds_bpermute_b32 v134, v26, v16
  ds_bpermute_b32 v130, v26, v17
  v_mfma_f32_16x16x32_bf16 v[44:47], v[116:119], v[152:155], v[44:47]
  ds_bpermute_b32 v135, v27, v16
  ds_bpermute_b32 v131, v27, v17
  v_mfma_f32_16x16x32_bf16 v[68:71], v[116:119], v[156:159], v[68:71]
  ds_bpermute_b32 v140, v24, v18
  ds_bpermute_b32 v136, v24, v19
  s_waitcnt lgkmcnt(15)
  v_mfma_f32_16x16x32_bf16 v[48:51], v[152:155], v[120:123], v[48:51]
  ds_bpermute_b32 v141, v25, v18
  ds_bpermute_b32 v137, v25, v19
  v_mfma_f32_16x16x32_bf16 v[72:75], v[156:159], v[120:123], v[72:75]
  ds_bpermute_b32 v142, v26, v18
  ds_bpermute_b32 v138, v26, v19
  v_mfma_f32_16x16x32_bf16 v[52:55], v[152:155], v[124:127], v[52:55]
  ds_bpermute_b32 v143, v27, v18
  ds_bpermute_b32 v139, v27, v19
  v_mfma_f32_16x16x32_bf16 v[76:79], v[156:159], v[124:127], v[76:79]
  v_mov_b32 v202, 0x3fb8aa3b
  v_mov_b32 v203, 0x3fb8aa3b
  s_waitcnt lgkmcnt(0)
  s_lshl_b32 s7, s5, 2
  s_add_u32 s6, s15, 2
  s_add_u32 s7, s7, 161808
  v_mov_b32 v232, s6
  v_mov_b32 v233, s7
  s_mov_b64 exec, 1
  ds_write_b32 v233, v232
  s_mov_b64 exec, -1
  v_pk_fma_f32 v[40:41], v[192:193], v[16:17], v[40:41] op_sel_hi:[1,0,1]
  v_pk_fma_f32 v[64:65], v[192:193], v[18:19], v[64:65] op_sel_hi:[1,0,1]
  v_pk_fma_f32 v[42:43], v[194:195], v[16:17], v[42:43] op_sel_hi:[1,0,1]
  v_pk_fma_f32 v[66:67], v[194:195], v[18:19], v[66:67] op_sel_hi:[1,0,1]
  v_pk_mul_f32 v[40:41], v[40:41], v[16:17] op_sel:[0,1] op_sel_hi:[1,1]
  v_pk_mul_f32 v[64:65], v[64:65], v[18:19] op_sel:[0,1] op_sel_hi:[1,1]
  v_pk_mul_f32 v[42:43], v[42:43], v[16:17] op_sel:[0,1] op_sel_hi:[1,1]
  v_pk_mul_f32 v[66:67], v[66:67], v[18:19] op_sel:[0,1] op_sel_hi:[1,1]
  v_pk_fma_f32 v[44:45], v[196:197], v[16:17], v[44:45] op_sel_hi:[1,0,1]
  v_pk_fma_f32 v[68:69], v[196:197], v[18:19], v[68:69] op_sel_hi:[1,0,1]
  v_pk_fma_f32 v[46:47], v[198:199], v[16:17], v[46:47] op_sel_hi:[1,0,1]
  v_pk_fma_f32 v[70:71], v[198:199], v[18:19], v[70:71] op_sel_hi:[1,0,1]
  v_pk_mul_f32 v[44:45], v[44:45], v[16:17] op_sel:[0,1] op_sel_hi:[1,1]
  v_pk_mul_f32 v[68:69], v[68:69], v[18:19] op_sel:[0,1] op_sel_hi:[1,1]
  v_pk_mul_f32 v[46:47], v[46:47], v[16:17] op_sel:[0,1] op_sel_hi:[1,1]
  v_pk_mul_f32 v[70:71], v[70:71], v[18:19] op_sel:[0,1] op_sel_hi:[1,1]
  v_cvt_pk_bf16_f32 v212, v40, v41
  v_cvt_pk_bf16_f32 v152, v64, v65
  v_cvt_pk_bf16_f32 v213, v42, v43
  v_cvt_pk_bf16_f32 v153, v66, v67
  v_cvt_pk_bf16_f32 v214, v44, v45
  v_cvt_pk_bf16_f32 v154, v68, v69
  v_cvt_pk_bf16_f32 v215, v46, v47
  v_cvt_pk_bf16_f32 v155, v70, v71
  v_mfma_f32_16x16x16_bf16 v[216:219], v[28:29], v[212:213], 0
  v_mfma_f32_16x16x16_bf16 v[156:159], v[28:29], v[152:153], 0
  v_mfma_f32_16x16x16_bf16 v[220:223], v[30:31], v[214:215], 0
  v_mfma_f32_16x16x16_bf16 v[160:163], v[30:31], v[154:155], 0
  v_pk_fma_f32 v[48:49], v[132:133], v[200:201], v[48:49] op_sel_hi:[1,0,1]
  v_pk_fma_f32 v[72:73], v[140:141], v[200:201], v[72:73] op_sel_hi:[1,0,1]
  v_pk_fma_f32 v[50:51], v[134:135], v[200:201], v[50:51] op_sel_hi:[1,0,1]
  v_pk_fma_f32 v[74:75], v[142:143], v[200:201], v[74:75] op_sel_hi:[1,0,1]
  v_pk_mul_f32 v[48:49], v[48:49], v[128:129]
  v_pk_mul_f32 v[72:73], v[72:73], v[136:137]
  v_pk_mul_f32 v[50:51], v[50:51], v[130:131]
  v_pk_mul_f32 v[74:75], v[74:75], v[138:139]
  v_cvt_pk_bf16_f32 v204, v48, v49
  v_cvt_pk_bf16_f32 v206, v72, v73
  v_cvt_pk_bf16_f32 v205, v50, v51
  v_cvt_pk_bf16_f32 v207, v74, v75
  v_pk_fma_f32 v[52:53], v[132:133], v[200:201], v[52:53] op_sel:[0,1,0] op_sel_hi:[1,1,1]
  v_pk_fma_f32 v[76:77], v[140:141], v[200:201], v[76:77] op_sel:[0,1,0] op_sel_hi:[1,1,1]
  v_pk_fma_f32 v[54:55], v[134:135], v[200:201], v[54:55] op_sel:[0,1,0] op_sel_hi:[1,1,1]
  v_pk_fma_f32 v[78:79], v[142:143], v[200:201], v[78:79] op_sel:[0,1,0] op_sel_hi:[1,1,1]
  v_pk_mul_f32 v[52:53], v[52:53], v[128:129]
  v_pk_mul_f32 v[76:77], v[76:77], v[136:137]
  v_pk_mul_f32 v[54:55], v[54:55], v[130:131]
  v_pk_mul_f32 v[78:79], v[78:79], v[138:139]
  v_cvt_pk_bf16_f32 v208, v52, v53
  v_cvt_pk_bf16_f32 v210, v76, v77
  v_cvt_pk_bf16_f32 v209, v54, v55
  v_cvt_pk_bf16_f32 v211, v78, v79
  v_cvt_pk_bf16_f32 v212, v216, v217
  v_cvt_pk_bf16_f32 v152, v156, v157
  v_cvt_pk_bf16_f32 v213, v218, v219
  v_cvt_pk_bf16_f32 v153, v158, v159
  v_lshlrev_b32 v216, 16, v212
  v_lshlrev_b32 v156, 16, v152
  v_and_b32 v217, 0xffff0000, v212
  v_and_b32 v157, 0xffff0000, v152
  v_lshlrev_b32 v218, 16, v213
  v_lshlrev_b32 v158, 16, v153
  v_and_b32 v219, 0xffff0000, v213
  v_and_b32 v159, 0xffff0000, v153
  v_cvt_pk_bf16_f32 v214, v220, v221
  v_cvt_pk_bf16_f32 v154, v160, v161
  v_cvt_pk_bf16_f32 v215, v222, v223
  v_cvt_pk_bf16_f32 v155, v162, v163
  v_lshlrev_b32 v220, 16, v214
  v_lshlrev_b32 v160, 16, v154
  v_and_b32 v221, 0xffff0000, v214
  v_and_b32 v161, 0xffff0000, v154
  v_lshlrev_b32 v222, 16, v215
  v_lshlrev_b32 v162, 16, v155
  v_and_b32 v223, 0xffff0000, v215
  v_and_b32 v163, 0xffff0000, v155
  v_max3_f32 v232, v216, v217, v218
  v_max3_f32 v172, v156, v157, v158
  v_max3_f32 v234, -v216, -v217, -v218
  v_max3_f32 v174, -v156, -v157, -v158
  v_max_f32 v232, v232, v219
  v_max_f32 v172, v172, v159
  v_max_f32_e64 v234, v234, -v219
  v_max_f32_e64 v174, v174, -v159
  v_max3_f32 v236, v220, v221, v222
  v_max3_f32 v176, v160, v161, v162
  v_max3_f32 v238, -v220, -v221, -v222
  v_max3_f32 v178, -v160, -v161, -v162
  v_max_f32 v236, v236, v223
  v_max_f32 v176, v176, v163
  v_max_f32_e64 v238, v238, -v223
  v_max_f32_e64 v178, v178, -v163
  v_permlane16_swap_b32 v232, v234
  v_permlane16_swap_b32 v172, v174
  v_permlane16_swap_b32 v236, v238
  v_permlane16_swap_b32 v176, v178
  v_max_f32 v232, v232, v234
  v_max_f32 v172, v172, v174
  v_max_f32 v236, v236, v238
  v_max_f32 v176, v176, v178
  s_nop 0
  v_permlane32_swap_b32 v232, v236
  v_permlane32_swap_b32 v172, v176
  v_max_f32 v232, v232, v236
  v_max_f32 v172, v172, v176
  v_mul_f32 v232, 0xbfb8aa3b, v232
  v_mul_f32 v172, 0xbfb8aa3b, v172
  v_mov_b32 v236, v232
  v_mov_b32 v176, v172
  s_nop 0
  v_permlane32_swap_b32 v232, v236
  v_permlane32_swap_b32 v172, v176
  v_mov_b32 v234, v232
  v_mov_b32 v174, v172
  v_mov_b32 v238, v236
  v_mov_b32 v178, v176
  v_permlane16_swap_b32 v232, v234
  v_permlane16_swap_b32 v172, v174
  v_permlane16_swap_b32 v236, v238
  v_permlane16_swap_b32 v176, v178
  v_pk_fma_f32 v[224:225], v[216:217], v[202:203], v[234:235] op_sel_hi:[1,1,0] neg_lo:[0,1,0] neg_hi:[0,1,0]
  v_pk_fma_f32 v[164:165], v[156:157], v[202:203], v[174:175] op_sel_hi:[1,1,0] neg_lo:[0,1,0] neg_hi:[0,1,0]
  v_pk_fma_f32 v[226:227], v[218:219], v[202:203], v[234:235] op_sel_hi:[1,1,0] neg_lo:[0,1,0] neg_hi:[0,1,0]
  v_pk_fma_f32 v[166:167], v[158:159], v[202:203], v[174:175] op_sel_hi:[1,1,0] neg_lo:[0,1,0] neg_hi:[0,1,0]
  v_pk_fma_f32 v[216:217], v[216:217], v[202:203], v[232:233] op_sel_hi:[1,1,0]
  v_pk_fma_f32 v[156:157], v[156:157], v[202:203], v[172:173] op_sel_hi:[1,1,0]
  v_pk_fma_f32 v[218:219], v[218:219], v[202:203], v[232:233] op_sel_hi:[1,1,0]
  v_pk_fma_f32 v[158:159], v[158:159], v[202:203], v[172:173] op_sel_hi:[1,1,0]
  v_pk_fma_f32 v[228:229], v[220:221], v[202:203], v[238:239] op_sel_hi:[1,1,0] neg_lo:[0,1,0] neg_hi:[0,1,0]
  v_pk_fma_f32 v[168:169], v[160:161], v[202:203], v[178:179] op_sel_hi:[1,1,0] neg_lo:[0,1,0] neg_hi:[0,1,0]
  v_pk_fma_f32 v[230:231], v[222:223], v[202:203], v[238:239] op_sel_hi:[1,1,0] neg_lo:[0,1,0] neg_hi:[0,1,0]
  v_pk_fma_f32 v[170:171], v[162:163], v[202:203], v[178:179] op_sel_hi:[1,1,0] neg_lo:[0,1,0] neg_hi:[0,1,0]
  v_pk_fma_f32 v[220:221], v[220:221], v[202:203], v[236:237] op_sel_hi:[1,1,0]
  v_pk_fma_f32 v[160:161], v[160:161], v[202:203], v[176:177] op_sel_hi:[1,1,0]
  v_pk_fma_f32 v[222:223], v[222:223], v[202:203], v[236:237] op_sel_hi:[1,1,0]
  v_pk_fma_f32 v[162:163], v[162:163], v[202:203], v[176:177] op_sel_hi:[1,1,0]
  v_exp_f32 v216, v216
  v_exp_f32 v156, v156
  v_exp_f32 v217, v217
  v_exp_f32 v157, v157
  v_exp_f32 v218, v218
  v_exp_f32 v158, v158
  v_exp_f32 v219, v219
  v_exp_f32 v159, v159
  v_exp_f32 v224, v224
  v_exp_f32 v164, v164
  v_exp_f32 v225, v225
  v_exp_f32 v165, v165
  v_exp_f32 v226, v226
  v_exp_f32 v166, v166
  v_exp_f32 v227, v227
  v_exp_f32 v167, v167
  v_exp_f32 v220, v220
  v_exp_f32 v160, v160
  v_exp_f32 v221, v221
  v_exp_f32 v161, v161
  v_exp_f32 v222, v222
  v_exp_f32 v162, v162
  v_exp_f32 v223, v223
  v_exp_f32 v163, v163
  v_exp_f32 v228, v228
  v_exp_f32 v168, v168
  v_exp_f32 v229, v229
  v_exp_f32 v169, v169
  v_exp_f32 v230, v230
  v_exp_f32 v170, v170
  v_exp_f32 v231, v231
  v_exp_f32 v171, v171
  v_pk_add_f32 v[232:233], v[216:217], v[218:219]
  v_pk_add_f32 v[172:173], v[156:157], v[158:159]
  v_pk_add_f32 v[234:235], v[224:225], v[226:227]
  v_pk_add_f32 v[174:175], v[164:165], v[166:167]
  v_pk_add_f32 v[236:237], v[220:221], v[222:223]
  v_pk_add_f32 v[176:177], v[160:161], v[162:163]
  v_pk_add_f32 v[238:239], v[228:229], v[230:231]
  v_pk_add_f32 v[178:179], v[168:169], v[170:171]
  v_add_f32 v232, v232, v233
  v_add_f32 v172, v172, v173
  v_add_f32 v234, v234, v235
  v_add_f32 v174, v174, v175
  v_add_f32 v236, v236, v237
  v_add_f32 v176, v176, v177
  v_add_f32 v238, v238, v239
  v_add_f32 v178, v178, v179
  v_permlane16_swap_b32 v232, v234
  v_permlane16_swap_b32 v172, v174
  v_permlane16_swap_b32 v236, v238
  v_permlane16_swap_b32 v176, v178
  v_add_f32 v232, v232, v234
  v_add_f32 v172, v172, v174
  v_add_f32 v236, v236, v238
  v_add_f32 v176, v176, v178
  s_nop 0
  v_permlane32_swap_b32 v232, v236
  v_permlane32_swap_b32 v172, v176
  v_add_f32 v232, v232, v236
  v_add_f32 v172, v172, v176
  v_rcp_f32 v232, v232
  v_rcp_f32 v172, v172
  v_mov_b32 v236, v232
  v_mov_b32 v176, v172
  s_nop 0
  v_permlane32_swap_b32 v232, v236
  v_permlane32_swap_b32 v172, v176
  v_mov_b32 v234, v232
  v_mov_b32 v174, v172
  v_mov_b32 v238, v236
  v_mov_b32 v178, v176
  v_permlane16_swap_b32 v232, v234
  v_permlane16_swap_b32 v172, v174
  v_permlane16_swap_b32 v236, v238
  v_permlane16_swap_b32 v176, v178
  v_pk_mul_f32 v[216:217], v[216:217], v[232:233] op_sel_hi:[1,0]
  v_pk_mul_f32 v[156:157], v[156:157], v[172:173] op_sel_hi:[1,0]
  v_pk_mul_f32 v[218:219], v[218:219], v[232:233] op_sel_hi:[1,0]
  v_pk_mul_f32 v[158:159], v[158:159], v[172:173] op_sel_hi:[1,0]
  v_pk_mul_f32 v[224:225], v[224:225], v[234:235] op_sel_hi:[1,0]
  v_pk_mul_f32 v[164:165], v[164:165], v[174:175] op_sel_hi:[1,0]
  v_pk_mul_f32 v[226:227], v[226:227], v[234:235] op_sel_hi:[1,0]
  v_pk_mul_f32 v[166:167], v[166:167], v[174:175] op_sel_hi:[1,0]
  v_pk_mul_f32 v[220:221], v[220:221], v[236:237] op_sel_hi:[1,0]
  v_pk_mul_f32 v[160:161], v[160:161], v[176:177] op_sel_hi:[1,0]
  v_pk_mul_f32 v[222:223], v[222:223], v[236:237] op_sel_hi:[1,0]
  v_pk_mul_f32 v[162:163], v[162:163], v[176:177] op_sel_hi:[1,0]
  v_pk_mul_f32 v[228:229], v[228:229], v[238:239] op_sel_hi:[1,0]
  v_pk_mul_f32 v[168:169], v[168:169], v[178:179] op_sel_hi:[1,0]
  v_pk_mul_f32 v[230:231], v[230:231], v[238:239] op_sel_hi:[1,0]
  v_pk_mul_f32 v[170:171], v[170:171], v[178:179] op_sel_hi:[1,0]
  v_cvt_pk_bf16_f32 v216, v216, v217
  v_cvt_pk_bf16_f32 v156, v156, v157
  v_cvt_pk_bf16_f32 v217, v218, v219
  v_cvt_pk_bf16_f32 v157, v158, v159
  s_nop 0
  v_mfma_f32_16x16x16_bf16 v[40:43], v[216:217], v[22:23], 0
  v_mfma_f32_16x16x16_bf16 v[64:67], v[156:157], v[22:23], 0
  v_cvt_pk_bf16_f32 v224, v224, v225
  v_cvt_pk_bf16_f32 v164, v164, v165
  v_cvt_pk_bf16_f32 v225, v226, v227
  v_cvt_pk_bf16_f32 v165, v166, v167
  s_nop 0
  v_mfma_f32_16x16x16_bf16 v[44:47], v[224:225], v[22:23], 0
  v_mfma_f32_16x16x16_bf16 v[68:71], v[164:165], v[22:23], 0
  v_cvt_pk_bf16_f32 v220, v220, v221
  v_cvt_pk_bf16_f32 v160, v160, v161
  v_cvt_pk_bf16_f32 v221, v222, v223
  v_cvt_pk_bf16_f32 v161, v162, v163
  s_nop 0
  v_mfma_f32_16x16x16_bf16 v[48:51], v[220:221], v[22:23], 0
  v_mfma_f32_16x16x16_bf16 v[72:75], v[160:161], v[22:23], 0
  v_cvt_pk_bf16_f32 v228, v228, v229
  v_cvt_pk_bf16_f32 v168, v168, v169
  v_cvt_pk_bf16_f32 v229, v230, v231
  v_cvt_pk_bf16_f32 v169, v170, v171
  s_nop 0
  v_mfma_f32_16x16x16_bf16 v[52:55], v[228:229], v[22:23], 0
  v_mfma_f32_16x16x16_bf16 v[76:79], v[168:169], v[22:23], 0
  v_cvt_pk_bf16_f32 v80, v40, v41
  v_cvt_pk_bf16_f32 v82, v64, v65
  v_cvt_pk_bf16_f32 v81, v42, v43
  v_cvt_pk_bf16_f32 v83, v66, v67
  v_cvt_pk_bf16_f32 v84, v44, v45
  v_cvt_pk_bf16_f32 v86, v68, v69
  v_cvt_pk_bf16_f32 v85, v46, v47
  v_cvt_pk_bf16_f32 v87, v70, v71
  v_cvt_pk_bf16_f32 v88, v48, v49
  v_cvt_pk_bf16_f32 v90, v72, v73
  v_cvt_pk_bf16_f32 v89, v50, v51
  v_cvt_pk_bf16_f32 v91, v74, v75
  v_cvt_pk_bf16_f32 v92, v52, v53
  v_cvt_pk_bf16_f32 v94, v76, v77
  v_cvt_pk_bf16_f32 v93, v54, v55
  v_cvt_pk_bf16_f32 v95, v78, v79
  v_mfma_f32_16x16x32_bf16 v[120:123], v[80:83], v[204:207], 0
  v_mfma_f32_16x16x32_bf16 v[124:127], v[84:87], v[204:207], 0
  v_mfma_f32_16x16x32_bf16 v[128:131], v[88:91], v[208:211], 0
  v_mfma_f32_16x16x32_bf16 v[132:135], v[92:95], v[208:211], 0
  v_mfma_f32_16x16x32_bf16 v[136:139], v[80:83], v[8:11], 0
  v_mfma_f32_16x16x32_bf16 v[140:143], v[84:87], v[8:11], 0
  v_mfma_f32_16x16x32_bf16 v[144:147], v[88:91], v[8:11], 0
  v_mfma_f32_16x16x32_bf16 v[148:151], v[92:95], v[8:11], 0
  v_mov_b32 v234, 161808
  s_add_u32 s7, s15, 2
LS1bc_pw38:
  ds_read_b128 v[226:229], v234
  s_waitcnt lgkmcnt(0)
  v_min_u32 v226, v226, v227
  v_min3_u32 v226, v226, v228, v229
  s_nop 0
  v_readfirstlane_b32 s6, v226
  s_cmp_ge_u32 s6, s7
  s_cbranch_scc1 LS1bc_pw38_ok
  s_sub_u32 s0, s0, 1
  s_cbranch_scc0 LS1bc_pw38
  s_mov_b32 s0, 0
LS1bc_pw38_ok:
  ds_write_b128 v4, v[120:123] offset:24576
  ds_write_b128 v4, v[124:127] offset:25600
  ds_write_b128 v4, v[128:131] offset:26624
  ds_write_b128 v4, v[132:135] offset:27648
  s_mov_b32 exec_lo, 0x00010001
  s_mov_b32 exec_hi, 0x00010001
  ds_write_b128 v5, v[136:139] offset:40960
  ds_write_b128 v5, v[140:143] offset:41024
  ds_write_b128 v5, v[144:147] offset:41088
  ds_write_b128 v5, v[148:151] offset:41152
  s_mov_b64 exec, 1
  ds_add_u32 v6, v7 offset:4
  s_mov_b64 exec, -1
LS1bc_rs:
  ds_read_b32 v7, v6 offset:4
  s_waitcnt lgkmcnt(0)
  v_readfirstlane_b32 s6, v7
  s_cmp_lt_u32 s6, 8
  s_cbranch_scc1 LS1bc_rs
  ds_read_b128 v[120:123], v12 offset:24576
  ds_read_b128 v[124:127], v12 offset:28672
  ds_read_b128 v[128:131], v12 offset:32768
  ds_read_b128 v[132:135], v12 offset:36864
  s_cmp_lg_u32 s5, 0
  s_cbranch_scc1 LS1bc_noz
  ds_read_b128 v[136:139], v12 offset:40960
  ds_read_b128 v[140:143], v12 offset:41216
  ds_read_b128 v[144:147], v12 offset:41472
  ds_read_b128 v[148:151], v12 offset:41728
  s_waitcnt lgkmcnt(0)
  v_pk_add_f32 v[136:137], v[136:137], v[144:145]
  v_pk_add_f32 v[138:139], v[138:139], v[146:147]
  v_pk_add_f32 v[140:141], v[140:141], v[148:149]
  v_pk_add_f32 v[142:143], v[142:143], v[150:151]
  v_pk_add_f32 v[136:137], v[136:137], v[140:141]
  v_pk_add_f32 v[138:139], v[138:139], v[142:143]
  s_mov_b64 exec, 0xffff
  buffer_store_dwordx4 v[136:139], v12, s[56:59], s13 offen offset:2048 sc1
  s_mov_b64 exec, -1
LS1bc_noz:
  s_waitcnt lgkmcnt(0)
  s_lshl_b32 s7, s5, 2
  s_add_u32 s6, s15, 3
  s_add_u32 s7, s7, 161808
  v_mov_b32 v232, s6
  v_mov_b32 v233, s7
  s_mov_b64 exec, 1
  ds_write_b32 v233, v232
  s_mov_b64 exec, -1
  v_pk_add_f32 v[120:121], v[120:121], v[128:129]
  v_pk_add_f32 v[122:123], v[122:123], v[130:131]
  v_pk_add_f32 v[124:125], v[124:125], v[132:133]
  v_pk_add_f32 v[126:127], v[126:127], v[134:135]
  v_pk_add_f32 v[120:121], v[120:121], v[124:125]
  v_pk_add_f32 v[122:123], v[122:123], v[126:127]
  v_cvt_pk_bf16_f32 v120, v120, v121
  v_cvt_pk_bf16_f32 v121, v122, v123
  buffer_store_dwordx2 v[120:121], v21, s[56:59], s13 offen sc1
  v_pk_fma_f32 v[32:33], v[184:185], v[16:17], v[32:33] op_sel_hi:[1,0,1]
  v_pk_fma_f32 v[56:57], v[184:185], v[18:19], v[56:57] op_sel_hi:[1,0,1]
  v_pk_fma_f32 v[34:35], v[186:187], v[16:17], v[34:35] op_sel_hi:[1,0,1]
  v_pk_fma_f32 v[58:59], v[186:187], v[18:19], v[58:59] op_sel_hi:[1,0,1]
  v_pk_mul_f32 v[32:33], v[32:33], v[16:17] op_sel:[0,1] op_sel_hi:[1,1]
  v_pk_mul_f32 v[56:57], v[56:57], v[18:19] op_sel:[0,1] op_sel_hi:[1,1]
  v_pk_mul_f32 v[34:35], v[34:35], v[16:17] op_sel:[0,1] op_sel_hi:[1,1]
  v_pk_mul_f32 v[58:59], v[58:59], v[18:19] op_sel:[0,1] op_sel_hi:[1,1]
  v_pk_fma_f32 v[36:37], v[188:189], v[16:17], v[36:37] op_sel_hi:[1,0,1]
  v_pk_fma_f32 v[60:61], v[188:189], v[18:19], v[60:61] op_sel_hi:[1,0,1]
  v_pk_fma_f32 v[38:39], v[190:191], v[16:17], v[38:39] op_sel_hi:[1,0,1]
  v_pk_fma_f32 v[62:63], v[190:191], v[18:19], v[62:63] op_sel_hi:[1,0,1]
  v_pk_mul_f32 v[36:37], v[36:37], v[16:17] op_sel:[0,1] op_sel_hi:[1,1]
  v_pk_mul_f32 v[60:61], v[60:61], v[18:19] op_sel:[0,1] op_sel_hi:[1,1]
  v_pk_mul_f32 v[38:39], v[38:39], v[16:17] op_sel:[0,1] op_sel_hi:[1,1]
  v_pk_mul_f32 v[62:63], v[62:63], v[18:19] op_sel:[0,1] op_sel_hi:[1,1]
  v_cvt_pk_bf16_f32 v212, v32, v33
  v_cvt_pk_bf16_f32 v152, v56, v57
  v_cvt_pk_bf16_f32 v213, v34, v35
  v_cvt_pk_bf16_f32 v153, v58, v59
  v_cvt_pk_bf16_f32 v214, v36, v37
  v_cvt_pk_bf16_f32 v154, v60, v61
  v_cvt_pk_bf16_f32 v215, v38, v39
  v_cvt_pk_bf16_f32 v155, v62, v63
  v_mfma_f32_16x16x16_bf16 v[216:219], v[28:29], v[212:213], 0
  v_mfma_f32_16x16x16_bf16 v[156:159], v[28:29], v[152:153], 0
  v_mfma_f32_16x16x16_bf16 v[220:223], v[30:31], v[214:215], 0
  v_mfma_f32_16x16x16_bf16 v[160:163], v[30:31], v[154:155], 0
  s_nop 4
  v_cvt_pk_bf16_f32 v212, v216, v217
  v_cvt_pk_bf16_f32 v152, v156, v157
  v_cvt_pk_bf16_f32 v213, v218, v219
  v_cvt_pk_bf16_f32 v153, v158, v159
  v_lshlrev_b32 v216, 16, v212
  v_lshlrev_b32 v156, 16, v152
  v_and_b32 v217, 0xffff0000, v212
  v_and_b32 v157, 0xffff0000, v152
  v_lshlrev_b32 v218, 16, v213
  v_lshlrev_b32 v158, 16, v153
  v_and_b32 v219, 0xffff0000, v213
  v_and_b32 v159, 0xffff0000, v153
  v_cvt_pk_bf16_f32 v214, v220, v221
  v_cvt_pk_bf16_f32 v154, v160, v161
  v_cvt_pk_bf16_f32 v215, v222, v223
  v_cvt_pk_bf16_f32 v155, v162, v163
  v_lshlrev_b32 v220, 16, v214
  v_lshlrev_b32 v160, 16, v154
  v_and_b32 v221, 0xffff0000, v214
  v_and_b32 v161, 0xffff0000, v154
  v_lshlrev_b32 v222, 16, v215
  v_lshlrev_b32 v162, 16, v155
  v_and_b32 v223, 0xffff0000, v215
  v_and_b32 v163, 0xffff0000, v155
  v_max3_f32 v232, v216, v217, v218
  v_max3_f32 v172, v156, v157, v158
  v_max3_f32 v234, -v216, -v217, -v218
  v_max3_f32 v174, -v156, -v157, -v158
  v_max_f32 v232, v232, v219
  v_max_f32 v172, v172, v159
  v_max_f32_e64 v234, v234, -v219
  v_max_f32_e64 v174, v174, -v159
  v_max3_f32 v236, v220, v221, v222
  v_max3_f32 v176, v160, v161, v162
  v_max3_f32 v238, -v220, -v221, -v222
  v_max3_f32 v178, -v160, -v161, -v162
  v_max_f32 v236, v236, v223
  v_max_f32 v176, v176, v163
  v_max_f32_e64 v238, v238, -v223
  v_max_f32_e64 v178, v178, -v163
  v_permlane16_swap_b32 v232, v234
  v_permlane16_swap_b32 v172, v174
  v_permlane16_swap_b32 v236, v238
  v_permlane16_swap_b32 v176, v178
  v_max_f32 v232, v232, v234
  v_max_f32 v172, v172, v174
  v_max_f32 v236, v236, v238
  v_max_f32 v176, v176, v178
  s_nop 0
  v_permlane32_swap_b32 v232, v236
  v_permlane32_swap_b32 v172, v176
  v_max_f32 v232, v232, v236
  v_max_f32 v172, v172, v176
  v_mul_f32 v232, 0xbfb8aa3b, v232
  v_mul_f32 v172, 0xbfb8aa3b, v172
  v_mov_b32 v236, v232
  v_mov_b32 v176, v172
  s_nop 0
  v_permlane32_swap_b32 v232, v236
  v_permlane32_swap_b32 v172, v176
  v_mov_b32 v234, v232
  v_mov_b32 v174, v172
  v_mov_b32 v238, v236
  v_mov_b32 v178, v176
  v_permlane16_swap_b32 v232, v234
  v_permlane16_swap_b32 v172, v174
  v_permlane16_swap_b32 v236, v238
  v_permlane16_swap_b32 v176, v178
  v_pk_fma_f32 v[224:225], v[216:217], v[202:203], v[234:235] op_sel_hi:[1,1,0] neg_lo:[0,1,0] neg_hi:[0,1,0]
  v_pk_fma_f32 v[164:165], v[156:157], v[202:203], v[174:175] op_sel_hi:[1,1,0] neg_lo:[0,1,0] neg_hi:[0,1,0]
  v_pk_fma_f32 v[226:227], v[218:219], v[202:203], v[234:235] op_sel_hi:[1,1,0] neg_lo:[0,1,0] neg_hi:[0,1,0]
  v_pk_fma_f32 v[166:167], v[158:159], v[202:203], v[174:175] op_sel_hi:[1,1,0] neg_lo:[0,1,0] neg_hi:[0,1,0]
  v_pk_fma_f32 v[216:217], v[216:217], v[202:203], v[232:233] op_sel_hi:[1,1,0]
  v_pk_fma_f32 v[156:157], v[156:157], v[202:203], v[172:173] op_sel_hi:[1,1,0]
  v_pk_fma_f32 v[218:219], v[218:219], v[202:203], v[232:233] op_sel_hi:[1,1,0]
  v_pk_fma_f32 v[158:159], v[158:159], v[202:203], v[172:173] op_sel_hi:[1,1,0]
  v_pk_fma_f32 v[228:229], v[220:221], v[202:203], v[238:239] op_sel_hi:[1,1,0] neg_lo:[0,1,0] neg_hi:[0,1,0]
  v_pk_fma_f32 v[168:169], v[160:161], v[202:203], v[178:179] op_sel_hi:[1,1,0] neg_lo:[0,1,0] neg_hi:[0,1,0]
  v_pk_fma_f32 v[230:231], v[222:223], v[202:203], v[238:239] op_sel_hi:[1,1,0] neg_lo:[0,1,0] neg_hi:[0,1,0]
  v_pk_fma_f32 v[170:171], v[162:163], v[202:203], v[178:179] op_sel_hi:[1,1,0] neg_lo:[0,1,0] neg_hi:[0,1,0]
  v_pk_fma_f32 v[220:221], v[220:221], v[202:203], v[236:237] op_sel_hi:[1,1,0]
  v_pk_fma_f32 v[160:161], v[160:161], v[202:203], v[176:177] op_sel_hi:[1,1,0]
  v_pk_fma_f32 v[222:223], v[222:223], v[202:203], v[236:237] op_sel_hi:[1,1,0]
  v_pk_fma_f32 v[162:163], v[162:163], v[202:203], v[176:177] op_sel_hi:[1,1,0]
  v_exp_f32 v216, v216
  v_exp_f32 v156, v156
  v_exp_f32 v217, v217
  v_exp_f32 v157, v157
  v_exp_f32 v218, v218
  v_exp_f32 v158, v158
  v_exp_f32 v219, v219
  v_exp_f32 v159, v159
  v_exp_f32 v224, v224
  v_exp_f32 v164, v164
  v_exp_f32 v225, v225
  v_exp_f32 v165, v165
  v_exp_f32 v226, v226
  v_exp_f32 v166, v166
  v_exp_f32 v227, v227
  v_exp_f32 v167, v167
  v_exp_f32 v220, v220
  v_exp_f32 v160, v160
  v_exp_f32 v221, v221
  v_exp_f32 v161, v161
  v_exp_f32 v222, v222
  v_exp_f32 v162, v162
  v_exp_f32 v223, v223
  v_exp_f32 v163, v163
  v_exp_f32 v228, v228
  v_exp_f32 v168, v168
  v_exp_f32 v229, v229
  v_exp_f32 v169, v169
  v_exp_f32 v230, v230
  v_exp_f32 v170, v170
  v_exp_f32 v231, v231
  v_exp_f32 v171, v171
  v_pk_add_f32 v[232:233], v[216:217], v[218:219]
  v_pk_add_f32 v[172:173], v[156:157], v[158:159]
  v_pk_add_f32 v[234:235], v[224:225], v[226:227]
  v_pk_add_f32 v[174:175], v[164:165], v[166:167]
  v_pk_add_f32 v[236:237], v[220:221], v[222:223]
  v_pk_add_f32 v[176:177], v[160:161], v[162:163]
  v_pk_add_f32 v[238:239], v[228:229], v[230:231]
  v_pk_add_f32 v[178:179], v[168:169], v[170:171]
  v_add_f32 v232, v232, v233
  v_add_f32 v172, v172, v173
  v_add_f32 v234, v234, v235
  v_add_f32 v174, v174, v175
  v_add_f32 v236, v236, v237
  v_add_f32 v176, v176, v177
  v_add_f32 v238, v238, v239
  v_add_f32 v178, v178, v179
  v_permlane16_swap_b32 v232, v234
  v_permlane16_swap_b32 v172, v174
  v_permlane16_swap_b32 v236, v238
  v_permlane16_swap_b32 v176, v178
  v_add_f32 v232, v232, v234
  v_add_f32 v172, v172, v174
  v_add_f32 v236, v236, v238
  v_add_f32 v176, v176, v178
  s_nop 0
  v_permlane32_swap_b32 v232, v236
  v_permlane32_swap_b32 v172, v176
  v_add_f32 v232, v232, v236
  v_add_f32 v172, v172, v176
  v_rcp_f32 v232, v232
  v_rcp_f32 v172, v172
  v_mov_b32 v236, v232
  v_mov_b32 v176, v172
  s_nop 0
  v_permlane32_swap_b32 v232, v236
  v_permlane32_swap_b32 v172, v176
  v_mov_b32 v234, v232
  v_mov_b32 v174, v172
  v_mov_b32 v238, v236
  v_mov_b32 v178, v176
  v_permlane16_swap_b32 v232, v234
  v_permlane16_swap_b32 v172, v174
  v_permlane16_swap_b32 v236, v238
  v_permlane16_swap_b32 v176, v178
  v_pk_mul_f32 v[216:217], v[216:217], v[232:233] op_sel_hi:[1,0]
  v_pk_mul_f32 v[156:157], v[156:157], v[172:173] op_sel_hi:[1,0]
  v_pk_mul_f32 v[218:219], v[218:219], v[232:233] op_sel_hi:[1,0]
  v_pk_mul_f32 v[158:159], v[158:159], v[172:173] op_sel_hi:[1,0]
  v_pk_mul_f32 v[224:225], v[224:225], v[234:235] op_sel_hi:[1,0]
  v_pk_mul_f32 v[164:165], v[164:165], v[174:175] op_sel_hi:[1,0]
  v_pk_mul_f32 v[226:227], v[226:227], v[234:235] op_sel_hi:[1,0]
  v_pk_mul_f32 v[166:167], v[166:167], v[174:175] op_sel_hi:[1,0]
  v_pk_mul_f32 v[220:221], v[220:221], v[236:237] op_sel_hi:[1,0]
  v_pk_mul_f32 v[160:161], v[160:161], v[176:177] op_sel_hi:[1,0]
  v_pk_mul_f32 v[222:223], v[222:223], v[236:237] op_sel_hi:[1,0]
  v_pk_mul_f32 v[162:163], v[162:163], v[176:177] op_sel_hi:[1,0]
  v_pk_mul_f32 v[228:229], v[228:229], v[238:239] op_sel_hi:[1,0]
  v_pk_mul_f32 v[168:169], v[168:169], v[178:179] op_sel_hi:[1,0]
  v_pk_mul_f32 v[230:231], v[230:231], v[238:239] op_sel_hi:[1,0]
  v_pk_mul_f32 v[170:171], v[170:171], v[178:179] op_sel_hi:[1,0]
  v_cvt_pk_bf16_f32 v32, v216, v217
  v_cvt_pk_bf16_f32 v56, v156, v157
  v_cvt_pk_bf16_f32 v33, v218, v219
  v_cvt_pk_bf16_f32 v57, v158, v159
  v_cvt_pk_bf16_f32 v34, v224, v225
  v_cvt_pk_bf16_f32 v58, v164, v165
  v_cvt_pk_bf16_f32 v35, v226, v227
  v_cvt_pk_bf16_f32 v59, v166, v167
  v_cvt_pk_bf16_f32 v36, v220, v221
  v_cvt_pk_bf16_f32 v60, v160, v161
  v_cvt_pk_bf16_f32 v37, v222, v223
  v_cvt_pk_bf16_f32 v61, v162, v163
  v_cvt_pk_bf16_f32 v38, v228, v229
  v_cvt_pk_bf16_f32 v62, v168, v169
  v_cvt_pk_bf16_f32 v39, v230, v231
  v_cvt_pk_bf16_f32 v63, v170, v171
  s_and_b32 s1, s2, 7
  s_lshl_b32 s1, s1, 5
  s_and_b32 s6, s3, 1
  s_lshl_b32 s6, s6, 3
  s_add_u32 s1, s1, s6
  s_lshl_b32 s6, s5, 1
  s_add_u32 s1, s1, s6
  s_lshl_b32 s1, s1, 7
  s_lshl_b32 s6, s4, 2
  s_add_u32 s1, s1, s6
  s_add_u32 s1, s1, 21626880
  s_add_u32 s6, s25, 1
  v_mov_b32 v236, s6
  v_lshlrev_b32 v237, 7, v1
  s_barrier
  ds_read_b128 v[152:155], v13 offset:41984
  ds_read_b128 v[156:159], v14 offset:44032
  ds_read_b128 v[160:163], v13 offset:43008
  ds_read_b128 v[164:167], v14 offset:44096
  s_waitcnt lgkmcnt(2)
  v_mfma_f32_16x16x32_bf16 v[172:175], v[156:159], v[32:35], 0
  v_mfma_f32_16x16x32_bf16 v[168:171], v[152:155], v[32:35], 0
  v_mfma_f32_16x16x32_bf16 v[188:191], v[156:159], v[56:59], 0
  v_mfma_f32_16x16x32_bf16 v[184:187], v[152:155], v[56:59], 0
  s_waitcnt lgkmcnt(0)
  v_mfma_f32_16x16x32_bf16 v[180:183], v[164:167], v[36:39], 0
  v_mfma_f32_16x16x32_bf16 v[176:179], v[160:163], v[36:39], 0
  v_mfma_f32_16x16x32_bf16 v[196:199], v[164:167], v[60:63], 0
  v_mfma_f32_16x16x32_bf16 v[192:195], v[160:163], v[60:63], 0
  v_cvt_pk_bf16_f32 v96, v172, v172
  s_nop 0
  v_cvt_pk_bf16_f32 v100, v188, v188
  s_nop 1
  v_cvt_pk_bf16_f32 v98, v180, v180
  s_nop 0
  v_cvt_pk_bf16_f32 v102, v196, v196
  v_lshlrev_b32 v172, 16, v96
  v_lshlrev_b32 v188, 16, v100
  v_lshlrev_b32 v180, 16, v98
  v_lshlrev_b32 v196, 16, v102
  v_add_f32 v172, 0x358637bd, v172
  v_add_f32 v188, 0x358637bd, v188
  v_add_f32 v180, 0x358637bd, v180
  v_add_f32 v196, 0x358637bd, v196
  v_cvt_pk_bf16_f32 v96, v172, v172
  v_cvt_pk_bf16_f32 v100, v188, v188
  v_cvt_pk_bf16_f32 v98, v180, v180
  v_cvt_pk_bf16_f32 v102, v196, v196
  v_lshlrev_b32 v172, 16, v96
  v_lshlrev_b32 v188, 16, v100
  v_lshlrev_b32 v180, 16, v98
  v_lshlrev_b32 v196, 16, v102
  v_rcp_f32 v172, v172
  v_rcp_f32 v188, v188
  v_rcp_f32 v180, v180
  v_rcp_f32 v196, v196
  v_cvt_pk_bf16_f32 v96, v168, v169
  v_cvt_pk_bf16_f32 v100, v184, v185
  v_cvt_pk_bf16_f32 v98, v176, v177
  v_cvt_pk_bf16_f32 v102, v192, v193
  v_cvt_pk_bf16_f32 v97, v170, v171
  v_cvt_pk_bf16_f32 v101, v186, v187
  v_cvt_pk_bf16_f32 v99, v178, v179
  v_cvt_pk_bf16_f32 v103, v194, v195
  v_lshlrev_b32 v168, 16, v96
  v_lshlrev_b32 v184, 16, v100
  v_lshlrev_b32 v176, 16, v98
  v_lshlrev_b32 v192, 16, v102
  v_and_b32 v169, 0xffff0000, v96
  v_and_b32 v185, 0xffff0000, v100
  v_and_b32 v177, 0xffff0000, v98
  v_and_b32 v193, 0xffff0000, v102
  v_lshlrev_b32 v170, 16, v97
  v_lshlrev_b32 v186, 16, v101
  v_lshlrev_b32 v178, 16, v99
  v_lshlrev_b32 v194, 16, v103
  v_and_b32 v171, 0xffff0000, v97
  v_and_b32 v187, 0xffff0000, v101
  v_and_b32 v179, 0xffff0000, v99
  v_and_b32 v195, 0xffff0000, v103
  v_pk_mul_f32 v[168:169], v[168:169], v[172:173] op_sel_hi:[1,0]
  v_pk_mul_f32 v[184:185], v[184:185], v[188:189] op_sel_hi:[1,0]
  v_pk_mul_f32 v[176:177], v[176:177], v[180:181] op_sel_hi:[1,0]
  v_pk_mul_f32 v[192:193], v[192:193], v[196:197] op_sel_hi:[1,0]
  v_pk_mul_f32 v[170:171], v[170:171], v[172:173] op_sel_hi:[1,0]
  v_pk_mul_f32 v[186:187], v[186:187], v[188:189] op_sel_hi:[1,0]
  v_pk_mul_f32 v[178:179], v[178:179], v[180:181] op_sel_hi:[1,0]
  v_pk_mul_f32 v[194:195], v[194:195], v[196:197] op_sel_hi:[1,0]
  v_cvt_pk_bf16_f32 v104, v168, v169
  v_cvt_pk_bf16_f32 v108, v184, v185
  v_cvt_pk_bf16_f32 v106, v176, v177
  v_cvt_pk_bf16_f32 v110, v192, v193
  v_cvt_pk_bf16_f32 v105, v170, v171
  v_cvt_pk_bf16_f32 v109, v186, v187
  v_cvt_pk_bf16_f32 v107, v178, v179
  v_cvt_pk_bf16_f32 v111, v194, v195
  v_permlane16_swap_b32 v104, v106
  v_permlane16_swap_b32 v105, v107
  v_permlane16_swap_b32 v108, v110
  v_permlane16_swap_b32 v109, v111
  buffer_store_dwordx4 v[104:107], v20, s[56:59], s9 offen
  buffer_store_dwordx4 v[108:111], v20, s[56:59], s12 offen
LS1bc_fin:
LS1bc_skip:
  s_branch LXc_loop
LX_end:
  s_endpgm
.p2align 8
LX_loader:
  s_and_b32 s6, s2, 7
  s_lshr_b32 s7, s2, 3
  s_lshl_b32 s6, s6, 1
  s_and_b32 s8, s7, 1
  s_add_u32 s3, s6, s8
  s_lshr_b32 s4, s7, 1
  v_mov_b32 v250, 1
  v_mov_b32 v251, 0
  v_mov_b32 v249, 161792
  s_lshl_b32 s49, s100, 5
  s_waitcnt lgkmcnt(0)
  s_mov_b32 s96, s36
  s_mov_b32 s97, s37
  s_mov_b32 s98, 256
  s_mov_b32 s99, 0x00020000
  s_cmp_lg_u32 s5, 0
  s_cbranch_scc1 LS1al_tk1
  s_mov_b64 exec, 1
  buffer_atomic_add v250, v251, s[96:99], s49 offen sc0
LS1al_tk1:
  s_cmp_lg_u32 s5, 0
  s_cbranch_scc1 LS1al_tk0
  s_waitcnt vmcnt(0)
  ds_write_b32 v249, v250
  s_mov_b64 exec, -1
LS1al_tk0:
  s_waitcnt lgkmcnt(0)
  s_mov_b32 s24, 0
  s_mov_b32 s25, 0
  s_mov_b32 s0, 60000
  s_mov_b32 s56, s38
  s_mov_b32 s57, s39
  s_mov_b32 s58, 67108864
  s_mov_b32 s59, 0x00020000
  s_mov_b32 s15, 0
  s_mov_b32 s40, s16
  s_mov_b32 s41, s17
  s_mov_b32 s42, 2097152
  s_mov_b32 s43, 0x00020000
  s_mov_b32 s44, s18
  s_mov_b32 s45, s19
  s_mov_b32 s46, 1572864
  s_mov_b32 s47, 0x00020000
  s_cmp_eq_u32 s5, 0
  s_cbranch_scc1 LS1al_nopfx
  s_bfe_u32 s6, s2, 0x50003
  s_mul_i32 s7, s6, 3
  s_add_u32 s7, s7, s5
  s_lshl_b32 s7, s7, 12
  s_sub_u32 s7, s7, 4096
  v_lshlrev_b32 v40, 6, v1
  buffer_load_dword v41, v40, s[44:47], s7 offen
  s_cmp_lg_u32 s5, 1
  s_cbranch_scc1 LS1al_nopfx
  s_and_b32 s7, s6, 15
  s_lshl_b32 s7, s7, 14
  s_lshr_b32 s6, s6, 4
  s_lshl_b32 s6, s6, 8
  s_add_u32 s7, s7, s6
  s_lshl_b32 s6, s100, 18
  s_add_u32 s7, s7, s6
  v_lshrrev_b32 v46, 2, v1
  v_and_b32 v47, 3, v1
  v_lshlrev_b32 v46, 10, v46
  v_lshl_add_u32 v46, v47, 6, v46
  buffer_load_dword v47, v46, s[40:43], s7 offen
LS1al_nopfx:
  s_barrier
  v_mov_b32 v24, 161792
  ds_read_b32 v24, v24
  s_waitcnt lgkmcnt(0)
  v_readfirstlane_b32 s6, v24
  s_lshl_b32 s6, s6, 3
  s_add_u32 s100, s100, s6
  s_mov_b32 s2, s100
  s_cmp_ge_u32 s2, 256
  s_cbranch_scc1 LX_end
  s_and_b32 s6, s2, 7
  s_lshr_b32 s7, s2, 3
  s_lshl_b32 s6, s6, 1
  s_and_b32 s8, s7, 1
  s_add_u32 s3, s6, s8
  s_lshr_b32 s4, s7, 1
  s_lshl_b32 s12, s4, 6
  s_add_u32 s8, s12, 1024
  s_add_u32 s9, s12, 2048
  v_lshrrev_b32 v24, 2, v1
  v_and_b32 v18, 3, v1
  v_lshrrev_b32 v25, 5, v1
  v_lshlrev_b32 v25, 1, v25
  v_xor_b32 v18, v18, v25
  v_lshlrev_b32 v18, 4, v18
  s_mov_b32 s6, 3072
  v_mul_lo_u32 v24, v24, s6
  v_add_u32 v18, v18, v24
  s_lshl_b32 s13, s5, 12
  s_lshl_b32 s14, s5, 10
  s_mul_i32 s10, s5, 49152
  s_add_u32 s12, s12, s10
  s_add_u32 s8, s8, s10
  s_add_u32 s9, s9, s10
  s_mul_i32 s6, s3, 128
  s_mul_i32 s7, s5, 32
  s_add_u32 s6, s6, s7
  s_mov_b32 s7, 1024
  v_lshrrev_b32 v26, 3, v1
  v_and_b32 v27, 7, v1
  v_add_u32 v24, 0, v3
  v_xor_b32 v25, v24, v27
  v_add_u32 v24, 0, v26
  v_add_u32 v24, s6, v24
  v_mul_lo_u32 v24, v24, s7
  v_lshl_add_u32 v16, v25, 4, v24
  v_add_u32 v24, 4, v3
  v_xor_b32 v25, v24, v27
  v_add_u32 v24, 8, v26
  v_add_u32 v24, s6, v24
  v_mul_lo_u32 v24, v24, s7
  v_lshl_add_u32 v17, v25, 4, v24
  s_add_u32 m0, s13, 0
  s_nop 0
  buffer_load_dwordx4 v16, s[40:43], 0 offen lds
  s_add_u32 m0, s13, 1024
  s_nop 0
  buffer_load_dwordx4 v17, s[40:43], 0 offen lds
  s_add_u32 m0, s13, 2048
  s_mov_b32 s7, 16384
  buffer_load_dwordx4 v16, s[40:43], s7 offen lds
  s_add_u32 m0, s13, 3072
  s_mov_b32 s7, 16384
  buffer_load_dwordx4 v17, s[40:43], s7 offen lds
  s_add_u32 m0, s14, 16384
  s_nop 0
  buffer_load_dwordx4 v18, s[44:47], s12 offen lds
  s_add_u32 m0, s14, 20480
  s_nop 0
  buffer_load_dwordx4 v18, s[44:47], s8 offen lds
  s_add_u32 m0, s14, 24576
  s_nop 0
  buffer_load_dwordx4 v18, s[44:47], s9 offen lds
  s_add_u32 m0, s13, 28672
  s_mov_b32 s7, 128
  buffer_load_dwordx4 v16, s[40:43], s7 offen lds
  s_add_u32 m0, s13, 29696
  s_mov_b32 s7, 128
  buffer_load_dwordx4 v17, s[40:43], s7 offen lds
  s_add_u32 m0, s13, 30720
  s_mov_b32 s7, 16512
  buffer_load_dwordx4 v16, s[40:43], s7 offen lds
  s_add_u32 m0, s13, 31744
  s_mov_b32 s7, 16512
  buffer_load_dwordx4 v17, s[40:43], s7 offen lds
  s_add_u32 m0, s14, 45056
  s_add_u32 s7, s12, 196608
  buffer_load_dwordx4 v18, s[44:47], s7 offen lds
  s_add_u32 m0, s14, 49152
  s_add_u32 s7, s8, 196608
  buffer_load_dwordx4 v18, s[44:47], s7 offen lds
  s_add_u32 m0, s14, 53248
  s_add_u32 s7, s9, 196608
  buffer_load_dwordx4 v18, s[44:47], s7 offen lds
  s_waitcnt vmcnt(7)
  s_barrier
  s_add_u32 m0, s13, 57344
  s_mov_b32 s7, 256
  buffer_load_dwordx4 v16, s[40:43], s7 offen lds
  s_add_u32 m0, s13, 58368
  s_mov_b32 s7, 256
  buffer_load_dwordx4 v17, s[40:43], s7 offen lds
  s_add_u32 m0, s13, 59392
  s_mov_b32 s7, 16640
  buffer_load_dwordx4 v16, s[40:43], s7 offen lds
  s_add_u32 m0, s13, 60416
  s_mov_b32 s7, 16640
  buffer_load_dwordx4 v17, s[40:43], s7 offen lds
  s_add_u32 m0, s14, 73728
  s_add_u32 s7, s12, 393216
  buffer_load_dwordx4 v18, s[44:47], s7 offen lds
  s_add_u32 m0, s14, 77824
  s_add_u32 s7, s8, 393216
  buffer_load_dwordx4 v18, s[44:47], s7 offen lds
  s_add_u32 m0, s14, 81920
  s_add_u32 s7, s9, 393216
  buffer_load_dwordx4 v18, s[44:47], s7 offen lds
  v_lshlrev_b32 v24, 2, v1
  v_add_u32 v24, 161796, v24
  v_mov_b32 v25, 0
  s_mov_b64 exec, 0x7ff
  ds_write_b32 v24, v25
  s_mov_b64 exec, -1
  v_mov_b32 v8, 0x3f803f80
  v_mov_b32 v9, 0x3f803f80
  v_mov_b32 v10, 0x3f803f80
  v_mov_b32 v11, 0x3f803f80
  v_lshrrev_b32 v24, 2, v2
  v_and_b32 v25, 3, v2
  v_lshl_add_u32 v26, v3, 3, v24
  v_and_b32 v27, 1, v3
  v_lshlrev_b32 v27, 1, v27
  v_lshlrev_b32 v26, 6, v26
  v_and_b32 v28, 1, v25
  v_lshl_add_u32 v26, v28, 3, v26
  v_lshrrev_b32 v25, 1, v25
  v_or_b32 v28, 0, v25
  v_xor_b32 v28, v28, v27
  v_lshl_add_u32 v160, v28, 4, v26
  v_or_b32 v28, 2, v25
  v_xor_b32 v28, v28, v27
  v_lshl_add_u32 v161, v28, 4, v26
  v_add_u32 v162, 4096, v160
  v_add_u32 v163, 4096, v161
  v_add_u32 v164, 8192, v160
  v_add_u32 v165, 8192, v161
  s_cmp_lt_u32 s5, 2
  s_cbranch_scc1 LS1al_lo3
  v_mov_b32 v160, v163
  v_mov_b32 v161, v164
  v_mov_b32 v162, v165
LS1al_lo3:
  s_and_b32 s6, s5, 1
  s_lshl_b32 s6, s6, 11
  v_add_u32 v160, s6, v160
  v_add_u32 v161, s6, v161
  v_add_u32 v162, s6, v162
  v_add_u32 v164, 65536, v160
  v_add_u32 v165, 65536, v161
  v_add_u32 v166, 65536, v162
  v_add_u32 v168, 131072, v160
  v_add_u32 v169, 131072, v161
  v_add_u32 v170, 131072, v162
  ds_read_b64_tr_b16 v[112:113], v160 offset:16384
  ds_read_b64_tr_b16 v[114:115], v160 offset:16640
  ds_read_b64_tr_b16 v[116:117], v161 offset:16384
  ds_read_b64_tr_b16 v[118:119], v161 offset:16640
  ds_read_b64_tr_b16 v[120:121], v162 offset:16384
  ds_read_b64_tr_b16 v[122:123], v162 offset:16640
  s_waitcnt lgkmcnt(4)
  v_mfma_f32_16x16x32_bf16 v[128:131], v[112:115], v[8:11], 0
  s_waitcnt lgkmcnt(2)
  v_mfma_f32_16x16x32_bf16 v[132:135], v[116:119], v[8:11], 0
  s_waitcnt lgkmcnt(0)
  v_mfma_f32_16x16x32_bf16 v[136:139], v[120:123], v[8:11], 0
  s_waitcnt vmcnt(7)
  s_barrier
  s_add_u32 m0, s13, 86016
  s_mov_b32 s7, 384
  buffer_load_dwordx4 v16, s[40:43], s7 offen lds
  s_add_u32 m0, s13, 87040
  s_mov_b32 s7, 384
  buffer_load_dwordx4 v17, s[40:43], s7 offen lds
  s_add_u32 m0, s13, 88064
  s_mov_b32 s7, 16768
  buffer_load_dwordx4 v16, s[40:43], s7 offen lds
  s_add_u32 m0, s13, 89088
  s_mov_b32 s7, 16768
  buffer_load_dwordx4 v17, s[40:43], s7 offen lds
  s_add_u32 m0, s14, 102400
  s_add_u32 s7, s12, 589824
  buffer_load_dwordx4 v18, s[44:47], s7 offen lds
  s_add_u32 m0, s14, 106496
  s_add_u32 s7, s8, 589824
  buffer_load_dwordx4 v18, s[44:47], s7 offen lds
  s_add_u32 m0, s14, 110592
  s_add_u32 s7, s9, 589824
  buffer_load_dwordx4 v18, s[44:47], s7 offen lds
  ds_read_b64_tr_b16 v[112:113], v160 offset:45056
  ds_read_b64_tr_b16 v[114:115], v160 offset:45312
  ds_read_b64_tr_b16 v[116:117], v161 offset:45056
  ds_read_b64_tr_b16 v[118:119], v161 offset:45312
  ds_read_b64_tr_b16 v[120:121], v162 offset:45056
  ds_read_b64_tr_b16 v[122:123], v162 offset:45312
  s_waitcnt lgkmcnt(4)
  v_mfma_f32_16x16x32_bf16 v[128:131], v[112:115], v[8:11], v[128:131]
  s_waitcnt lgkmcnt(2)
  v_mfma_f32_16x16x32_bf16 v[132:135], v[116:119], v[8:11], v[132:135]
  s_waitcnt lgkmcnt(0)
  v_mfma_f32_16x16x32_bf16 v[136:139], v[120:123], v[8:11], v[136:139]
  s_waitcnt vmcnt(7)
  s_barrier
  s_add_u32 m0, s13, 114688
  s_mov_b32 s7, 512
  buffer_load_dwordx4 v16, s[40:43], s7 offen lds
  s_add_u32 m0, s13, 115712
  s_mov_b32 s7, 512
  buffer_load_dwordx4 v17, s[40:43], s7 offen lds
  s_add_u32 m0, s13, 116736
  s_mov_b32 s7, 16896
  buffer_load_dwordx4 v16, s[40:43], s7 offen lds
  s_add_u32 m0, s13, 117760
  s_mov_b32 s7, 16896
  buffer_load_dwordx4 v17, s[40:43], s7 offen lds
  s_add_u32 m0, s14, 131072
  s_add_u32 s7, s12, 786432
  buffer_load_dwordx4 v18, s[44:47], s7 offen lds
  s_add_u32 m0, s14, 135168
  s_add_u32 s7, s8, 786432
  buffer_load_dwordx4 v18, s[44:47], s7 offen lds
  s_add_u32 m0, s14, 139264
  s_add_u32 s7, s9, 786432
  buffer_load_dwordx4 v18, s[44:47], s7 offen lds
  s_cmp_ge_u32 s5, 1
  s_cbranch_scc1 LS1al_nosm
  s_mov_b32 s52, s20
  s_mov_b32 s53, s21
  s_mov_b32 s54, 16384
  s_mov_b32 s55, 0x00020000
  v_lshlrev_b32 v22, 4, v1
  s_lshl_b32 s6, s4, 10
  s_mov_b32 m0, 144384
  s_nop 0
  buffer_load_dwordx4 v22, s[52:55], s6 offen lds
LS1al_nosm:
  ds_read_b64_tr_b16 v[112:113], v164 offset:8192
  ds_read_b64_tr_b16 v[114:115], v164 offset:8448
  ds_read_b64_tr_b16 v[116:117], v165 offset:8192
  ds_read_b64_tr_b16 v[118:119], v165 offset:8448
  ds_read_b64_tr_b16 v[120:121], v166 offset:8192
  ds_read_b64_tr_b16 v[122:123], v166 offset:8448
  s_waitcnt lgkmcnt(4)
  v_mfma_f32_16x16x32_bf16 v[128:131], v[112:115], v[8:11], v[128:131]
  s_waitcnt lgkmcnt(2)
  v_mfma_f32_16x16x32_bf16 v[132:135], v[116:119], v[8:11], v[132:135]
  s_waitcnt lgkmcnt(0)
  v_mfma_f32_16x16x32_bf16 v[136:139], v[120:123], v[8:11], v[136:139]
  s_waitcnt vmcnt(7)
  s_barrier
  s_add_u32 m0, s13, 0
  s_mov_b32 s7, 640
  buffer_load_dwordx4 v16, s[40:43], s7 offen lds
  s_add_u32 m0, s13, 1024
  s_mov_b32 s7, 640
  buffer_load_dwordx4 v17, s[40:43], s7 offen lds
  s_add_u32 m0, s13, 2048
  s_mov_b32 s7, 17024
  buffer_load_dwordx4 v16, s[40:43], s7 offen lds
  s_add_u32 m0, s13, 3072
  s_mov_b32 s7, 17024
  buffer_load_dwordx4 v17, s[40:43], s7 offen lds
  s_add_u32 m0, s14, 16384
  s_add_u32 s7, s12, 983040
  buffer_load_dwordx4 v18, s[44:47], s7 offen lds
  s_add_u32 m0, s14, 20480
  s_add_u32 s7, s8, 983040
  buffer_load_dwordx4 v18, s[44:47], s7 offen lds
  s_add_u32 m0, s14, 24576
  s_add_u32 s7, s9, 983040
  buffer_load_dwordx4 v18, s[44:47], s7 offen lds
  ds_read_b64_tr_b16 v[112:113], v164 offset:36864
  ds_read_b64_tr_b16 v[114:115], v164 offset:37120
  ds_read_b64_tr_b16 v[116:117], v165 offset:36864
  ds_read_b64_tr_b16 v[118:119], v165 offset:37120
  ds_read_b64_tr_b16 v[120:121], v166 offset:36864
  ds_read_b64_tr_b16 v[122:123], v166 offset:37120
  s_waitcnt lgkmcnt(4)
  v_mfma_f32_16x16x32_bf16 v[128:131], v[112:115], v[8:11], v[128:131]
  s_waitcnt lgkmcnt(2)
  v_mfma_f32_16x16x32_bf16 v[132:135], v[116:119], v[8:11], v[132:135]
  s_waitcnt lgkmcnt(0)
  v_mfma_f32_16x16x32_bf16 v[136:139], v[120:123], v[8:11], v[136:139]
  s_waitcnt vmcnt(7)
  s_barrier
  s_add_u32 m0, s13, 28672
  s_mov_b32 s7, 768
  buffer_load_dwordx4 v16, s[40:43], s7 offen lds
  s_add_u32 m0, s13, 29696
  s_mov_b32 s7, 768
  buffer_load_dwordx4 v17, s[40:43], s7 offen lds
  s_add_u32 m0, s13, 30720
  s_mov_b32 s7, 17152
  buffer_load_dwordx4 v16, s[40:43], s7 offen lds
  s_add_u32 m0, s13, 31744
  s_mov_b32 s7, 17152
  buffer_load_dwordx4 v17, s[40:43], s7 offen lds
  s_add_u32 m0, s14, 45056
  s_add_u32 s7, s12, 1179648
  buffer_load_dwordx4 v18, s[44:47], s7 offen lds
  s_add_u32 m0, s14, 49152
  s_add_u32 s7, s8, 1179648
  buffer_load_dwordx4 v18, s[44:47], s7 offen lds
  s_add_u32 m0, s14, 53248
  s_add_u32 s7, s9, 1179648
  buffer_load_dwordx4 v18, s[44:47], s7 offen lds
  ds_read_b64_tr_b16 v[112:113], v168 offset:0
  ds_read_b64_tr_b16 v[114:115], v168 offset:256
  ds_read_b64_tr_b16 v[116:117], v169 offset:0
  ds_read_b64_tr_b16 v[118:119], v169 offset:256
  ds_read_b64_tr_b16 v[120:121], v170 offset:0
  ds_read_b64_tr_b16 v[122:123], v170 offset:256
  s_waitcnt lgkmcnt(4)
  v_mfma_f32_16x16x32_bf16 v[128:131], v[112:115], v[8:11], v[128:131]
  s_waitcnt lgkmcnt(2)
  v_mfma_f32_16x16x32_bf16 v[132:135], v[116:119], v[8:11], v[132:135]
  s_waitcnt lgkmcnt(0)
  v_mfma_f32_16x16x32_bf16 v[136:139], v[120:123], v[8:11], v[136:139]
  s_waitcnt vmcnt(7)
  s_barrier
  s_add_u32 m0, s13, 57344
  s_mov_b32 s7, 896
  buffer_load_dwordx4 v16, s[40:43], s7 offen lds
  s_add_u32 m0, s13, 58368
  s_mov_b32 s7, 896
  buffer_load_dwordx4 v17, s[40:43], s7 offen lds
  s_add_u32 m0, s13, 59392
  s_mov_b32 s7, 17280
  buffer_load_dwordx4 v16, s[40:43], s7 offen lds
  s_add_u32 m0, s13, 60416
  s_mov_b32 s7, 17280
  buffer_load_dwordx4 v17, s[40:43], s7 offen lds
  s_add_u32 m0, s14, 73728
  s_add_u32 s7, s12, 1376256
  buffer_load_dwordx4 v18, s[44:47], s7 offen lds
  s_add_u32 m0, s14, 77824
  s_add_u32 s7, s8, 1376256
  buffer_load_dwordx4 v18, s[44:47], s7 offen lds
  s_add_u32 m0, s14, 81920
  s_add_u32 s7, s9, 1376256
  buffer_load_dwordx4 v18, s[44:47], s7 offen lds
  s_xor_b32 s48, s2, 128
  s_mov_b32 s44, s22
  s_mov_b32 s45, s23
  s_mov_b32 s46, 524288
  s_mov_b32 s47, 0x00020000
  s_mov_b32 s40, s26
  s_mov_b32 s41, s27
  s_mov_b32 s42, 524288
  s_mov_b32 s43, 0x00020000
  v_lshrrev_b32 v24, 3, v1
  v_and_b32 v20, 7, v1
  v_and_b32 v25, 2, v24
  s_and_b32 s6, s5, 1
  s_lshl_b32 s6, s6, 2
  v_or_b32 v25, s6, v25
  v_xor_b32 v20, v20, v25
  v_lshlrev_b32 v20, 4, v20
  s_mov_b32 s6, 1024
  v_mul_lo_u32 v24, v24, s6
  v_add_u32 v20, v20, v24
  v_lshlrev_b32 v21, 4, v1
  v_lshlrev_b32 v23, 4, v1
  s_lshl_b32 s13, s5, 10
  s_lshr_b32 s7, s2, 5
  s_lshl_b32 s10, s7, 7
  s_lshl_b32 s6, s5, 13
  s_add_u32 s10, s10, s6
  s_mul_i32 s12, s7, 69888
  s_add_u32 s12, s12, s13
  s_add_u32 s12, s12, 24117248
  s_mul_i32 s14, s7, 200960
  s_add_u32 s14, s14, s13
  s_add_u32 s14, s14, 26214400
  s_lshr_b32 s7, s2, 4
  s_mul_i32 s11, s7, 111360
  s_add_u32 s11, s11, s13
  s_add_u32 s11, s11, 28311552
  s_mul_i32 s51, s7, 37120
  s_add_u32 s51, s51, s13
  s_add_u32 s51, s51, 22020096
  s_lshr_b32 s6, s2, 3
  s_lshl_b32 s6, s6, 2
  s_add_u32 s6, s6, s5
  s_lshl_b32 s6, s6, 12
  v_lshlrev_b32 v18, 6, v1
  v_add_u32 v18, s6, v18
  v_and_b32 v17, 0xffff, v18
  v_and_b32 v16, 0x7fff, v18
  s_mul_i32 s6, s7, 37120
  v_add_u32 v16, s6, v16
  v_min_u32 v240, 7, v1
  v_lshlrev_b32 v240, 5, v240
  s_cmp_lg_u32 s5, 1
  s_cbranch_scc1 LS1al_ini0
  buffer_load_dword v241, v240, s[96:99], 0 offen offset:4 sc1
LS1al_ini0:
  ds_read_b64_tr_b16 v[112:113], v160 offset:16384
  ds_read_b64_tr_b16 v[114:115], v160 offset:16640
  ds_read_b64_tr_b16 v[116:117], v161 offset:16384
  ds_read_b64_tr_b16 v[118:119], v161 offset:16640
  ds_read_b64_tr_b16 v[120:121], v162 offset:16384
  ds_read_b64_tr_b16 v[122:123], v162 offset:16640
  s_waitcnt lgkmcnt(4)
  v_mfma_f32_16x16x32_bf16 v[128:131], v[112:115], v[8:11], v[128:131]
  s_waitcnt lgkmcnt(2)
  v_mfma_f32_16x16x32_bf16 v[132:135], v[116:119], v[8:11], v[132:135]
  s_waitcnt lgkmcnt(0)
  v_mfma_f32_16x16x32_bf16 v[136:139], v[120:123], v[8:11], v[136:139]
  s_waitcnt vmcnt(7)
  s_barrier
  s_add_u32 m0, s13, 114688
  s_add_u32 s7, s10, 131072
  buffer_load_dwordx4 v20, s[44:47], s7 offen lds
  s_add_u32 m0, s13, 118784
  s_add_u32 s7, s10, 163840
  buffer_load_dwordx4 v20, s[44:47], s7 offen lds
  s_add_u32 m0, s13, 122880
  s_add_u32 s7, s10, 196608
  buffer_load_dwordx4 v20, s[44:47], s7 offen lds
  s_add_u32 m0, s13, 126976
  s_add_u32 s7, s10, 229376
  buffer_load_dwordx4 v20, s[44:47], s7 offen lds
  s_add_u32 m0, s13, 131072
  s_add_u32 s7, s10, 294912
  buffer_load_dwordx4 v20, s[44:47], s7 offen lds
  s_add_u32 m0, s13, 135168
  s_add_u32 s7, s10, 327680
  buffer_load_dwordx4 v20, s[44:47], s7 offen lds
  s_add_u32 m0, s13, 139264
  s_add_u32 s7, s10, 360448
  buffer_load_dwordx4 v20, s[44:47], s7 offen lds
  s_add_u32 m0, s13, 0
  s_nop 0
  buffer_load_dwordx4 v20, s[44:47], s10 offen lds
  s_add_u32 m0, s13, 4096
  s_add_u32 s7, s10, 32768
  buffer_load_dwordx4 v20, s[44:47], s7 offen lds
  s_add_u32 m0, s13, 8192
  s_add_u32 s7, s10, 65536
  buffer_load_dwordx4 v20, s[44:47], s7 offen lds
  s_add_u32 m0, s13, 12288
  s_add_u32 s7, s10, 98304
  buffer_load_dwordx4 v20, s[44:47], s7 offen lds
  ds_read_b64_tr_b16 v[112:113], v160 offset:45056
  ds_read_b64_tr_b16 v[114:115], v160 offset:45312
  ds_read_b64_tr_b16 v[116:117], v161 offset:45056
  ds_read_b64_tr_b16 v[118:119], v161 offset:45312
  ds_read_b64_tr_b16 v[120:121], v162 offset:45056
  ds_read_b64_tr_b16 v[122:123], v162 offset:45312
  s_waitcnt lgkmcnt(4)
  v_mfma_f32_16x16x32_bf16 v[128:131], v[112:115], v[8:11], v[128:131]
  s_waitcnt lgkmcnt(2)
  v_mfma_f32_16x16x32_bf16 v[132:135], v[116:119], v[8:11], v[132:135]
  s_waitcnt lgkmcnt(0)
  v_mfma_f32_16x16x32_bf16 v[136:139], v[120:123], v[8:11], v[136:139]
  s_waitcnt vmcnt(11)
  s_barrier
  s_add_u32 m0, s13, 110592
  s_add_u32 s7, s10, 491520
  buffer_load_dwordx4 v20, s[44:47], s7 offen lds
  s_add_u32 m0, s13, 86016
  s_add_u32 s7, s10, 327680
  buffer_load_dwordx4 v20, s[40:43], s7 offen lds
  s_add_u32 m0, s13, 90112
  s_add_u32 s7, s10, 360448
  buffer_load_dwordx4 v20, s[40:43], s7 offen lds
  s_add_u32 m0, s13, 94208
  s_add_u32 s7, s10, 393216
  buffer_load_dwordx4 v20, s[40:43], s7 offen lds
  s_add_u32 m0, s13, 98304
  s_add_u32 s7, s10, 425984
  buffer_load_dwordx4 v20, s[40:43], s7 offen lds
  s_add_u32 m0, s13, 102400
  s_add_u32 s7, s10, 458752
  buffer_load_dwordx4 v20, s[40:43], s7 offen lds
  s_add_u32 m0, s13, 106496
  s_add_u32 s7, s10, 491520
  buffer_load_dwordx4 v20, s[40:43], s7 offen lds
  s_add_u32 m0, s13, 45056
  s_nop 0
  buffer_load_dwordx4 v20, s[40:43], s10 offen lds
  s_add_u32 m0, s13, 49152
  s_add_u32 s7, s10, 32768
  buffer_load_dwordx4 v20, s[40:43], s7 offen lds
  s_add_u32 m0, s13, 53248
  s_add_u32 s7, s10, 65536
  buffer_load_dwordx4 v20, s[40:43], s7 offen lds
  ds_read_b64_tr_b16 v[112:113], v164 offset:8192
  ds_read_b64_tr_b16 v[114:115], v164 offset:8448
  ds_read_b64_tr_b16 v[116:117], v165 offset:8192
  ds_read_b64_tr_b16 v[118:119], v165 offset:8448
  ds_read_b64_tr_b16 v[120:121], v166 offset:8192
  ds_read_b64_tr_b16 v[122:123], v166 offset:8448
  s_waitcnt lgkmcnt(4)
  v_mfma_f32_16x16x32_bf16 v[128:131], v[112:115], v[8:11], v[128:131]
  s_waitcnt lgkmcnt(2)
  v_mfma_f32_16x16x32_bf16 v[132:135], v[116:119], v[8:11], v[132:135]
  s_waitcnt lgkmcnt(0)
  v_mfma_f32_16x16x32_bf16 v[136:139], v[120:123], v[8:11], v[136:139]
  s_and_b32 s6, s5, 1
  s_mul_i32 s6, s6, 384
  s_lshr_b32 s7, s5, 1
  s_mul_i32 s7, s7, 192
  s_add_u32 s6, s6, s7
  s_add_u32 s6, s6, 143360
  v_lshlrev_b32 v24, 4, v3
  v_add_u32 v24, s6, v24
  s_mov_b32 exec_lo, 0x00010001
  s_mov_b32 exec_hi, 0x00010001
  ds_write_b128 v24, v[128:131] offset:0
  ds_write_b128 v24, v[132:135] offset:64
  ds_write_b128 v24, v[136:139] offset:128
  s_mov_b64 exec, -1
  s_waitcnt lgkmcnt(0)
  s_barrier
  s_cmp_lg_u32 s5, 1
  s_cbranch_scc1 LS1al_ini_ok
  s_waitcnt vmcnt(21)
LS1al_ini:
  v_cmp_gt_u32 vcc, 32, v241
  s_cmp_eq_u64 vcc, 0
  s_cbranch_scc1 LS1al_ini_ok
  buffer_load_dword v241, v240, s[96:99], 0 offen offset:4 sc1
  s_waitcnt vmcnt(0)
  s_sub_u32 s0, s0, 1
  s_cbranch_scc0 LS1al_ini
  s_mov_b32 s0, 0
LS1al_ini_ok:
  s_cmp_lg_u32 s5, 0
  s_cbranch_scc1 LS1al_noe
  s_cmp_lg_u32 s3, 0
  s_cbranch_scc1 LS1al_jc
  v_lshlrev_b32 v24, 4, v1
  v_add_u32 v24, 143360, v24
  ds_read_b128 v[60:63], v24
  ds_read_b128 v[64:67], v24 offset:384
  v_lshrrev_b32 v25, 3, v1
  v_and_b32 v26, 7, v1
  v_lshlrev_b32 v25, 11, v25
  v_lshl_add_u32 v25, v26, 4, v25
  s_lshl_b32 s6, s4, 7
  s_add_u32 s6, s6, 21495808
  s_waitcnt lgkmcnt(0)
  v_pk_add_f32 v[60:61], v[60:61], v[64:65]
  v_pk_add_f32 v[62:63], v[62:63], v[66:67]
  s_mov_b64 exec, 0xffffff
  buffer_store_dwordx4 v[60:63], v25, s[56:59], s6 offen sc1
  s_branch LS1al_jc
LS1al_noe:
  s_cmp_lg_u32 s5, 3
  s_cbranch_scc1 LS1al_jc
  s_cmp_ge_u32 s48, 118
  s_cbranch_scc1 LS1al_jd
  v_lshrrev_b32 v24, 2, v2
  v_and_b32 v25, 3, v2
  v_lshl_add_u32 v26, v3, 3, v24
  v_and_b32 v27, 1, v3
  v_lshlrev_b32 v27, 1, v27
  v_lshlrev_b32 v26, 6, v26
  v_and_b32 v28, 1, v25
  v_lshl_add_u32 v26, v28, 3, v26
  v_lshrrev_b32 v25, 1, v25
  v_or_b32 v28, 0, v25
  v_xor_b32 v28, v28, v27
  v_lshl_add_u32 v160, v28, 4, v26
  v_or_b32 v28, 2, v25
  v_xor_b32 v28, v28, v27
  v_lshl_add_u32 v161, v28, 4, v26
  v_add_u32 v162, 4096, v160
  v_add_u32 v163, 4096, v161
  v_add_u32 v164, 8192, v160
  v_add_u32 v165, 8192, v161
  v_add_u32 v160, 145408, v160
  v_add_u32 v161, 145408, v161
  ds_read_b64_tr_b16 v[64:65], v160 offset:0
  ds_read_b64_tr_b16 v[66:67], v160 offset:256
  ds_read_b64_tr_b16 v[68:69], v161 offset:0
  ds_read_b64_tr_b16 v[70:71], v161 offset:256
  ds_read_b64_tr_b16 v[72:73], v160 offset:2048
  ds_read_b64_tr_b16 v[74:75], v160 offset:2304
  ds_read_b64_tr_b16 v[76:77], v161 offset:2048
  ds_read_b64_tr_b16 v[78:79], v161 offset:2304
  ds_read_b64_tr_b16 v[80:81], v160 offset:4096
  ds_read_b64_tr_b16 v[82:83], v160 offset:4352
  ds_read_b64_tr_b16 v[84:85], v161 offset:4096
  ds_read_b64_tr_b16 v[86:87], v161 offset:4352
  s_waitcnt lgkmcnt(8)
  v_mfma_f32_16x16x32_bf16 v[40:43], v[64:67], v[8:11], 0
  v_mfma_f32_16x16x32_bf16 v[44:47], v[68:71], v[8:11], 0
  ds_read_b64_tr_b16 v[88:89], v160 offset:6144
  ds_read_b64_tr_b16 v[90:91], v160 offset:6400
  ds_read_b64_tr_b16 v[92:93], v161 offset:6144
  ds_read_b64_tr_b16 v[94:95], v161 offset:6400
  s_waitcnt lgkmcnt(8)
  v_mfma_f32_16x16x32_bf16 v[40:43], v[72:75], v[8:11], v[40:43]
  v_mfma_f32_16x16x32_bf16 v[44:47], v[76:79], v[8:11], v[44:47]
  ds_read_b64_tr_b16 v[96:97], v160 offset:8192
  ds_read_b64_tr_b16 v[98:99], v160 offset:8448
  ds_read_b64_tr_b16 v[100:101], v161 offset:8192
  ds_read_b64_tr_b16 v[102:103], v161 offset:8448
  s_waitcnt lgkmcnt(8)
  v_mfma_f32_16x16x32_bf16 v[40:43], v[80:83], v[8:11], v[40:43]
  v_mfma_f32_16x16x32_bf16 v[44:47], v[84:87], v[8:11], v[44:47]
  ds_read_b64_tr_b16 v[104:105], v160 offset:10240
  ds_read_b64_tr_b16 v[106:107], v160 offset:10496
  ds_read_b64_tr_b16 v[108:109], v161 offset:10240
  ds_read_b64_tr_b16 v[110:111], v161 offset:10496
  s_waitcnt lgkmcnt(8)
  v_mfma_f32_16x16x32_bf16 v[40:43], v[88:91], v[8:11], v[40:43]
  v_mfma_f32_16x16x32_bf16 v[44:47], v[92:95], v[8:11], v[44:47]
  ds_read_b64_tr_b16 v[112:113], v160 offset:12288
  ds_read_b64_tr_b16 v[114:115], v160 offset:12544
  ds_read_b64_tr_b16 v[116:117], v161 offset:12288
  ds_read_b64_tr_b16 v[118:119], v161 offset:12544
  s_waitcnt lgkmcnt(8)
  v_mfma_f32_16x16x32_bf16 v[40:43], v[96:99], v[8:11], v[40:43]
  v_mfma_f32_16x16x32_bf16 v[44:47], v[100:103], v[8:11], v[44:47]
  ds_read_b64_tr_b16 v[120:121], v160 offset:14336
  ds_read_b64_tr_b16 v[122:123], v160 offset:14592
  ds_read_b64_tr_b16 v[124:125], v161 offset:14336
  ds_read_b64_tr_b16 v[126:127], v161 offset:14592
  s_waitcnt lgkmcnt(8)
  v_mfma_f32_16x16x32_bf16 v[40:43], v[104:107], v[8:11], v[40:43]
  v_mfma_f32_16x16x32_bf16 v[44:47], v[108:111], v[8:11], v[44:47]
  s_lshr_b32 s6, s48, 1
  s_mov_b32 s49, 21504000
  s_cmp_lt_u32 s6, 16
  s_cselect_b32 s49, s49, 21506048
  s_lshl_b32 s7, s6, 7
  s_add_u32 s49, s49, s7
  s_and_b32 s7, s48, 1
  s_mul_i32 s7, s7, 32768
  s_add_u32 s49, s49, s7
  s_waitcnt lgkmcnt(4)
  v_mfma_f32_16x16x32_bf16 v[40:43], v[112:115], v[8:11], v[40:43]
  v_mfma_f32_16x16x32_bf16 v[44:47], v[116:119], v[8:11], v[44:47]
  s_waitcnt lgkmcnt(0)
  v_mfma_f32_16x16x32_bf16 v[40:43], v[120:123], v[8:11], v[40:43]
  v_mfma_f32_16x16x32_bf16 v[44:47], v[124:127], v[8:11], v[44:47]
  v_lshlrev_b32 v24, 4, v3
  s_mov_b32 exec_lo, 0x00010001
  s_mov_b32 exec_hi, 0x00010001
  s_nop 3
  buffer_store_dwordx4 v[40:43], v24, s[56:59], s49 offen offset:0 sc1
  buffer_store_dwordx4 v[44:47], v24, s[56:59], s49 offen offset:64 sc1
LS1al_jc:
  s_mov_b64 exec, -1
  s_sub_u32 s6, s48, 32
  s_cmp_ge_u32 s6, 86
  s_cbranch_scc1 LS1al_jd
  s_lshl_b32 s7, s5, 12
  s_add_u32 s7, s7, 131072
  v_lshrrev_b32 v24, 2, v2
  v_and_b32 v25, 3, v2
  v_lshl_add_u32 v26, v3, 3, v24
  v_and_b32 v27, 1, v3
  v_lshlrev_b32 v27, 1, v27
  v_lshlrev_b32 v26, 6, v26
  v_and_b32 v28, 1, v25
  v_lshl_add_u32 v26, v28, 3, v26
  v_lshrrev_b32 v25, 1, v25
  v_or_b32 v28, 0, v25
  v_xor_b32 v28, v28, v27
  v_lshl_add_u32 v160, v28, 4, v26
  v_or_b32 v28, 2, v25
  v_xor_b32 v28, v28, v27
  v_lshl_add_u32 v161, v28, 4, v26
  v_add_u32 v160, s7, v160
  v_add_u32 v161, s7, v161
  ds_read_b64_tr_b16 v[64:65], v160 offset:14336
  ds_read_b64_tr_b16 v[66:67], v160 offset:14592
  ds_read_b64_tr_b16 v[68:69], v161 offset:14336
  ds_read_b64_tr_b16 v[70:71], v161 offset:14592
  ds_read_b64_tr_b16 v[72:73], v160 offset:16384
  ds_read_b64_tr_b16 v[74:75], v160 offset:16640
  ds_read_b64_tr_b16 v[76:77], v161 offset:16384
  ds_read_b64_tr_b16 v[78:79], v161 offset:16640
  s_lshr_b32 s6, s48, 1
  s_sub_u32 s6, s6, 16
  s_mul_i32 s6, s6, 37120
  s_and_b32 s7, s48, 1
  s_lshl_b32 s7, s7, 14
  s_add_u32 s6, s6, s7
  s_add_u32 s6, s6, 28311552
  s_lshl_b32 s7, s5, 12
  s_add_u32 s6, s6, s7
  s_waitcnt lgkmcnt(6)
  buffer_store_dwordx4 v[64:67], v21, s[56:59], s6 offen offset:0 sc1
  s_waitcnt lgkmcnt(4)
  buffer_store_dwordx4 v[68:71], v21, s[56:59], s6 offen offset:1024 sc1
  s_waitcnt lgkmcnt(2)
  buffer_store_dwordx4 v[72:75], v21, s[56:59], s6 offen offset:2048 sc1
  s_waitcnt lgkmcnt(0)
  buffer_store_dwordx4 v[76:79], v21, s[56:59], s6 offen offset:3072 sc1
  s_nop 1
LS1al_jd:
  s_mov_b64 exec, -1
  s_lshl_b32 s7, s5, 2
  s_add_u32 s6, s15, 1
  s_add_u32 s7, s7, 161824
  v_mov_b32 v232, s6
  v_mov_b32 v233, s7
  s_mov_b64 exec, 1
  ds_write_b32 v233, v232
  s_mov_b64 exec, -1
  s_mul_i32 s50, s4, 36864
  s_add_u32 s50, s50, 30408704
  s_add_u32 m0, s13, 57344
  s_add_u32 s7, s10, 98304
  buffer_load_dwordx4 v20, s[40:43], s7 offen lds
  s_add_u32 m0, s13, 61440
  s_add_u32 s7, s10, 131072
  buffer_load_dwordx4 v20, s[40:43], s7 offen lds
  s_add_u32 m0, s13, 65536
  s_add_u32 s7, s10, 163840
  buffer_load_dwordx4 v20, s[40:43], s7 offen lds
  s_add_u32 m0, s13, 69632
  s_add_u32 s7, s10, 196608
  buffer_load_dwordx4 v20, s[40:43], s7 offen lds
  s_add_u32 m0, s13, 73728
  s_add_u32 s7, s10, 229376
  buffer_load_dwordx4 v20, s[40:43], s7 offen lds
  s_add_u32 m0, s13, 77824
  s_add_u32 s7, s10, 262144
  buffer_load_dwordx4 v20, s[40:43], s7 offen lds
  s_add_u32 m0, s13, 81920
  s_add_u32 s7, s10, 294912
  buffer_load_dwordx4 v20, s[40:43], s7 offen lds
  v_mov_b32 v234, 161808
  s_add_u32 s7, s15, 2
LS1al_pw2:
  ds_read_b128 v[226:229], v234
  s_waitcnt lgkmcnt(0)
  v_min_u32 v226, v226, v227
  v_min3_u32 v226, v226, v228, v229
  s_nop 0
  v_readfirstlane_b32 s6, v226
  s_cmp_ge_u32 s6, s7
  s_cbranch_scc1 LS1al_pw2_ok
  s_sleep 1
  s_sub_u32 s0, s0, 1
  s_cbranch_scc0 LS1al_pw2
  s_mov_b32 s0, 0
LS1al_pw2_ok:
  v_mov_b32 v234, 161824
  s_add_u32 s7, s15, 1
LS1al_pw3:
  ds_read_b128 v[226:229], v234
  s_waitcnt lgkmcnt(0)
  v_min_u32 v226, v226, v227
  v_min3_u32 v226, v226, v228, v229
  s_nop 0
  v_readfirstlane_b32 s6, v226
  s_cmp_ge_u32 s6, s7
  s_cbranch_scc1 LS1al_pw3_ok
  s_sleep 1
  s_sub_u32 s0, s0, 1
  s_cbranch_scc0 LS1al_pw3
  s_mov_b32 s0, 0
LS1al_pw3_ok:
  s_add_u32 m0, s13, 155648
  s_add_u32 s7, s10, 262144
  buffer_load_dwordx4 v20, s[44:47], s7 offen lds
  s_add_u32 m0, s13, 143360
  s_add_u32 s7, s10, 393216
  buffer_load_dwordx4 v20, s[44:47], s7 offen lds
  s_add_u32 m0, s13, 147456
  s_add_u32 s7, s10, 425984
  buffer_load_dwordx4 v20, s[44:47], s7 offen lds
  s_add_u32 m0, s13, 151552
  s_add_u32 s7, s10, 458752
  buffer_load_dwordx4 v20, s[44:47], s7 offen lds
  s_waitcnt vmcnt(11)
  v_mov_b32 v240, 161792
  v_mov_b32 v241, 1
  v_mov_b32 v242, 1
  s_mov_b64 exec, 1
  ds_add_rtn_u32 v241, v240, v241 offset:8
  s_and_b32 s6, s100, 7
  s_lshl_b32 s6, s6, 12
  s_lshr_b32 s7, s100, 3
  s_lshl_b32 s7, s7, 2
  s_add_u32 s7, s7, s6
  s_add_u32 s7, s7, 21626880
  v_mov_b32 v240, s7
  s_waitcnt lgkmcnt(0)
  v_readfirstlane_b32 s6, v241
  s_cmp_lg_u32 s6, 7
  s_cbranch_scc1 LS1al_arr_no
  buffer_store_dword v242, v240, s[56:59], 0 offen offset:2560 sc1
LS1al_arr_no:
  s_mov_b64 exec, -1
  s_lshl_b32 s6, s5, 9
  v_lshlrev_b32 v26, 3, v1
  v_add_u32 v26, s6, v26
  v_mul_u32_u24 v27, 2304, v2
  v_lshl_add_u32 v27, v3, 4, v27
  s_lshl_b32 s6, s5, 6
  s_add_u32 s6, s6, 2048
  v_add_u32 v27, s6, v27
  s_lshr_b32 s6, s5, 1
  s_and_b32 s7, s5, 1
  s_lshl_b32 s7, s7, 3
  s_lshl_b32 s8, s6, 10
  s_add_u32 s8, s8, s7
  s_add_u32 s8, s8, 41984
  s_lshl_b32 s9, s6, 6
  s_add_u32 s9, s9, s7
  s_add_u32 s9, s9, 44032
  v_lshlrev_b32 v28, 6, v2
  v_lshl_add_u32 v28, v3, 4, v28
  v_add_u32 v28, s8, v28
  v_lshlrev_b32 v29, 4, v3
  v_add_u32 v29, s9, v29
  v_mov_b32 v30, 161792
  v_mov_b32 v32, 0x3f80
  v_mov_b32 v33, 0x3f800000
  v_mov_b32 v132, 0
  v_mov_b32 v133, 0
  v_mov_b32 v134, 0
  v_mov_b32 v135, 0
  s_mov_b32 s8, 0x1ffff
LS1al_gw:
  ds_read_b32 v31, v30 offset:4
  s_waitcnt lgkmcnt(0)
  v_readfirstlane_b32 s6, v31
  s_cmp_ge_u32 s6, 4
  s_cbranch_scc1 LS1al_gw_ok
  s_sleep 1
  s_branch LS1al_gw
LS1al_gw_ok:
  buffer_load_dwordx4 v[128:131], v27, s[56:59], s50 offen sc1
  s_add_u32 s7, s50, 0
  buffer_load_dwordx2 v[64:65], v26, s[56:59], s7 offen sc1
  s_add_u32 s7, s50, 2304
  buffer_load_dwordx2 v[66:67], v26, s[56:59], s7 offen sc1
  s_add_u32 s7, s50, 4608
  buffer_load_dwordx2 v[68:69], v26, s[56:59], s7 offen sc1
  s_add_u32 s7, s50, 6912
  buffer_load_dwordx2 v[70:71], v26, s[56:59], s7 offen sc1
  s_add_u32 s7, s50, 9216
  buffer_load_dwordx2 v[72:73], v26, s[56:59], s7 offen sc1
  s_add_u32 s7, s50, 11520
  buffer_load_dwordx2 v[74:75], v26, s[56:59], s7 offen sc1
  s_add_u32 s7, s50, 13824
  buffer_load_dwordx2 v[76:77], v26, s[56:59], s7 offen sc1
  s_add_u32 s7, s50, 16128
  buffer_load_dwordx2 v[78:79], v26, s[56:59], s7 offen sc1
  s_add_u32 s7, s50, 18432
  buffer_load_dwordx2 v[80:81], v26, s[56:59], s7 offen sc1
  s_add_u32 s7, s50, 20736
  buffer_load_dwordx2 v[82:83], v26, s[56:59], s7 offen sc1
  s_add_u32 s7, s50, 23040
  buffer_load_dwordx2 v[84:85], v26, s[56:59], s7 offen sc1
  s_add_u32 s7, s50, 25344
  buffer_load_dwordx2 v[86:87], v26, s[56:59], s7 offen sc1
  s_add_u32 s7, s50, 27648
  buffer_load_dwordx2 v[88:89], v26, s[56:59], s7 offen sc1
  s_add_u32 s7, s50, 29952
  buffer_load_dwordx2 v[90:91], v26, s[56:59], s7 offen sc1
  s_add_u32 s7, s50, 32256
  buffer_load_dwordx2 v[92:93], v26, s[56:59], s7 offen sc1
  s_add_u32 s7, s50, 34560
  buffer_load_dwordx2 v[94:95], v26, s[56:59], s7 offen sc1
  s_and_b32 s6, s2, 7
  s_lshl_b32 s6, s6, 4
  s_lshr_b32 s7, s2, 4
  s_add_u32 s6, s6, s7
  s_and_b32 s7, s2, 8
  s_add_u32 s7, s7, s101
  s_mul_i32 s6, s6, 62464
  s_mul_i32 s7, s7, 1024
  s_add_u32 s6, s6, s7
  s_add_u32 s6, s6, 50331648
  s_add_u32 s94, s38, s6
  s_addc_u32 s95, s39, 0
  s_load_dword s93, s[94:95], 0
  s_load_dword s93, s[94:95], 64
  s_load_dword s93, s[94:95], 128
  s_load_dword s93, s[94:95], 192
  s_load_dword s93, s[94:95], 256
  s_load_dword s93, s[94:95], 320
  s_load_dword s93, s[94:95], 384
  s_load_dword s93, s[94:95], 448
  s_load_dword s93, s[94:95], 512
  s_load_dword s93, s[94:95], 576
  s_load_dword s93, s[94:95], 640
  s_load_dword s93, s[94:95], 704
  s_load_dword s93, s[94:95], 768
  s_load_dword s93, s[94:95], 832
  s_load_dword s93, s[94:95], 896
  s_load_dword s93, s[94:95], 960
LS1al_st4:
  s_waitcnt vmcnt(16)
  v_max3_u32 v31, v128, v129, v130
  v_max_u32 v31, v31, v131
  v_cmp_eq_u32 vcc, -1, v31
  s_cbranch_vccnz LS1al_gar16
  v_add_f32_dpp v128, v128, v128 row_ror:8 row_mask:0xf bank_mask:0xf
  v_add_f32_dpp v129, v129, v129 row_ror:8 row_mask:0xf bank_mask:0xf
  v_add_f32_dpp v130, v130, v130 row_ror:8 row_mask:0xf bank_mask:0xf
  v_add_f32_dpp v131, v131, v131 row_ror:8 row_mask:0xf bank_mask:0xf
  v_add_f32_dpp v128, v128, v128 row_ror:4 row_mask:0xf bank_mask:0xf
  v_add_f32_dpp v129, v129, v129 row_ror:4 row_mask:0xf bank_mask:0xf
  v_add_f32_dpp v130, v130, v130 row_ror:4 row_mask:0xf bank_mask:0xf
  v_add_f32_dpp v131, v131, v131 row_ror:4 row_mask:0xf bank_mask:0xf
  v_add_f32_dpp v128, v128, v128 row_ror:2 row_mask:0xf bank_mask:0xf
  v_add_f32_dpp v129, v129, v129 row_ror:2 row_mask:0xf bank_mask:0xf
  v_add_f32_dpp v130, v130, v130 row_ror:2 row_mask:0xf bank_mask:0xf
  v_add_f32_dpp v131, v131, v131 row_ror:2 row_mask:0xf bank_mask:0xf
  v_add_f32_dpp v128, v128, v128 row_ror:1 row_mask:0xf bank_mask:0xf
  v_add_f32_dpp v129, v129, v129 row_ror:1 row_mask:0xf bank_mask:0xf
  v_add_f32_dpp v130, v130, v130 row_ror:1 row_mask:0xf bank_mask:0xf
  v_add_f32_dpp v131, v131, v131 row_ror:1 row_mask:0xf bank_mask:0xf
  v_cvt_pk_bf16_f32 v142, v128, v129
  v_cvt_pk_bf16_f32 v143, v130, v131
  s_bitset0_b32 s8, 16
LS1al_gan16:
  s_waitcnt vmcnt(15)
  v_max_u32 v31, v64, v65
  v_cmp_eq_u32 vcc, -1, v31
  s_cbranch_vccnz LS1al_gar0
  v_dot2_f32_bf16 v132, v64, v32, v132
  v_dot2_f32_bf16 v133, v64, v33, v133
  v_dot2_f32_bf16 v134, v65, v32, v134
  v_dot2_f32_bf16 v135, v65, v33, v135
  s_bitset0_b32 s8, 0
LS1al_gan0:
  s_waitcnt vmcnt(14)
  v_max_u32 v31, v66, v67
  v_cmp_eq_u32 vcc, -1, v31
  s_cbranch_vccnz LS1al_gar1
  v_dot2_f32_bf16 v132, v66, v32, v132
  v_dot2_f32_bf16 v133, v66, v33, v133
  v_dot2_f32_bf16 v134, v67, v32, v134
  v_dot2_f32_bf16 v135, v67, v33, v135
  s_bitset0_b32 s8, 1
LS1al_gan1:
  s_waitcnt vmcnt(13)
  v_max_u32 v31, v68, v69
  v_cmp_eq_u32 vcc, -1, v31
  s_cbranch_vccnz LS1al_gar2
  v_dot2_f32_bf16 v132, v68, v32, v132
  v_dot2_f32_bf16 v133, v68, v33, v133
  v_dot2_f32_bf16 v134, v69, v32, v134
  v_dot2_f32_bf16 v135, v69, v33, v135
  s_bitset0_b32 s8, 2
LS1al_gan2:
  s_waitcnt vmcnt(12)
  v_max_u32 v31, v70, v71
  v_cmp_eq_u32 vcc, -1, v31
  s_cbranch_vccnz LS1al_gar3
  v_dot2_f32_bf16 v132, v70, v32, v132
  v_dot2_f32_bf16 v133, v70, v33, v133
  v_dot2_f32_bf16 v134, v71, v32, v134
  v_dot2_f32_bf16 v135, v71, v33, v135
  s_bitset0_b32 s8, 3
LS1al_gan3:
  s_waitcnt vmcnt(11)
  v_max_u32 v31, v72, v73
  v_cmp_eq_u32 vcc, -1, v31
  s_cbranch_vccnz LS1al_gar4
  v_dot2_f32_bf16 v132, v72, v32, v132
  v_dot2_f32_bf16 v133, v72, v33, v133
  v_dot2_f32_bf16 v134, v73, v32, v134
  v_dot2_f32_bf16 v135, v73, v33, v135
  s_bitset0_b32 s8, 4
LS1al_gan4:
  s_waitcnt vmcnt(10)
  v_max_u32 v31, v74, v75
  v_cmp_eq_u32 vcc, -1, v31
  s_cbranch_vccnz LS1al_gar5
  v_dot2_f32_bf16 v132, v74, v32, v132
  v_dot2_f32_bf16 v133, v74, v33, v133
  v_dot2_f32_bf16 v134, v75, v32, v134
  v_dot2_f32_bf16 v135, v75, v33, v135
  s_bitset0_b32 s8, 5
LS1al_gan5:
  s_waitcnt vmcnt(9)
  v_max_u32 v31, v76, v77
  v_cmp_eq_u32 vcc, -1, v31
  s_cbranch_vccnz LS1al_gar6
  v_dot2_f32_bf16 v132, v76, v32, v132
  v_dot2_f32_bf16 v133, v76, v33, v133
  v_dot2_f32_bf16 v134, v77, v32, v134
  v_dot2_f32_bf16 v135, v77, v33, v135
  s_bitset0_b32 s8, 6
LS1al_gan6:
  s_waitcnt vmcnt(8)
  v_max_u32 v31, v78, v79
  v_cmp_eq_u32 vcc, -1, v31
  s_cbranch_vccnz LS1al_gar7
  v_dot2_f32_bf16 v132, v78, v32, v132
  v_dot2_f32_bf16 v133, v78, v33, v133
  v_dot2_f32_bf16 v134, v79, v32, v134
  v_dot2_f32_bf16 v135, v79, v33, v135
  s_bitset0_b32 s8, 7
LS1al_gan7:
  s_waitcnt vmcnt(7)
  v_max_u32 v31, v80, v81
  v_cmp_eq_u32 vcc, -1, v31
  s_cbranch_vccnz LS1al_gar8
  v_dot2_f32_bf16 v132, v80, v32, v132
  v_dot2_f32_bf16 v133, v80, v33, v133
  v_dot2_f32_bf16 v134, v81, v32, v134
  v_dot2_f32_bf16 v135, v81, v33, v135
  s_bitset0_b32 s8, 8
LS1al_gan8:
  s_waitcnt vmcnt(6)
  v_max_u32 v31, v82, v83
  v_cmp_eq_u32 vcc, -1, v31
  s_cbranch_vccnz LS1al_gar9
  v_dot2_f32_bf16 v132, v82, v32, v132
  v_dot2_f32_bf16 v133, v82, v33, v133
  v_dot2_f32_bf16 v134, v83, v32, v134
  v_dot2_f32_bf16 v135, v83, v33, v135
  s_bitset0_b32 s8, 9
LS1al_gan9:
  s_waitcnt vmcnt(5)
  v_max_u32 v31, v84, v85
  v_cmp_eq_u32 vcc, -1, v31
  s_cbranch_vccnz LS1al_gar10
  v_dot2_f32_bf16 v132, v84, v32, v132
  v_dot2_f32_bf16 v133, v84, v33, v133
  v_dot2_f32_bf16 v134, v85, v32, v134
  v_dot2_f32_bf16 v135, v85, v33, v135
  s_bitset0_b32 s8, 10
LS1al_gan10:
  s_waitcnt vmcnt(4)
  v_max_u32 v31, v86, v87
  v_cmp_eq_u32 vcc, -1, v31
  s_cbranch_vccnz LS1al_gar11
  v_dot2_f32_bf16 v132, v86, v32, v132
  v_dot2_f32_bf16 v133, v86, v33, v133
  v_dot2_f32_bf16 v134, v87, v32, v134
  v_dot2_f32_bf16 v135, v87, v33, v135
  s_bitset0_b32 s8, 11
LS1al_gan11:
  s_waitcnt vmcnt(3)
  v_max_u32 v31, v88, v89
  v_cmp_eq_u32 vcc, -1, v31
  s_cbranch_vccnz LS1al_gar12
  v_dot2_f32_bf16 v132, v88, v32, v132
  v_dot2_f32_bf16 v133, v88, v33, v133
  v_dot2_f32_bf16 v134, v89, v32, v134
  v_dot2_f32_bf16 v135, v89, v33, v135
  s_bitset0_b32 s8, 12
LS1al_gan12:
  s_waitcnt vmcnt(2)
  v_max_u32 v31, v90, v91
  v_cmp_eq_u32 vcc, -1, v31
  s_cbranch_vccnz LS1al_gar13
  v_dot2_f32_bf16 v132, v90, v32, v132
  v_dot2_f32_bf16 v133, v90, v33, v133
  v_dot2_f32_bf16 v134, v91, v32, v134
  v_dot2_f32_bf16 v135, v91, v33, v135
  s_bitset0_b32 s8, 13
LS1al_gan13:
  s_waitcnt vmcnt(1)
  v_max_u32 v31, v92, v93
  v_cmp_eq_u32 vcc, -1, v31
  s_cbranch_vccnz LS1al_gar14
  v_dot2_f32_bf16 v132, v92, v32, v132
  v_dot2_f32_bf16 v133, v92, v33, v133
  v_dot2_f32_bf16 v134, v93, v32, v134
  v_dot2_f32_bf16 v135, v93, v33, v135
  s_bitset0_b32 s8, 14
LS1al_gan14:
  s_waitcnt vmcnt(0)
  v_max_u32 v31, v94, v95
  v_cmp_eq_u32 vcc, -1, v31
  s_cbranch_vccnz LS1al_gar15
  v_dot2_f32_bf16 v132, v94, v32, v132
  v_dot2_f32_bf16 v133, v94, v33, v133
  v_dot2_f32_bf16 v134, v95, v32, v134
  v_dot2_f32_bf16 v135, v95, v33, v135
  s_bitset0_b32 s8, 15
LS1al_gan15:
LS1al_gchk:
  s_cmp_eq_u32 s8, 0
  s_cbranch_scc1 LS1al_gok
  s_waitcnt vmcnt(0)
  s_bitcmp1_b32 s8, 16
  s_cbranch_scc0 LS1al_gbn16
  v_max3_u32 v31, v128, v129, v130
  v_max_u32 v31, v31, v131
  v_cmp_eq_u32 vcc, -1, v31
  s_cbranch_vccnz LS1al_gbr16
  v_add_f32_dpp v128, v128, v128 row_ror:8 row_mask:0xf bank_mask:0xf
  v_add_f32_dpp v129, v129, v129 row_ror:8 row_mask:0xf bank_mask:0xf
  v_add_f32_dpp v130, v130, v130 row_ror:8 row_mask:0xf bank_mask:0xf
  v_add_f32_dpp v131, v131, v131 row_ror:8 row_mask:0xf bank_mask:0xf
  v_add_f32_dpp v128, v128, v128 row_ror:4 row_mask:0xf bank_mask:0xf
  v_add_f32_dpp v129, v129, v129 row_ror:4 row_mask:0xf bank_mask:0xf
  v_add_f32_dpp v130, v130, v130 row_ror:4 row_mask:0xf bank_mask:0xf
  v_add_f32_dpp v131, v131, v131 row_ror:4 row_mask:0xf bank_mask:0xf
  v_add_f32_dpp v128, v128, v128 row_ror:2 row_mask:0xf bank_mask:0xf
  v_add_f32_dpp v129, v129, v129 row_ror:2 row_mask:0xf bank_mask:0xf
  v_add_f32_dpp v130, v130, v130 row_ror:2 row_mask:0xf bank_mask:0xf
  v_add_f32_dpp v131, v131, v131 row_ror:2 row_mask:0xf bank_mask:0xf
  v_add_f32_dpp v128, v128, v128 row_ror:1 row_mask:0xf bank_mask:0xf
  v_add_f32_dpp v129, v129, v129 row_ror:1 row_mask:0xf bank_mask:0xf
  v_add_f32_dpp v130, v130, v130 row_ror:1 row_mask:0xf bank_mask:0xf
  v_add_f32_dpp v131, v131, v131 row_ror:1 row_mask:0xf bank_mask:0xf
  v_cvt_pk_bf16_f32 v142, v128, v129
  v_cvt_pk_bf16_f32 v143, v130, v131
  s_bitset0_b32 s8, 16
LS1al_gbn16:
  s_bitcmp1_b32 s8, 0
  s_cbranch_scc0 LS1al_gbn0
  v_max_u32 v31, v64, v65
  v_cmp_eq_u32 vcc, -1, v31
  s_cbranch_vccnz LS1al_gbr0
  v_dot2_f32_bf16 v132, v64, v32, v132
  v_dot2_f32_bf16 v133, v64, v33, v133
  v_dot2_f32_bf16 v134, v65, v32, v134
  v_dot2_f32_bf16 v135, v65, v33, v135
  s_bitset0_b32 s8, 0
LS1al_gbn0:
  s_bitcmp1_b32 s8, 1
  s_cbranch_scc0 LS1al_gbn1
  v_max_u32 v31, v66, v67
  v_cmp_eq_u32 vcc, -1, v31
  s_cbranch_vccnz LS1al_gbr1
  v_dot2_f32_bf16 v132, v66, v32, v132
  v_dot2_f32_bf16 v133, v66, v33, v133
  v_dot2_f32_bf16 v134, v67, v32, v134
  v_dot2_f32_bf16 v135, v67, v33, v135
  s_bitset0_b32 s8, 1
LS1al_gbn1:
  s_bitcmp1_b32 s8, 2
  s_cbranch_scc0 LS1al_gbn2
  v_max_u32 v31, v68, v69
  v_cmp_eq_u32 vcc, -1, v31
  s_cbranch_vccnz LS1al_gbr2
  v_dot2_f32_bf16 v132, v68, v32, v132
  v_dot2_f32_bf16 v133, v68, v33, v133
  v_dot2_f32_bf16 v134, v69, v32, v134
  v_dot2_f32_bf16 v135, v69, v33, v135
  s_bitset0_b32 s8, 2
LS1al_gbn2:
  s_bitcmp1_b32 s8, 3
  s_cbranch_scc0 LS1al_gbn3
  v_max_u32 v31, v70, v71
  v_cmp_eq_u32 vcc, -1, v31
  s_cbranch_vccnz LS1al_gbr3
  v_dot2_f32_bf16 v132, v70, v32, v132
  v_dot2_f32_bf16 v133, v70, v33, v133
  v_dot2_f32_bf16 v134, v71, v32, v134
  v_dot2_f32_bf16 v135, v71, v33, v135
  s_bitset0_b32 s8, 3
LS1al_gbn3:
  s_bitcmp1_b32 s8, 4
  s_cbranch_scc0 LS1al_gbn4
  v_max_u32 v31, v72, v73
  v_cmp_eq_u32 vcc, -1, v31
  s_cbranch_vccnz LS1al_gbr4
  v_dot2_f32_bf16 v132, v72, v32, v132
  v_dot2_f32_bf16 v133, v72, v33, v133
  v_dot2_f32_bf16 v134, v73, v32, v134
  v_dot2_f32_bf16 v135, v73, v33, v135
  s_bitset0_b32 s8, 4
LS1al_gbn4:
  s_bitcmp1_b32 s8, 5
  s_cbranch_scc0 LS1al_gbn5
  v_max_u32 v31, v74, v75
  v_cmp_eq_u32 vcc, -1, v31
  s_cbranch_vccnz LS1al_gbr5
  v_dot2_f32_bf16 v132, v74, v32, v132
  v_dot2_f32_bf16 v133, v74, v33, v133
  v_dot2_f32_bf16 v134, v75, v32, v134
  v_dot2_f32_bf16 v135, v75, v33, v135
  s_bitset0_b32 s8, 5
LS1al_gbn5:
  s_bitcmp1_b32 s8, 6
  s_cbranch_scc0 LS1al_gbn6
  v_max_u32 v31, v76, v77
  v_cmp_eq_u32 vcc, -1, v31
  s_cbranch_vccnz LS1al_gbr6
  v_dot2_f32_bf16 v132, v76, v32, v132
  v_dot2_f32_bf16 v133, v76, v33, v133
  v_dot2_f32_bf16 v134, v77, v32, v134
  v_dot2_f32_bf16 v135, v77, v33, v135
  s_bitset0_b32 s8, 6
LS1al_gbn6:
  s_bitcmp1_b32 s8, 7
  s_cbranch_scc0 LS1al_gbn7
  v_max_u32 v31, v78, v79
  v_cmp_eq_u32 vcc, -1, v31
  s_cbranch_vccnz LS1al_gbr7
  v_dot2_f32_bf16 v132, v78, v32, v132
  v_dot2_f32_bf16 v133, v78, v33, v133
  v_dot2_f32_bf16 v134, v79, v32, v134
  v_dot2_f32_bf16 v135, v79, v33, v135
  s_bitset0_b32 s8, 7
LS1al_gbn7:
  s_bitcmp1_b32 s8, 8
  s_cbranch_scc0 LS1al_gbn8
  v_max_u32 v31, v80, v81
  v_cmp_eq_u32 vcc, -1, v31
  s_cbranch_vccnz LS1al_gbr8
  v_dot2_f32_bf16 v132, v80, v32, v132
  v_dot2_f32_bf16 v133, v80, v33, v133
  v_dot2_f32_bf16 v134, v81, v32, v134
  v_dot2_f32_bf16 v135, v81, v33, v135
  s_bitset0_b32 s8, 8
LS1al_gbn8:
  s_bitcmp1_b32 s8, 9
  s_cbranch_scc0 LS1al_gbn9
  v_max_u32 v31, v82, v83
  v_cmp_eq_u32 vcc, -1, v31
  s_cbranch_vccnz LS1al_gbr9
  v_dot2_f32_bf16 v132, v82, v32, v132
  v_dot2_f32_bf16 v133, v82, v33, v133
  v_dot2_f32_bf16 v134, v83, v32, v134
  v_dot2_f32_bf16 v135, v83, v33, v135
  s_bitset0_b32 s8, 9
LS1al_gbn9:
  s_bitcmp1_b32 s8, 10
  s_cbranch_scc0 LS1al_gbn10
  v_max_u32 v31, v84, v85
  v_cmp_eq_u32 vcc, -1, v31
  s_cbranch_vccnz LS1al_gbr10
  v_dot2_f32_bf16 v132, v84, v32, v132
  v_dot2_f32_bf16 v133, v84, v33, v133
  v_dot2_f32_bf16 v134, v85, v32, v134
  v_dot2_f32_bf16 v135, v85, v33, v135
  s_bitset0_b32 s8, 10
LS1al_gbn10:
  s_bitcmp1_b32 s8, 11
  s_cbranch_scc0 LS1al_gbn11
  v_max_u32 v31, v86, v87
  v_cmp_eq_u32 vcc, -1, v31
  s_cbranch_vccnz LS1al_gbr11
  v_dot2_f32_bf16 v132, v86, v32, v132
  v_dot2_f32_bf16 v133, v86, v33, v133
  v_dot2_f32_bf16 v134, v87, v32, v134
  v_dot2_f32_bf16 v135, v87, v33, v135
  s_bitset0_b32 s8, 11
LS1al_gbn11:
  s_bitcmp1_b32 s8, 12
  s_cbranch_scc0 LS1al_gbn12
  v_max_u32 v31, v88, v89
  v_cmp_eq_u32 vcc, -1, v31
  s_cbranch_vccnz LS1al_gbr12
  v_dot2_f32_bf16 v132, v88, v32, v132
  v_dot2_f32_bf16 v133, v88, v33, v133
  v_dot2_f32_bf16 v134, v89, v32, v134
  v_dot2_f32_bf16 v135, v89, v33, v135
  s_bitset0_b32 s8, 12
LS1al_gbn12:
  s_bitcmp1_b32 s8, 13
  s_cbranch_scc0 LS1al_gbn13
  v_max_u32 v31, v90, v91
  v_cmp_eq_u32 vcc, -1, v31
  s_cbranch_vccnz LS1al_gbr13
  v_dot2_f32_bf16 v132, v90, v32, v132
  v_dot2_f32_bf16 v133, v90, v33, v133
  v_dot2_f32_bf16 v134, v91, v32, v134
  v_dot2_f32_bf16 v135, v91, v33, v135
  s_bitset0_b32 s8, 13
LS1al_gbn13:
  s_bitcmp1_b32 s8, 14
  s_cbranch_scc0 LS1al_gbn14
  v_max_u32 v31, v92, v93
  v_cmp_eq_u32 vcc, -1, v31
  s_cbranch_vccnz LS1al_gbr14
  v_dot2_f32_bf16 v132, v92, v32, v132
  v_dot2_f32_bf16 v133, v92, v33, v133
  v_dot2_f32_bf16 v134, v93, v32, v134
  v_dot2_f32_bf16 v135, v93, v33, v135
  s_bitset0_b32 s8, 14
LS1al_gbn14:
  s_bitcmp1_b32 s8, 15
  s_cbranch_scc0 LS1al_gbn15
  v_max_u32 v31, v94, v95
  v_cmp_eq_u32 vcc, -1, v31
  s_cbranch_vccnz LS1al_gbr15
  v_dot2_f32_bf16 v132, v94, v32, v132
  v_dot2_f32_bf16 v133, v94, v33, v133
  v_dot2_f32_bf16 v134, v95, v32, v134
  v_dot2_f32_bf16 v135, v95, v33, v135
  s_bitset0_b32 s8, 15
LS1al_gbn15:
  s_sub_u32 s0, s0, 1
  s_cbranch_scc0 LS1al_gchk
  s_mov_b32 s0, 0
  s_waitcnt vmcnt(0)
  s_branch LS1al_gok
LS1al_gar16:
  buffer_load_dwordx4 v[128:131], v27, s[56:59], s50 offen sc1
  s_branch LS1al_gan16
LS1al_gar0:
  s_add_u32 s7, s50, 0
  buffer_load_dwordx2 v[64:65], v26, s[56:59], s7 offen sc1
  s_branch LS1al_gan0
LS1al_gar1:
  s_add_u32 s7, s50, 2304
  buffer_load_dwordx2 v[66:67], v26, s[56:59], s7 offen sc1
  s_branch LS1al_gan1
LS1al_gar2:
  s_add_u32 s7, s50, 4608
  buffer_load_dwordx2 v[68:69], v26, s[56:59], s7 offen sc1
  s_branch LS1al_gan2
LS1al_gar3:
  s_add_u32 s7, s50, 6912
  buffer_load_dwordx2 v[70:71], v26, s[56:59], s7 offen sc1
  s_branch LS1al_gan3
LS1al_gar4:
  s_add_u32 s7, s50, 9216
  buffer_load_dwordx2 v[72:73], v26, s[56:59], s7 offen sc1
  s_branch LS1al_gan4
LS1al_gar5:
  s_add_u32 s7, s50, 11520
  buffer_load_dwordx2 v[74:75], v26, s[56:59], s7 offen sc1
  s_branch LS1al_gan5
LS1al_gar6:
  s_add_u32 s7, s50, 13824
  buffer_load_dwordx2 v[76:77], v26, s[56:59], s7 offen sc1
  s_branch LS1al_gan6
LS1al_gar7:
  s_add_u32 s7, s50, 16128
  buffer_load_dwordx2 v[78:79], v26, s[56:59], s7 offen sc1
  s_branch LS1al_gan7
LS1al_gar8:
  s_add_u32 s7, s50, 18432
  buffer_load_dwordx2 v[80:81], v26, s[56:59], s7 offen sc1
  s_branch LS1al_gan8
LS1al_gar9:
  s_add_u32 s7, s50, 20736
  buffer_load_dwordx2 v[82:83], v26, s[56:59], s7 offen sc1
  s_branch LS1al_gan9
LS1al_gar10:
  s_add_u32 s7, s50, 23040
  buffer_load_dwordx2 v[84:85], v26, s[56:59], s7 offen sc1
  s_branch LS1al_gan10
LS1al_gar11:
  s_add_u32 s7, s50, 25344
  buffer_load_dwordx2 v[86:87], v26, s[56:59], s7 offen sc1
  s_branch LS1al_gan11
LS1al_gar12:
  s_add_u32 s7, s50, 27648
  buffer_load_dwordx2 v[88:89], v26, s[56:59], s7 offen sc1
  s_branch LS1al_gan12
LS1al_gar13:
  s_add_u32 s7, s50, 29952
  buffer_load_dwordx2 v[90:91], v26, s[56:59], s7 offen sc1
  s_branch LS1al_gan13
LS1al_gar14:
  s_add_u32 s7, s50, 32256
  buffer_load_dwordx2 v[92:93], v26, s[56:59], s7 offen sc1
  s_branch LS1al_gan14
LS1al_gar15:
  s_add_u32 s7, s50, 34560
  buffer_load_dwordx2 v[94:95], v26, s[56:59], s7 offen sc1
  s_branch LS1al_gan15
LS1al_gbr16:
  buffer_load_dwordx4 v[128:131], v27, s[56:59], s50 offen sc1
  s_branch LS1al_gbn16
LS1al_gbr0:
  s_add_u32 s7, s50, 0
  buffer_load_dwordx2 v[64:65], v26, s[56:59], s7 offen sc1
  s_branch LS1al_gbn0
LS1al_gbr1:
  s_add_u32 s7, s50, 2304
  buffer_load_dwordx2 v[66:67], v26, s[56:59], s7 offen sc1
  s_branch LS1al_gbn1
LS1al_gbr2:
  s_add_u32 s7, s50, 4608
  buffer_load_dwordx2 v[68:69], v26, s[56:59], s7 offen sc1
  s_branch LS1al_gbn2
LS1al_gbr3:
  s_add_u32 s7, s50, 6912
  buffer_load_dwordx2 v[70:71], v26, s[56:59], s7 offen sc1
  s_branch LS1al_gbn3
LS1al_gbr4:
  s_add_u32 s7, s50, 9216
  buffer_load_dwordx2 v[72:73], v26, s[56:59], s7 offen sc1
  s_branch LS1al_gbn4
LS1al_gbr5:
  s_add_u32 s7, s50, 11520
  buffer_load_dwordx2 v[74:75], v26, s[56:59], s7 offen sc1
  s_branch LS1al_gbn5
LS1al_gbr6:
  s_add_u32 s7, s50, 13824
  buffer_load_dwordx2 v[76:77], v26, s[56:59], s7 offen sc1
  s_branch LS1al_gbn6
LS1al_gbr7:
  s_add_u32 s7, s50, 16128
  buffer_load_dwordx2 v[78:79], v26, s[56:59], s7 offen sc1
  s_branch LS1al_gbn7
LS1al_gbr8:
  s_add_u32 s7, s50, 18432
  buffer_load_dwordx2 v[80:81], v26, s[56:59], s7 offen sc1
  s_branch LS1al_gbn8
LS1al_gbr9:
  s_add_u32 s7, s50, 20736
  buffer_load_dwordx2 v[82:83], v26, s[56:59], s7 offen sc1
  s_branch LS1al_gbn9
LS1al_gbr10:
  s_add_u32 s7, s50, 23040
  buffer_load_dwordx2 v[84:85], v26, s[56:59], s7 offen sc1
  s_branch LS1al_gbn10
LS1al_gbr11:
  s_add_u32 s7, s50, 25344
  buffer_load_dwordx2 v[86:87], v26, s[56:59], s7 offen sc1
  s_branch LS1al_gbn11
LS1al_gbr12:
  s_add_u32 s7, s50, 27648
  buffer_load_dwordx2 v[88:89], v26, s[56:59], s7 offen sc1
  s_branch LS1al_gbn12
LS1al_gbr13:
  s_add_u32 s7, s50, 29952
  buffer_load_dwordx2 v[90:91], v26, s[56:59], s7 offen sc1
  s_branch LS1al_gbn13
LS1al_gbr14:
  s_add_u32 s7, s50, 32256
  buffer_load_dwordx2 v[92:93], v26, s[56:59], s7 offen sc1
  s_branch LS1al_gbn14
LS1al_gbr15:
  s_add_u32 s7, s50, 34560
  buffer_load_dwordx2 v[94:95], v26, s[56:59], s7 offen sc1
  s_branch LS1al_gbn15
LS1al_gok:
  v_cvt_pk_bf16_f32 v140, v132, v133
  v_cvt_pk_bf16_f32 v141, v134, v135
  ds_write_b64 v28, v[140:141]
  s_mov_b32 exec_lo, 0x00010001
  s_mov_b32 exec_hi, 0x00010001
  ds_write_b64 v29, v[142:143]
  s_mov_b64 exec, -1
  s_waitcnt lgkmcnt(0)
  s_barrier
  s_lshl_b32 s7, s5, 2
  s_add_u32 s6, s15, 2
  s_add_u32 s7, s7, 161824
  v_mov_b32 v232, s6
  v_mov_b32 v233, s7
  s_mov_b64 exec, 1
  ds_write_b32 v233, v232
  s_mov_b64 exec, -1
  s_and_b32 s6, s2, 7
  s_lshl_b32 s6, s6, 5
  s_lshr_b32 s7, s2, 3
  s_add_u32 s6, s6, s7
  s_lshl_b32 s6, s6, 2
  s_add_u32 s6, s6, s5
  s_and_b32 s7, s6, 7
  s_lshr_b32 s6, s6, 3
  s_mul_i32 s6, s6, 62464
  s_mul_i32 s7, s7, 2304
  s_add_u32 s6, s6, s7
  s_add_u32 s6, s6, 50375680
  s_add_u32 s94, s38, s6
  s_addc_u32 s95, s39, 0
  s_load_dword s93, s[94:95], 0
  s_load_dword s93, s[94:95], 64
  s_load_dword s93, s[94:95], 128
  s_load_dword s93, s[94:95], 192
  s_load_dword s93, s[94:95], 256
  s_load_dword s93, s[94:95], 320
  s_load_dword s93, s[94:95], 384
  s_load_dword s93, s[94:95], 448
  s_load_dword s93, s[94:95], 512
  s_load_dword s93, s[94:95], 576
  s_load_dword s93, s[94:95], 640
  s_load_dword s93, s[94:95], 704
  s_load_dword s93, s[94:95], 768
  s_load_dword s93, s[94:95], 832
  s_load_dword s93, s[94:95], 896
  s_load_dword s93, s[94:95], 960
  s_load_dword s93, s[94:95], 1024
  s_load_dword s93, s[94:95], 1088
  s_load_dword s93, s[94:95], 1152
  s_load_dword s93, s[94:95], 1216
  s_load_dword s93, s[94:95], 1280
  s_load_dword s93, s[94:95], 1344
  s_load_dword s93, s[94:95], 1408
  s_load_dword s93, s[94:95], 1472
  s_load_dword s93, s[94:95], 1536
  s_load_dword s93, s[94:95], 1600
  s_load_dword s93, s[94:95], 1664
  s_load_dword s93, s[94:95], 1728
  s_load_dword s93, s[94:95], 1792
  s_load_dword s93, s[94:95], 1856
  s_load_dword s93, s[94:95], 1920
  s_load_dword s93, s[94:95], 1984
  s_load_dword s93, s[94:95], 2048
  s_load_dword s93, s[94:95], 2112
  s_load_dword s93, s[94:95], 2176
  s_load_dword s93, s[94:95], 2240
LS1al_st5:
  s_cmp_lg_u32 s5, 0
  s_cbranch_scc1 LS1al_j_skip
  v_lshrrev_b32 v240, 3, v1
  v_and_b32 v241, 7, v1
  v_lshlrev_b32 v241, 4, v241
  v_lshl_add_u32 v240, v240, 12, v241
  s_mov_b32 s8, 21626880
LS1al_j:
  buffer_load_dwordx4 v[242:245], v240, s[56:59], s8 offen offset:2560 sc1
  s_waitcnt vmcnt(0)
  v_min_u32 v242, v242, v243
  v_min3_u32 v242, v242, v244, v245
  v_cmp_gt_u32 vcc, 1, v242
  s_cmp_eq_u64 vcc, 0
  s_cbranch_scc1 LS1al_j_ok
  s_sleep 8
  s_sub_u32 s0, s0, 1
  s_cbranch_scc0 LS1al_j
  s_mov_b32 s0, 0
LS1al_j_ok:
  v_lshlrev_b32 v22, 4, v1
  s_mul_i32 s6, s5, 32768
  s_lshr_b32 s7, s2, 5
  s_lshl_b32 s7, s7, 8
  s_add_u32 s6, s6, s7
  s_add_u32 s6, s6, 21504000
  s_add_u32 m0, s13, 159744
  s_nop 0
  buffer_load_dwordx4 v22, s[56:59], s6 offen lds
  s_add_u32 s6, s6, 32768
  s_mov_b32 m0, 160768
  s_nop 0
  buffer_load_dwordx4 v22, s[56:59], s6 offen lds
LS1al_j_skip:
  s_waitcnt vmcnt(0)
  s_lshl_b32 s7, s5, 2
  s_add_u32 s6, s15, 3
  s_add_u32 s7, s7, 161824
  v_mov_b32 v232, s6
  v_mov_b32 v233, s7
  s_mov_b64 exec, 1
  ds_write_b32 v233, v232
  s_mov_b64 exec, -1
  v_mov_b32 v234, 161824
  s_add_u32 s7, s15, 3
LS1al_pw6:
  ds_read_b128 v[226:229], v234
  s_waitcnt lgkmcnt(0)
  v_min_u32 v226, v226, v227
  v_min3_u32 v226, v226, v228, v229
  s_nop 0
  v_readfirstlane_b32 s6, v226
  s_cmp_ge_u32 s6, s7
  s_cbranch_scc1 LS1al_pw6_ok
  s_sleep 2
  s_sub_u32 s0, s0, 1
  s_cbranch_scc0 LS1al_pw6
  s_mov_b32 s0, 0
LS1al_pw6_ok:
LS1al_fin:
LS1al_skip:
  s_mov_b32 s2, s100
  s_cmp_ge_u32 s2, 256
  s_cbranch_scc1 LX_end
LXl_loop:
  s_and_b32 s6, s2, 7
  s_lshr_b32 s7, s2, 3
  s_lshl_b32 s6, s6, 2
  s_and_b32 s8, s7, 3
  s_add_u32 s3, s6, s8
  s_lshr_b32 s4, s7, 2
  v_mov_b32 v234, 161808
  s_add_u32 s7, s15, 4
LS2l_pw9:
  ds_read_b128 v[226:229], v234
  s_waitcnt lgkmcnt(0)
  v_min_u32 v226, v226, v227
  v_min3_u32 v226, v226, v228, v229
  s_nop 0
  v_readfirstlane_b32 s6, v226
  s_cmp_ge_u32 s6, s7
  s_cbranch_scc1 LS2l_pw9_ok
  s_sleep 1
  s_sub_u32 s0, s0, 1
  s_cbranch_scc0 LS2l_pw9
  s_mov_b32 s0, 0
LS2l_pw9_ok:
  s_cmp_lg_u32 s24, 0
  s_cbranch_scc1 LS2l_l1
  s_add_u32 m0, s13, 16384
  s_add_u32 s7, s12, 20480
  buffer_load_dwordx4 v23, s[56:59], s7 offen lds
  s_add_u32 m0, s13, 20480
  s_add_u32 s7, s12, 24576
  buffer_load_dwordx4 v23, s[56:59], s7 offen lds
  s_add_u32 m0, s13, 24576
  s_add_u32 s7, s12, 28672
  buffer_load_dwordx4 v23, s[56:59], s7 offen lds
  s_add_u32 m0, s13, 28672
  s_add_u32 s7, s12, 32768
  buffer_load_dwordx4 v23, s[56:59], s7 offen lds
  s_add_u32 m0, s13, 32768
  s_add_u32 s7, s12, 36864
  buffer_load_dwordx4 v23, s[56:59], s7 offen lds
  s_add_u32 m0, s13, 36864
  s_add_u32 s7, s12, 40960
  buffer_load_dwordx4 v23, s[56:59], s7 offen lds
LS2l_l1:
  s_add_u32 m0, s13, 40960
  s_add_u32 s7, s12, 45056
  buffer_load_dwordx4 v23, s[56:59], s7 offen lds
  v_mov_b32 v234, 161808
  s_add_u32 s7, s15, 5
LS2l_pw10:
  ds_read_b128 v[226:229], v234
  s_waitcnt lgkmcnt(0)
  v_min_u32 v226, v226, v227
  v_min3_u32 v226, v226, v228, v229
  s_nop 0
  v_readfirstlane_b32 s6, v226
  s_cmp_ge_u32 s6, s7
  s_cbranch_scc1 LS2l_pw10_ok
  s_sleep 1
  s_sub_u32 s0, s0, 1
  s_cbranch_scc0 LS2l_pw10
  s_mov_b32 s0, 0
LS2l_pw10_ok:
  s_add_u32 m0, s13, 0
  s_add_u32 s7, s12, 4096
  buffer_load_dwordx4 v23, s[56:59], s7 offen lds
  s_add_u32 m0, s13, 4096
  s_add_u32 s7, s12, 8192
  buffer_load_dwordx4 v23, s[56:59], s7 offen lds
  s_add_u32 m0, s13, 8192
  s_add_u32 s7, s12, 12288
  buffer_load_dwordx4 v23, s[56:59], s7 offen lds
  s_add_u32 m0, s13, 12288
  s_add_u32 s7, s12, 16384
  buffer_load_dwordx4 v23, s[56:59], s7 offen lds
  s_add_u32 m0, s13, 114688
  s_add_u32 s7, s12, 49152
  buffer_load_dwordx4 v23, s[56:59], s7 offen lds
  s_add_u32 m0, s13, 118784
  s_add_u32 s7, s12, 53248
  buffer_load_dwordx4 v23, s[56:59], s7 offen lds
  s_add_u32 m0, s13, 122880
  s_add_u32 s7, s12, 57344
  buffer_load_dwordx4 v23, s[56:59], s7 offen lds
  s_add_u32 m0, s13, 126976
  s_add_u32 s7, s12, 61440
  buffer_load_dwordx4 v23, s[56:59], s7 offen lds
  s_add_u32 m0, s13, 155648
  s_nop 0
  buffer_load_dwordx4 v23, s[56:59], s12 offen lds
  s_waitcnt vmcnt(0)
  s_lshl_b32 s7, s5, 2
  s_add_u32 s6, s15, 4
  s_add_u32 s7, s7, 161824
  v_mov_b32 v232, s6
  v_mov_b32 v233, s7
  s_mov_b64 exec, 1
  ds_write_b32 v233, v232
  s_mov_b64 exec, -1
  s_cmp_lg_u32 s24, 0
  s_cbranch_scc1 LS2l_st11
  s_and_b32 s6, s2, 7
  s_lshl_b32 s6, s6, 5
  s_lshr_b32 s7, s2, 3
  s_add_u32 s6, s6, s7
  s_lshl_b32 s6, s6, 2
  s_add_u32 s6, s6, s5
  s_lshr_b32 s7, s6, 7
  s_lshl_b32 s7, s7, 4
  s_add_u32 s6, s6, s7
  s_lshl_b32 s6, s6, 11
  s_add_u32 s6, s6, 58736640
  s_add_u32 s94, s38, s6
  s_addc_u32 s95, s39, 0
  s_load_dword s93, s[94:95], 0
  s_load_dword s93, s[94:95], 64
  s_load_dword s93, s[94:95], 128
  s_load_dword s93, s[94:95], 192
  s_load_dword s93, s[94:95], 256
  s_load_dword s93, s[94:95], 320
  s_load_dword s93, s[94:95], 384
  s_load_dword s93, s[94:95], 448
  s_load_dword s93, s[94:95], 512
  s_load_dword s93, s[94:95], 576
  s_load_dword s93, s[94:95], 640
  s_load_dword s93, s[94:95], 704
  s_load_dword s93, s[94:95], 768
  s_load_dword s93, s[94:95], 832
  s_load_dword s93, s[94:95], 896
  s_load_dword s93, s[94:95], 960
  s_load_dword s93, s[94:95], 1024
  s_load_dword s93, s[94:95], 1088
  s_load_dword s93, s[94:95], 1152
  s_load_dword s93, s[94:95], 1216
  s_load_dword s93, s[94:95], 1280
  s_load_dword s93, s[94:95], 1344
  s_load_dword s93, s[94:95], 1408
  s_load_dword s93, s[94:95], 1472
  s_load_dword s93, s[94:95], 1536
  s_load_dword s93, s[94:95], 1600
  s_load_dword s93, s[94:95], 1664
  s_load_dword s93, s[94:95], 1728
  s_load_dword s93, s[94:95], 1792
  s_load_dword s93, s[94:95], 1856
  s_load_dword s93, s[94:95], 1920
  s_load_dword s93, s[94:95], 1984
LS2l_st11:
LS2l_fin:
LS2l_skip:
  s_and_b32 s6, s2, 7
  s_lshr_b32 s7, s2, 3
  s_lshl_b32 s6, s6, 2
  s_and_b32 s8, s7, 3
  s_add_u32 s3, s6, s8
  s_lshr_b32 s4, s7, 2
  v_mov_b32 v234, 161808
  s_add_u32 s7, s15, 7
LS3l_pw14:
  ds_read_b128 v[226:229], v234
  s_waitcnt lgkmcnt(0)
  v_min_u32 v226, v226, v227
  v_min3_u32 v226, v226, v228, v229
  s_nop 0
  v_readfirstlane_b32 s6, v226
  s_cmp_ge_u32 s6, s7
  s_cbranch_scc1 LS3l_pw14_ok
  s_sleep 1
  s_sub_u32 s0, s0, 1
  s_cbranch_scc0 LS3l_pw14
  s_mov_b32 s0, 0
LS3l_pw14_ok:
  s_add_u32 m0, s13, 110592
  s_add_u32 s7, s11, 57600
  buffer_load_dwordx4 v21, s[56:59], s7 offen lds
  s_add_u32 m0, s13, 131072
  s_add_u32 s7, s11, 94720
  buffer_load_dwordx4 v21, s[56:59], s7 offen lds
  s_add_u32 m0, s13, 135168
  s_add_u32 s7, s11, 24576
  buffer_load_dwordx4 v21, s[56:59], s7 offen lds
  s_add_u32 m0, s13, 139264
  s_add_u32 s7, s11, 61696
  buffer_load_dwordx4 v21, s[56:59], s7 offen lds
  s_add_u32 m0, s13, 143360
  s_add_u32 s7, s11, 98816
  buffer_load_dwordx4 v21, s[56:59], s7 offen lds
  s_add_u32 m0, s13, 147456
  s_add_u32 s7, s11, 28672
  buffer_load_dwordx4 v21, s[56:59], s7 offen lds
  s_add_u32 m0, s13, 151552
  s_add_u32 s7, s11, 65792
  buffer_load_dwordx4 v21, s[56:59], s7 offen lds
  s_cmp_ge_u32 s5, 2
  s_cbranch_scc1 LS3l_nocs
  v_lshlrev_b32 v22, 4, v1
  s_mul_i32 s6, s5, 32768
  s_lshr_b32 s7, s2, 4
  s_mul_i32 s7, s7, 384
  s_add_u32 s6, s6, s7
  s_add_u32 s6, s6, 21508096
  s_add_u32 m0, s13, 159744
  s_nop 0
  buffer_load_dwordx4 v22, s[56:59], s6 offen lds
LS3l_nocs:
  v_mov_b32 v234, 161808
  s_add_u32 s7, s15, 8
LS3l_pw15:
  ds_read_b128 v[226:229], v234
  s_waitcnt lgkmcnt(0)
  v_min_u32 v226, v226, v227
  v_min3_u32 v226, v226, v228, v229
  s_nop 0
  v_readfirstlane_b32 s6, v226
  s_cmp_ge_u32 s6, s7
  s_cbranch_scc1 LS3l_pw15_ok
  s_sleep 1
  s_sub_u32 s0, s0, 1
  s_cbranch_scc0 LS3l_pw15
  s_mov_b32 s0, 0
LS3l_pw15_ok:
  s_add_u32 m0, s13, 45056
  s_nop 0
  buffer_load_dwordx4 v21, s[56:59], s11 offen lds
  s_add_u32 m0, s13, 49152
  s_add_u32 s7, s11, 37120
  buffer_load_dwordx4 v21, s[56:59], s7 offen lds
  s_add_u32 m0, s13, 53248
  s_add_u32 s7, s11, 74240
  buffer_load_dwordx4 v21, s[56:59], s7 offen lds
  s_add_u32 m0, s13, 57344
  s_add_u32 s7, s11, 4096
  buffer_load_dwordx4 v21, s[56:59], s7 offen lds
  s_add_u32 m0, s13, 61440
  s_add_u32 s7, s11, 41216
  buffer_load_dwordx4 v21, s[56:59], s7 offen lds
  s_add_u32 m0, s13, 65536
  s_add_u32 s7, s11, 78336
  buffer_load_dwordx4 v21, s[56:59], s7 offen lds
  s_add_u32 m0, s13, 69632
  s_add_u32 s7, s11, 8192
  buffer_load_dwordx4 v21, s[56:59], s7 offen lds
  s_add_u32 m0, s13, 73728
  s_add_u32 s7, s11, 45312
  buffer_load_dwordx4 v21, s[56:59], s7 offen lds
  s_add_u32 m0, s13, 77824
  s_add_u32 s7, s11, 82432
  buffer_load_dwordx4 v21, s[56:59], s7 offen lds
  s_cmp_lg_u32 s24, 0
  s_cbranch_scc1 LS3l_st16
  s_and_b32 s6, s2, 7
  s_lshl_b32 s6, s6, 5
  s_lshr_b32 s7, s2, 3
  s_add_u32 s6, s6, s7
  s_lshl_b32 s6, s6, 2
  s_add_u32 s6, s6, s5
  s_and_b32 s7, s6, 7
  s_lshr_b32 s6, s6, 3
  s_mul_i32 s6, s6, 62464
  s_mul_i32 s7, s7, 3456
  s_add_u32 s6, s6, s7
  s_add_u32 s6, s6, 50348032
  s_add_u32 s94, s38, s6
  s_addc_u32 s95, s39, 0
  s_load_dword s93, s[94:95], 0
  s_load_dword s93, s[94:95], 64
  s_load_dword s93, s[94:95], 128
  s_load_dword s93, s[94:95], 192
  s_load_dword s93, s[94:95], 256
  s_load_dword s93, s[94:95], 320
  s_load_dword s93, s[94:95], 384
  s_load_dword s93, s[94:95], 448
  s_load_dword s93, s[94:95], 512
  s_load_dword s93, s[94:95], 576
  s_load_dword s93, s[94:95], 640
  s_load_dword s93, s[94:95], 704
  s_load_dword s93, s[94:95], 768
  s_load_dword s93, s[94:95], 832
  s_load_dword s93, s[94:95], 896
  s_load_dword s93, s[94:95], 960
  s_load_dword s93, s[94:95], 1024
  s_load_dword s93, s[94:95], 1088
  s_load_dword s93, s[94:95], 1152
  s_load_dword s93, s[94:95], 1216
  s_load_dword s93, s[94:95], 1280
  s_load_dword s93, s[94:95], 1344
  s_load_dword s93, s[94:95], 1408
  s_load_dword s93, s[94:95], 1472
  s_load_dword s93, s[94:95], 1536
  s_load_dword s93, s[94:95], 1600
  s_load_dword s93, s[94:95], 1664
  s_load_dword s93, s[94:95], 1728
LS3l_st16:
LS3l_fin:
LS3l_skip:
  s_and_b32 s6, s2, 7
  s_lshr_b32 s7, s2, 3
  s_lshl_b32 s6, s6, 2
  s_and_b32 s8, s7, 3
  s_add_u32 s3, s6, s8
  s_lshr_b32 s4, s7, 2
  v_mov_b32 v234, 161808
  s_add_u32 s7, s15, 10
LS4l_pw19:
  ds_read_b128 v[226:229], v234
  s_waitcnt lgkmcnt(0)
  v_min_u32 v226, v226, v227
  v_min3_u32 v226, v226, v228, v229
  s_nop 0
  v_readfirstlane_b32 s6, v226
  s_cmp_ge_u32 s6, s7
  s_cbranch_scc1 LS4l_pw19_ok
  s_sleep 1
  s_sub_u32 s0, s0, 1
  s_cbranch_scc0 LS4l_pw19
  s_mov_b32 s0, 0
LS4l_pw19_ok:
  s_add_u32 m0, s13, 81920
  s_add_u32 s7, s11, 12288
  buffer_load_dwordx4 v21, s[56:59], s7 offen lds
  s_add_u32 m0, s13, 86016
  s_add_u32 s7, s11, 49408
  buffer_load_dwordx4 v21, s[56:59], s7 offen lds
  s_add_u32 m0, s13, 90112
  s_add_u32 s7, s11, 86528
  buffer_load_dwordx4 v21, s[56:59], s7 offen lds
  s_add_u32 m0, s13, 94208
  s_add_u32 s7, s11, 16384
  buffer_load_dwordx4 v21, s[56:59], s7 offen lds
  s_add_u32 m0, s13, 98304
  s_add_u32 s7, s11, 53504
  buffer_load_dwordx4 v21, s[56:59], s7 offen lds
  s_add_u32 m0, s13, 102400
  s_add_u32 s7, s11, 90624
  buffer_load_dwordx4 v21, s[56:59], s7 offen lds
  s_add_u32 m0, s13, 106496
  s_add_u32 s7, s11, 20480
  buffer_load_dwordx4 v21, s[56:59], s7 offen lds
  v_mov_b32 v234, 161808
  s_add_u32 s7, s15, 11
LS4l_pw20:
  ds_read_b128 v[226:229], v234
  s_waitcnt lgkmcnt(0)
  v_min_u32 v226, v226, v227
  v_min3_u32 v226, v226, v228, v229
  s_nop 0
  v_readfirstlane_b32 s6, v226
  s_cmp_ge_u32 s6, s7
  s_cbranch_scc1 LS4l_pw20_ok
  s_sleep 1
  s_sub_u32 s0, s0, 1
  s_cbranch_scc0 LS4l_pw20
  s_mov_b32 s0, 0
LS4l_pw20_ok:
  s_add_u32 m0, s13, 155648
  s_add_u32 s7, s11, 102912
  buffer_load_dwordx4 v21, s[56:59], s7 offen lds
  s_add_u32 m0, s13, 0
  s_nop 0
  buffer_load_dwordx4 v23, s[56:59], s14 offen lds
  s_add_u32 m0, s13, 4096
  s_add_u32 s7, s14, 4096
  buffer_load_dwordx4 v23, s[56:59], s7 offen lds
  s_add_u32 m0, s13, 8192
  s_add_u32 s7, s14, 8192
  buffer_load_dwordx4 v23, s[56:59], s7 offen lds
  s_add_u32 m0, s13, 12288
  s_add_u32 s7, s14, 12288
  buffer_load_dwordx4 v23, s[56:59], s7 offen lds
  s_waitcnt vmcnt(4)
  s_lshl_b32 s7, s5, 2
  s_add_u32 s6, s15, 5
  s_add_u32 s7, s7, 161824
  v_mov_b32 v232, s6
  v_mov_b32 v233, s7
  s_mov_b64 exec, 1
  ds_write_b32 v233, v232
  s_mov_b64 exec, -1
  s_cmp_lg_u32 s24, 0
  s_cbranch_scc1 LS4l_st21
  s_and_b32 s6, s2, 7
  s_lshl_b32 s6, s6, 5
  s_lshr_b32 s7, s2, 3
  s_add_u32 s6, s6, s7
  s_lshl_b32 s6, s6, 2
  s_add_u32 s6, s6, s5
  s_and_b32 s7, s6, 7
  s_lshr_b32 s6, s6, 3
  s_mul_i32 s6, s6, 62464
  s_mul_i32 s7, s7, 3456
  s_add_u32 s6, s6, s7
  s_add_u32 s6, s6, 50349824
  s_add_u32 s94, s38, s6
  s_addc_u32 s95, s39, 0
  s_load_dword s93, s[94:95], 0
  s_load_dword s93, s[94:95], 64
  s_load_dword s93, s[94:95], 128
  s_load_dword s93, s[94:95], 192
  s_load_dword s93, s[94:95], 256
  s_load_dword s93, s[94:95], 320
  s_load_dword s93, s[94:95], 384
  s_load_dword s93, s[94:95], 448
  s_load_dword s93, s[94:95], 512
  s_load_dword s93, s[94:95], 576
  s_load_dword s93, s[94:95], 640
  s_load_dword s93, s[94:95], 704
  s_load_dword s93, s[94:95], 768
  s_load_dword s93, s[94:95], 832
  s_load_dword s93, s[94:95], 896
  s_load_dword s93, s[94:95], 960
  s_load_dword s93, s[94:95], 1024
  s_load_dword s93, s[94:95], 1088
  s_load_dword s93, s[94:95], 1152
  s_load_dword s93, s[94:95], 1216
  s_load_dword s93, s[94:95], 1280
  s_load_dword s93, s[94:95], 1344
  s_load_dword s93, s[94:95], 1408
  s_load_dword s93, s[94:95], 1472
  s_load_dword s93, s[94:95], 1536
  s_load_dword s93, s[94:95], 1600
LS4l_st21:
LS4l_fin:
LS4l_skip:
  s_and_b32 s6, s2, 7
  s_lshr_b32 s7, s2, 3
  s_lshl_b32 s6, s6, 1
  s_and_b32 s8, s7, 1
  s_add_u32 s3, s6, s8
  s_lshr_b32 s4, s7, 1
  v_mov_b32 v234, 161808
  s_add_u32 s7, s15, 13
LS5l_pw24:
  ds_read_b128 v[226:229], v234
  s_waitcnt lgkmcnt(0)
  v_min_u32 v226, v226, v227
  v_min3_u32 v226, v226, v228, v229
  s_nop 0
  v_readfirstlane_b32 s6, v226
  s_cmp_ge_u32 s6, s7
  s_cbranch_scc1 LS5l_pw24_ok
  s_sleep 1
  s_sub_u32 s0, s0, 1
  s_cbranch_scc0 LS5l_pw24
  s_mov_b32 s0, 0
LS5l_pw24_ok:
  s_add_u32 m0, s13, 16384
  s_add_u32 s7, s14, 16384
  buffer_load_dwordx4 v23, s[56:59], s7 offen lds
  s_add_u32 m0, s13, 20480
  s_add_u32 s7, s14, 20480
  buffer_load_dwordx4 v23, s[56:59], s7 offen lds
  s_add_u32 m0, s13, 24576
  s_add_u32 s7, s14, 24576
  buffer_load_dwordx4 v23, s[56:59], s7 offen lds
  s_add_u32 m0, s13, 28672
  s_add_u32 s7, s14, 28672
  buffer_load_dwordx4 v23, s[56:59], s7 offen lds
  s_add_u32 m0, s13, 32768
  s_add_u32 s7, s14, 32768
  buffer_load_dwordx4 v23, s[56:59], s7 offen lds
  s_add_u32 m0, s13, 36864
  s_add_u32 s7, s14, 36864
  buffer_load_dwordx4 v23, s[56:59], s7 offen lds
  s_add_u32 m0, s13, 40960
  s_add_u32 s7, s14, 40960
  buffer_load_dwordx4 v23, s[56:59], s7 offen lds
  s_add_u32 m0, s13, 114688
  s_add_u32 s7, s14, 114688
  buffer_load_dwordx4 v23, s[56:59], s7 offen lds
  s_add_u32 m0, s13, 118784
  s_add_u32 s7, s14, 118784
  buffer_load_dwordx4 v23, s[56:59], s7 offen lds
  s_add_u32 m0, s13, 122880
  s_add_u32 s7, s14, 122880
  buffer_load_dwordx4 v23, s[56:59], s7 offen lds
  s_add_u32 m0, s13, 126976
  s_add_u32 s7, s14, 126976
  buffer_load_dwordx4 v23, s[56:59], s7 offen lds
  s_cmp_lg_u32 s24, 0
  s_cbranch_scc1 LS5l_nopq
LS5l_nopq:
  v_mov_b32 v234, 161808
  s_add_u32 s7, s15, 14
LS5l_pw25:
  ds_read_b128 v[226:229], v234
  s_waitcnt lgkmcnt(0)
  v_min_u32 v226, v226, v227
  v_min3_u32 v226, v226, v228, v229
  s_nop 0
  v_readfirstlane_b32 s6, v226
  s_cmp_ge_u32 s6, s7
  s_cbranch_scc1 LS5l_pw25_ok
  s_sleep 1
  s_sub_u32 s0, s0, 1
  s_cbranch_scc0 LS5l_pw25
  s_mov_b32 s0, 0
LS5l_pw25_ok:
  s_add_u32 m0, s13, 45056
  s_add_u32 s7, s14, 45056
  buffer_load_dwordx4 v23, s[56:59], s7 offen lds
  s_add_u32 m0, s13, 49152
  s_add_u32 s7, s14, 49152
  buffer_load_dwordx4 v23, s[56:59], s7 offen lds
  s_add_u32 m0, s13, 53248
  s_add_u32 s7, s14, 53248
  buffer_load_dwordx4 v23, s[56:59], s7 offen lds
  s_add_u32 m0, s13, 57344
  s_add_u32 s7, s14, 57344
  buffer_load_dwordx4 v23, s[56:59], s7 offen lds
  s_add_u32 m0, s13, 61440
  s_add_u32 s7, s14, 61440
  buffer_load_dwordx4 v23, s[56:59], s7 offen lds
  s_add_u32 m0, s13, 65536
  s_add_u32 s7, s14, 65536
  buffer_load_dwordx4 v23, s[56:59], s7 offen lds
  v_mov_b32 v234, 161808
  s_add_u32 s7, s15, 15
LS5l_pw26:
  ds_read_b128 v[226:229], v234
  s_waitcnt lgkmcnt(0)
  v_min_u32 v226, v226, v227
  v_min3_u32 v226, v226, v228, v229
  s_nop 0
  v_readfirstlane_b32 s6, v226
  s_cmp_ge_u32 s6, s7
  s_cbranch_scc1 LS5l_pw26_ok
  s_sleep 1
  s_sub_u32 s0, s0, 1
  s_cbranch_scc0 LS5l_pw26
  s_mov_b32 s0, 0
LS5l_pw26_ok:
  s_add_u32 m0, s13, 69632
  s_add_u32 s7, s14, 69632
  buffer_load_dwordx4 v23, s[56:59], s7 offen lds
  s_add_u32 m0, s13, 73728
  s_add_u32 s7, s14, 73728
  buffer_load_dwordx4 v23, s[56:59], s7 offen lds
  s_add_u32 m0, s13, 77824
  s_add_u32 s7, s14, 77824
  buffer_load_dwordx4 v23, s[56:59], s7 offen lds
  s_add_u32 m0, s13, 81920
  s_add_u32 s7, s14, 81920
  buffer_load_dwordx4 v23, s[56:59], s7 offen lds
  s_add_u32 m0, s13, 86016
  s_add_u32 s7, s14, 86016
  buffer_load_dwordx4 v23, s[56:59], s7 offen lds
  s_add_u32 m0, s13, 90112
  s_add_u32 s7, s14, 90112
  buffer_load_dwordx4 v23, s[56:59], s7 offen lds
  v_mov_b32 v234, 161808
  s_add_u32 s7, s15, 16
LS5l_pw27:
  ds_read_b128 v[226:229], v234
  s_waitcnt lgkmcnt(0)
  v_min_u32 v226, v226, v227
  v_min3_u32 v226, v226, v228, v229
  s_nop 0
  v_readfirstlane_b32 s6, v226
  s_cmp_ge_u32 s6, s7
  s_cbranch_scc1 LS5l_pw27_ok
  s_sleep 1
  s_sub_u32 s0, s0, 1
  s_cbranch_scc0 LS5l_pw27
  s_mov_b32 s0, 0
LS5l_pw27_ok:
  s_add_u32 m0, s13, 94208
  s_add_u32 s7, s14, 94208
  buffer_load_dwordx4 v23, s[56:59], s7 offen lds
  s_add_u32 m0, s13, 98304
  s_add_u32 s7, s14, 98304
  buffer_load_dwordx4 v23, s[56:59], s7 offen lds
  s_add_u32 m0, s13, 102400
  s_add_u32 s7, s14, 102400
  buffer_load_dwordx4 v23, s[56:59], s7 offen lds
  s_add_u32 m0, s13, 106496
  s_add_u32 s7, s14, 106496
  buffer_load_dwordx4 v23, s[56:59], s7 offen lds
  s_add_u32 m0, s13, 110592
  s_add_u32 s7, s14, 110592
  buffer_load_dwordx4 v23, s[56:59], s7 offen lds
  s_add_u32 m0, s13, 131072
  s_add_u32 s7, s14, 131072
  buffer_load_dwordx4 v23, s[56:59], s7 offen lds
  v_mov_b32 v234, 161808
  s_add_u32 s7, s15, 17
LS5l_pw28:
  ds_read_b128 v[226:229], v234
  s_waitcnt lgkmcnt(0)
  v_min_u32 v226, v226, v227
  v_min3_u32 v226, v226, v228, v229
  s_nop 0
  v_readfirstlane_b32 s6, v226
  s_cmp_ge_u32 s6, s7
  s_cbranch_scc1 LS5l_pw28_ok
  s_sleep 1
  s_sub_u32 s0, s0, 1
  s_cbranch_scc0 LS5l_pw28
  s_mov_b32 s0, 0
LS5l_pw28_ok:
  s_add_u32 m0, s13, 135168
  s_add_u32 s7, s14, 135168
  buffer_load_dwordx4 v23, s[56:59], s7 offen lds
  s_add_u32 m0, s13, 139264
  s_add_u32 s7, s14, 139264
  buffer_load_dwordx4 v23, s[56:59], s7 offen lds
  s_add_u32 m0, s13, 143360
  s_add_u32 s7, s14, 143360
  buffer_load_dwordx4 v23, s[56:59], s7 offen lds
  s_add_u32 m0, s13, 147456
  s_add_u32 s7, s14, 147456
  buffer_load_dwordx4 v23, s[56:59], s7 offen lds
  s_add_u32 m0, s13, 151552
  s_add_u32 s7, s14, 151552
  buffer_load_dwordx4 v23, s[56:59], s7 offen lds
  s_add_u32 m0, s13, 155648
  s_add_u32 s7, s14, 155648
  buffer_load_dwordx4 v23, s[56:59], s7 offen lds
  s_waitcnt vmcnt(6)
  s_lshl_b32 s7, s5, 2
  s_add_u32 s6, s15, 6
  s_add_u32 s7, s7, 161824
  v_mov_b32 v232, s6
  v_mov_b32 v233, s7
  s_mov_b64 exec, 1
  ds_write_b32 v233, v232
  s_mov_b64 exec, -1
  s_waitcnt vmcnt(0)
  s_lshl_b32 s7, s5, 2
  s_add_u32 s6, s15, 7
  s_add_u32 s7, s7, 161824
  v_mov_b32 v232, s6
  v_mov_b32 v233, s7
  s_mov_b64 exec, 1
  ds_write_b32 v233, v232
  s_mov_b64 exec, -1
LS5l_fin:
LS5l_skip:
  s_and_b32 s6, s2, 7
  s_lshr_b32 s7, s2, 3
  s_lshl_b32 s6, s6, 2
  s_and_b32 s8, s7, 3
  s_add_u32 s3, s6, s8
  s_lshr_b32 s4, s7, 2
  v_mov_b32 v234, 161808
  s_add_u32 s7, s15, 19
LS6l_pw32:
  ds_read_b128 v[226:229], v234
  s_waitcnt lgkmcnt(0)
  v_min_u32 v226, v226, v227
  v_min3_u32 v226, v226, v228, v229
  s_nop 0
  v_readfirstlane_b32 s6, v226
  s_cmp_ge_u32 s6, s7
  s_cbranch_scc1 LS6l_pw32_ok
  s_sleep 1
  s_sub_u32 s0, s0, 1
  s_cbranch_scc0 LS6l_pw32
  s_mov_b32 s0, 0
LS6l_pw32_ok:
  s_add_u32 m0, s13, 0
  s_add_u32 s7, s14, 159744
  buffer_load_dwordx4 v23, s[56:59], s7 offen lds
  s_add_u32 m0, s13, 4096
  s_add_u32 s7, s14, 163840
  buffer_load_dwordx4 v23, s[56:59], s7 offen lds
  s_add_u32 m0, s13, 8192
  s_add_u32 s7, s14, 167936
  buffer_load_dwordx4 v23, s[56:59], s7 offen lds
  s_add_u32 m0, s13, 12288
  s_add_u32 s7, s14, 172032
  buffer_load_dwordx4 v23, s[56:59], s7 offen lds
  s_waitcnt vmcnt(0)
  s_lshl_b32 s7, s5, 2
  s_add_u32 s6, s15, 8
  s_add_u32 s7, s7, 161824
  v_mov_b32 v232, s6
  v_mov_b32 v233, s7
  s_mov_b64 exec, 1
  ds_write_b32 v233, v232
  s_mov_b64 exec, -1
  s_cmp_lg_u32 s24, 0
  s_cbranch_scc1 LS6l_fin
  v_mov_b32 v234, 161808
  s_add_u32 s7, s15, 20
LS6l_pw33:
  ds_read_b128 v[226:229], v234
  s_waitcnt lgkmcnt(0)
  v_min_u32 v226, v226, v227
  v_min3_u32 v226, v226, v228, v229
  s_nop 0
  v_readfirstlane_b32 s6, v226
  s_cmp_ge_u32 s6, s7
  s_cbranch_scc1 LS6l_pw33_ok
  s_sleep 1
  s_sub_u32 s0, s0, 1
  s_cbranch_scc0 LS6l_pw33
  s_mov_b32 s0, 0
LS6l_pw33_ok:
  s_add_u32 m0, s13, 16384
  s_nop 0
  buffer_load_dwordx4 v21, s[56:59], s51 offen lds
  s_add_u32 m0, s13, 20480
  s_add_u32 s7, s51, 593920
  buffer_load_dwordx4 v21, s[56:59], s7 offen lds
  s_add_u32 m0, s13, 24576
  s_add_u32 s7, s51, 1187840
  buffer_load_dwordx4 v21, s[56:59], s7 offen lds
  s_add_u32 m0, s13, 28672
  s_add_u32 s7, s51, 4096
  buffer_load_dwordx4 v21, s[56:59], s7 offen lds
  s_add_u32 m0, s13, 32768
  s_add_u32 s7, s51, 598016
  buffer_load_dwordx4 v21, s[56:59], s7 offen lds
  s_add_u32 m0, s13, 36864
  s_add_u32 s7, s51, 1191936
  buffer_load_dwordx4 v21, s[56:59], s7 offen lds
  s_add_u32 m0, s13, 40960
  s_add_u32 s7, s51, 8192
  buffer_load_dwordx4 v21, s[56:59], s7 offen lds
  s_add_u32 m0, s13, 45056
  s_add_u32 s7, s51, 602112
  buffer_load_dwordx4 v21, s[56:59], s7 offen lds
  v_mov_b32 v234, 161808
  s_add_u32 s7, s15, 21
LS6l_pw34:
  ds_read_b128 v[226:229], v234
  s_waitcnt lgkmcnt(0)
  v_min_u32 v226, v226, v227
  v_min3_u32 v226, v226, v228, v229
  s_nop 0
  v_readfirstlane_b32 s6, v226
  s_cmp_ge_u32 s6, s7
  s_cbranch_scc1 LS6l_pw34_ok
  s_sleep 1
  s_sub_u32 s0, s0, 1
  s_cbranch_scc0 LS6l_pw34
  s_mov_b32 s0, 0
LS6l_pw34_ok:
  s_add_u32 m0, s13, 49152
  s_add_u32 s7, s51, 1196032
  buffer_load_dwordx4 v21, s[56:59], s7 offen lds
  s_add_u32 m0, s13, 53248
  s_add_u32 s7, s51, 12288
  buffer_load_dwordx4 v21, s[56:59], s7 offen lds
  s_add_u32 m0, s13, 57344
  s_add_u32 s7, s51, 606208
  buffer_load_dwordx4 v21, s[56:59], s7 offen lds
  s_add_u32 m0, s13, 61440
  s_add_u32 s7, s51, 1200128
  buffer_load_dwordx4 v21, s[56:59], s7 offen lds
  s_add_u32 m0, s13, 65536
  s_add_u32 s7, s51, 16384
  buffer_load_dwordx4 v21, s[56:59], s7 offen lds
  s_add_u32 m0, s13, 69632
  s_add_u32 s7, s51, 610304
  buffer_load_dwordx4 v21, s[56:59], s7 offen lds
  s_add_u32 m0, s13, 73728
  s_add_u32 s7, s51, 1204224
  buffer_load_dwordx4 v21, s[56:59], s7 offen lds
  s_add_u32 m0, s13, 77824
  s_add_u32 s7, s51, 20480
  buffer_load_dwordx4 v21, s[56:59], s7 offen lds
  v_mov_b32 v234, 161808
  s_add_u32 s7, s15, 22
LS6l_pw35:
  ds_read_b128 v[226:229], v234
  s_waitcnt lgkmcnt(0)
  v_min_u32 v226, v226, v227
  v_min3_u32 v226, v226, v228, v229
  s_nop 0
  v_readfirstlane_b32 s6, v226
  s_cmp_ge_u32 s6, s7
  s_cbranch_scc1 LS6l_pw35_ok
  s_sleep 1
  s_sub_u32 s0, s0, 1
  s_cbranch_scc0 LS6l_pw35
  s_mov_b32 s0, 0
LS6l_pw35_ok:
  s_add_u32 m0, s13, 81920
  s_add_u32 s7, s51, 614400
  buffer_load_dwordx4 v21, s[56:59], s7 offen lds
  s_add_u32 m0, s13, 86016
  s_add_u32 s7, s51, 1208320
  buffer_load_dwordx4 v21, s[56:59], s7 offen lds
  s_add_u32 m0, s13, 90112
  s_add_u32 s7, s51, 24576
  buffer_load_dwordx4 v21, s[56:59], s7 offen lds
  s_add_u32 m0, s13, 94208
  s_add_u32 s7, s51, 618496
  buffer_load_dwordx4 v21, s[56:59], s7 offen lds
  s_add_u32 m0, s13, 98304
  s_add_u32 s7, s51, 1212416
  buffer_load_dwordx4 v21, s[56:59], s7 offen lds
  s_add_u32 m0, s13, 102400
  s_add_u32 s7, s51, 28672
  buffer_load_dwordx4 v21, s[56:59], s7 offen lds
  s_add_u32 m0, s13, 106496
  s_add_u32 s7, s51, 622592
  buffer_load_dwordx4 v21, s[56:59], s7 offen lds
  s_add_u32 m0, s13, 110592
  s_add_u32 s7, s51, 1216512
  buffer_load_dwordx4 v21, s[56:59], s7 offen lds
  s_mov_b32 s52, s20
  s_mov_b32 s53, s21
  s_mov_b32 s54, 16384
  s_mov_b32 s55, 0x00020000
  s_cmp_ge_u32 s5, 2
  s_cbranch_scc1 LS6l_nosm
  s_lshr_b32 s8, s2, 4
  s_cmp_eq_u32 s5, 0
  s_cbranch_scc0 LS6l_sm1
  v_lshlrev_b32 v22, 4, v1
  s_lshl_b32 s6, s8, 10
  s_mov_b32 m0, 160768
  s_nop 0
  buffer_load_dwordx4 v22, s[52:55], s6 offen lds
  s_branch LS6l_nosm
LS6l_sm1:
  v_lshrrev_b32 v24, 3, v1
  v_min_u32 v24, 2, v24
  v_and_b32 v22, 7, v1
  v_lshlrev_b32 v22, 4, v22
  v_lshl_add_u32 v22, v24, 11, v22
  s_lshl_b32 s6, s8, 7
  s_add_u32 s6, s6, 21495808
  s_mov_b32 m0, 159744
  s_nop 0
  buffer_load_dwordx4 v22, s[56:59], s6 offen lds
LS6l_nosm:
  s_waitcnt vmcnt(0)
  s_lshl_b32 s7, s5, 2
  s_add_u32 s6, s15, 65
  s_add_u32 s7, s7, 161824
  v_mov_b32 v232, s6
  v_mov_b32 v233, s7
  s_mov_b64 exec, 1
  ds_write_b32 v233, v232
  s_mov_b64 exec, -1
LS6l_fin:
LS6l_skip:
  s_cmp_lg_u32 s24, 0
  s_cbranch_scc1 LX_end
  s_mov_b32 s24, 1
  s_mov_b32 s25, 6
  s_mov_b32 s15, 64
  s_and_b32 s6, s2, 7
  s_lshr_b32 s7, s2, 3
  s_lshl_b32 s6, s6, 1
  s_and_b32 s8, s7, 1
  s_add_u32 s3, s6, s8
  s_lshr_b32 s4, s7, 1
  s_mul_i32 s50, s4, 36864
  s_add_u32 s50, s50, 30998528
  v_mov_b32 v234, 161808
  s_add_u32 s7, s15, 1
LS1bl_pw39:
  ds_read_b128 v[226:229], v234
  s_waitcnt lgkmcnt(0)
  v_min_u32 v226, v226, v227
  v_min3_u32 v226, v226, v228, v229
  s_nop 0
  v_readfirstlane_b32 s6, v226
  s_cmp_ge_u32 s6, s7
  s_cbranch_scc1 LS1bl_pw39_ok
  s_sleep 1
  s_sub_u32 s0, s0, 1
  s_cbranch_scc0 LS1bl_pw39
  s_mov_b32 s0, 0
LS1bl_pw39_ok:
  s_add_u32 m0, s13, 0
  s_nop 0
  buffer_load_dwordx4 v20, s[44:47], s10 offen lds
  s_add_u32 m0, s13, 4096
  s_add_u32 s7, s10, 32768
  buffer_load_dwordx4 v20, s[44:47], s7 offen lds
  s_add_u32 m0, s13, 8192
  s_add_u32 s7, s10, 65536
  buffer_load_dwordx4 v20, s[44:47], s7 offen lds
  s_add_u32 m0, s13, 12288
  s_add_u32 s7, s10, 98304
  buffer_load_dwordx4 v20, s[44:47], s7 offen lds
  s_add_u32 m0, s13, 114688
  s_add_u32 s7, s10, 131072
  buffer_load_dwordx4 v20, s[44:47], s7 offen lds
  s_add_u32 m0, s13, 118784
  s_add_u32 s7, s10, 163840
  buffer_load_dwordx4 v20, s[44:47], s7 offen lds
  s_add_u32 m0, s13, 122880
  s_add_u32 s7, s10, 196608
  buffer_load_dwordx4 v20, s[44:47], s7 offen lds
  s_add_u32 m0, s13, 126976
  s_add_u32 s7, s10, 229376
  buffer_load_dwordx4 v20, s[44:47], s7 offen lds
  s_add_u32 m0, s13, 155648
  s_add_u32 s7, s10, 262144
  buffer_load_dwordx4 v20, s[44:47], s7 offen lds
  s_add_u32 m0, s13, 131072
  s_add_u32 s7, s10, 294912
  buffer_load_dwordx4 v20, s[44:47], s7 offen lds
  s_add_u32 m0, s13, 135168
  s_add_u32 s7, s10, 327680
  buffer_load_dwordx4 v20, s[44:47], s7 offen lds
  s_add_u32 m0, s13, 139264
  s_add_u32 s7, s10, 360448
  buffer_load_dwordx4 v20, s[44:47], s7 offen lds
  s_add_u32 m0, s13, 143360
  s_add_u32 s7, s10, 393216
  buffer_load_dwordx4 v20, s[44:47], s7 offen lds
  s_add_u32 m0, s13, 147456
  s_add_u32 s7, s10, 425984
  buffer_load_dwordx4 v20, s[44:47], s7 offen lds
  s_add_u32 m0, s13, 151552
  s_add_u32 s7, s10, 458752
  buffer_load_dwordx4 v20, s[44:47], s7 offen lds
  v_mov_b32 v234, 161808
  s_add_u32 s7, s15, 2
LS1bl_pw40:
  ds_read_b128 v[226:229], v234
  s_waitcnt lgkmcnt(0)
  v_min_u32 v226, v226, v227
  v_min3_u32 v226, v226, v228, v229
  s_nop 0
  v_readfirstlane_b32 s6, v226
  s_cmp_ge_u32 s6, s7
  s_cbranch_scc1 LS1bl_pw40_ok
  s_sleep 1
  s_sub_u32 s0, s0, 1
  s_cbranch_scc0 LS1bl_pw40
  s_mov_b32 s0, 0
LS1bl_pw40_ok:
  s_add_u32 m0, s13, 110592
  s_add_u32 s7, s10, 491520
  buffer_load_dwordx4 v20, s[44:47], s7 offen lds
  s_add_u32 m0, s13, 45056
  s_nop 0
  buffer_load_dwordx4 v20, s[40:43], s10 offen lds
  s_add_u32 m0, s13, 49152
  s_add_u32 s7, s10, 32768
  buffer_load_dwordx4 v20, s[40:43], s7 offen lds
  s_add_u32 m0, s13, 53248
  s_add_u32 s7, s10, 65536
  buffer_load_dwordx4 v20, s[40:43], s7 offen lds
  s_add_u32 m0, s13, 57344
  s_add_u32 s7, s10, 98304
  buffer_load_dwordx4 v20, s[40:43], s7 offen lds
  s_add_u32 m0, s13, 61440
  s_add_u32 s7, s10, 131072
  buffer_load_dwordx4 v20, s[40:43], s7 offen lds
  s_add_u32 m0, s13, 65536
  s_add_u32 s7, s10, 163840
  buffer_load_dwordx4 v20, s[40:43], s7 offen lds
  s_add_u32 m0, s13, 69632
  s_add_u32 s7, s10, 196608
  buffer_load_dwordx4 v20, s[40:43], s7 offen lds
  s_add_u32 m0, s13, 73728
  s_add_u32 s7, s10, 229376
  buffer_load_dwordx4 v20, s[40:43], s7 offen lds
  s_add_u32 m0, s13, 77824
  s_add_u32 s7, s10, 262144
  buffer_load_dwordx4 v20, s[40:43], s7 offen lds
  s_add_u32 m0, s13, 81920
  s_add_u32 s7, s10, 294912
  buffer_load_dwordx4 v20, s[40:43], s7 offen lds
  s_add_u32 m0, s13, 86016
  s_add_u32 s7, s10, 327680
  buffer_load_dwordx4 v20, s[40:43], s7 offen lds
  s_add_u32 m0, s13, 90112
  s_add_u32 s7, s10, 360448
  buffer_load_dwordx4 v20, s[40:43], s7 offen lds
  s_add_u32 m0, s13, 94208
  s_add_u32 s7, s10, 393216
  buffer_load_dwordx4 v20, s[40:43], s7 offen lds
  s_add_u32 m0, s13, 98304
  s_add_u32 s7, s10, 425984
  buffer_load_dwordx4 v20, s[40:43], s7 offen lds
  s_add_u32 m0, s13, 102400
  s_add_u32 s7, s10, 458752
  buffer_load_dwordx4 v20, s[40:43], s7 offen lds
  s_add_u32 m0, s13, 106496
  s_add_u32 s7, s10, 491520
  buffer_load_dwordx4 v20, s[40:43], s7 offen lds
  s_cmp_ge_u32 s5, 2
  s_cbranch_scc1 LS1bl_nocs
  v_lshlrev_b32 v22, 4, v1
  s_mul_i32 s6, s5, 32768
  s_lshr_b32 s7, s2, 5
  s_lshl_b32 s7, s7, 8
  s_add_u32 s6, s6, s7
  s_add_u32 s6, s6, 21504000
  s_add_u32 m0, s13, 159744
  s_nop 0
  buffer_load_dwordx4 v22, s[56:59], s6 offen lds
LS1bl_nocs:
  s_add_u32 m0, s13, 16384
  s_add_u32 s7, s12, 20480
  buffer_load_dwordx4 v23, s[56:59], s7 offen lds
  s_add_u32 m0, s13, 20480
  s_add_u32 s7, s12, 24576
  buffer_load_dwordx4 v23, s[56:59], s7 offen lds
  s_lshl_b32 s6, s5, 9
  v_lshlrev_b32 v26, 3, v1
  v_add_u32 v26, s6, v26
  v_mul_u32_u24 v27, 2304, v2
  v_lshl_add_u32 v27, v3, 4, v27
  s_lshl_b32 s6, s5, 6
  s_add_u32 s6, s6, 2048
  v_add_u32 v27, s6, v27
  s_lshr_b32 s6, s5, 1
  s_and_b32 s7, s5, 1
  s_lshl_b32 s7, s7, 3
  s_lshl_b32 s8, s6, 10
  s_add_u32 s8, s8, s7
  s_add_u32 s8, s8, 41984
  s_lshl_b32 s9, s6, 6
  s_add_u32 s9, s9, s7
  s_add_u32 s9, s9, 44032
  v_lshlrev_b32 v28, 6, v2
  v_lshl_add_u32 v28, v3, 4, v28
  v_add_u32 v28, s8, v28
  v_lshlrev_b32 v29, 4, v3
  v_add_u32 v29, s9, v29
  v_mov_b32 v30, 161792
  v_mov_b32 v32, 0x3f80
  v_mov_b32 v33, 0x3f800000
  v_mov_b32 v132, 0
  v_mov_b32 v133, 0
  v_mov_b32 v134, 0
  v_mov_b32 v135, 0
  s_mov_b32 s8, 0x1ffff
LS1bl_gw:
  ds_read_b32 v31, v30 offset:4
  s_waitcnt lgkmcnt(0)
  v_readfirstlane_b32 s6, v31
  s_cmp_ge_u32 s6, 8
  s_cbranch_scc1 LS1bl_gw_ok
  s_sleep 1
  s_branch LS1bl_gw
LS1bl_gw_ok:
  v_mov_b32 v234, 161808
  s_add_u32 s7, s15, 3
LS1bl_pw41:
  ds_read_b128 v[226:229], v234
  s_waitcnt lgkmcnt(0)
  v_min_u32 v226, v226, v227
  v_min3_u32 v226, v226, v228, v229
  s_nop 0
  v_readfirstlane_b32 s6, v226
  s_cmp_ge_u32 s6, s7
  s_cbranch_scc1 LS1bl_pw41_ok
  s_sleep 1
  s_sub_u32 s0, s0, 1
  s_cbranch_scc0 LS1bl_pw41
  s_mov_b32 s0, 0
LS1bl_pw41_ok:
  s_add_u32 m0, s13, 24576
  s_add_u32 s7, s12, 28672
  buffer_load_dwordx4 v23, s[56:59], s7 offen lds
  s_add_u32 m0, s13, 28672
  s_add_u32 s7, s12, 32768
  buffer_load_dwordx4 v23, s[56:59], s7 offen lds
  s_add_u32 m0, s13, 32768
  s_add_u32 s7, s12, 36864
  buffer_load_dwordx4 v23, s[56:59], s7 offen lds
  s_add_u32 m0, s13, 36864
  s_add_u32 s7, s12, 40960
  buffer_load_dwordx4 v23, s[56:59], s7 offen lds
  buffer_load_dwordx4 v[128:131], v27, s[56:59], s50 offen sc1
  s_add_u32 s7, s50, 0
  buffer_load_dwordx2 v[64:65], v26, s[56:59], s7 offen sc1
  s_add_u32 s7, s50, 2304
  buffer_load_dwordx2 v[66:67], v26, s[56:59], s7 offen sc1
  s_add_u32 s7, s50, 4608
  buffer_load_dwordx2 v[68:69], v26, s[56:59], s7 offen sc1
  s_add_u32 s7, s50, 6912
  buffer_load_dwordx2 v[70:71], v26, s[56:59], s7 offen sc1
  s_add_u32 s7, s50, 9216
  buffer_load_dwordx2 v[72:73], v26, s[56:59], s7 offen sc1
  s_add_u32 s7, s50, 11520
  buffer_load_dwordx2 v[74:75], v26, s[56:59], s7 offen sc1
  s_add_u32 s7, s50, 13824
  buffer_load_dwordx2 v[76:77], v26, s[56:59], s7 offen sc1
  s_add_u32 s7, s50, 16128
  buffer_load_dwordx2 v[78:79], v26, s[56:59], s7 offen sc1
  s_add_u32 s7, s50, 18432
  buffer_load_dwordx2 v[80:81], v26, s[56:59], s7 offen sc1
  s_add_u32 s7, s50, 20736
  buffer_load_dwordx2 v[82:83], v26, s[56:59], s7 offen sc1
  s_add_u32 s7, s50, 23040
  buffer_load_dwordx2 v[84:85], v26, s[56:59], s7 offen sc1
  s_add_u32 s7, s50, 25344
  buffer_load_dwordx2 v[86:87], v26, s[56:59], s7 offen sc1
  s_add_u32 s7, s50, 27648
  buffer_load_dwordx2 v[88:89], v26, s[56:59], s7 offen sc1
  s_add_u32 s7, s50, 29952
  buffer_load_dwordx2 v[90:91], v26, s[56:59], s7 offen sc1
  s_add_u32 s7, s50, 32256
  buffer_load_dwordx2 v[92:93], v26, s[56:59], s7 offen sc1
  s_add_u32 s7, s50, 34560
  buffer_load_dwordx2 v[94:95], v26, s[56:59], s7 offen sc1
  s_waitcnt vmcnt(16)
  v_max3_u32 v31, v128, v129, v130
  v_max_u32 v31, v31, v131
  v_cmp_eq_u32 vcc, -1, v31
  s_cbranch_vccnz LS1bl_gar16
  v_add_f32_dpp v128, v128, v128 row_ror:8 row_mask:0xf bank_mask:0xf
  v_add_f32_dpp v129, v129, v129 row_ror:8 row_mask:0xf bank_mask:0xf
  v_add_f32_dpp v130, v130, v130 row_ror:8 row_mask:0xf bank_mask:0xf
  v_add_f32_dpp v131, v131, v131 row_ror:8 row_mask:0xf bank_mask:0xf
  v_add_f32_dpp v128, v128, v128 row_ror:4 row_mask:0xf bank_mask:0xf
  v_add_f32_dpp v129, v129, v129 row_ror:4 row_mask:0xf bank_mask:0xf
  v_add_f32_dpp v130, v130, v130 row_ror:4 row_mask:0xf bank_mask:0xf
  v_add_f32_dpp v131, v131, v131 row_ror:4 row_mask:0xf bank_mask:0xf
  v_add_f32_dpp v128, v128, v128 row_ror:2 row_mask:0xf bank_mask:0xf
  v_add_f32_dpp v129, v129, v129 row_ror:2 row_mask:0xf bank_mask:0xf
  v_add_f32_dpp v130, v130, v130 row_ror:2 row_mask:0xf bank_mask:0xf
  v_add_f32_dpp v131, v131, v131 row_ror:2 row_mask:0xf bank_mask:0xf
  v_add_f32_dpp v128, v128, v128 row_ror:1 row_mask:0xf bank_mask:0xf
  v_add_f32_dpp v129, v129, v129 row_ror:1 row_mask:0xf bank_mask:0xf
  v_add_f32_dpp v130, v130, v130 row_ror:1 row_mask:0xf bank_mask:0xf
  v_add_f32_dpp v131, v131, v131 row_ror:1 row_mask:0xf bank_mask:0xf
  v_cvt_pk_bf16_f32 v142, v128, v129
  v_cvt_pk_bf16_f32 v143, v130, v131
  s_bitset0_b32 s8, 16
LS1bl_gan16:
  s_waitcnt vmcnt(15)
  v_max_u32 v31, v64, v65
  v_cmp_eq_u32 vcc, -1, v31
  s_cbranch_vccnz LS1bl_gar0
  v_dot2_f32_bf16 v132, v64, v32, v132
  v_dot2_f32_bf16 v133, v64, v33, v133
  v_dot2_f32_bf16 v134, v65, v32, v134
  v_dot2_f32_bf16 v135, v65, v33, v135
  s_bitset0_b32 s8, 0
LS1bl_gan0:
  s_waitcnt vmcnt(14)
  v_max_u32 v31, v66, v67
  v_cmp_eq_u32 vcc, -1, v31
  s_cbranch_vccnz LS1bl_gar1
  v_dot2_f32_bf16 v132, v66, v32, v132
  v_dot2_f32_bf16 v133, v66, v33, v133
  v_dot2_f32_bf16 v134, v67, v32, v134
  v_dot2_f32_bf16 v135, v67, v33, v135
  s_bitset0_b32 s8, 1
LS1bl_gan1:
  s_waitcnt vmcnt(13)
  v_max_u32 v31, v68, v69
  v_cmp_eq_u32 vcc, -1, v31
  s_cbranch_vccnz LS1bl_gar2
  v_dot2_f32_bf16 v132, v68, v32, v132
  v_dot2_f32_bf16 v133, v68, v33, v133
  v_dot2_f32_bf16 v134, v69, v32, v134
  v_dot2_f32_bf16 v135, v69, v33, v135
  s_bitset0_b32 s8, 2
LS1bl_gan2:
  s_waitcnt vmcnt(12)
  v_max_u32 v31, v70, v71
  v_cmp_eq_u32 vcc, -1, v31
  s_cbranch_vccnz LS1bl_gar3
  v_dot2_f32_bf16 v132, v70, v32, v132
  v_dot2_f32_bf16 v133, v70, v33, v133
  v_dot2_f32_bf16 v134, v71, v32, v134
  v_dot2_f32_bf16 v135, v71, v33, v135
  s_bitset0_b32 s8, 3
LS1bl_gan3:
  s_waitcnt vmcnt(11)
  v_max_u32 v31, v72, v73
  v_cmp_eq_u32 vcc, -1, v31
  s_cbranch_vccnz LS1bl_gar4
  v_dot2_f32_bf16 v132, v72, v32, v132
  v_dot2_f32_bf16 v133, v72, v33, v133
  v_dot2_f32_bf16 v134, v73, v32, v134
  v_dot2_f32_bf16 v135, v73, v33, v135
  s_bitset0_b32 s8, 4
LS1bl_gan4:
  s_waitcnt vmcnt(10)
  v_max_u32 v31, v74, v75
  v_cmp_eq_u32 vcc, -1, v31
  s_cbranch_vccnz LS1bl_gar5
  v_dot2_f32_bf16 v132, v74, v32, v132
  v_dot2_f32_bf16 v133, v74, v33, v133
  v_dot2_f32_bf16 v134, v75, v32, v134
  v_dot2_f32_bf16 v135, v75, v33, v135
  s_bitset0_b32 s8, 5
LS1bl_gan5:
  s_waitcnt vmcnt(9)
  v_max_u32 v31, v76, v77
  v_cmp_eq_u32 vcc, -1, v31
  s_cbranch_vccnz LS1bl_gar6
  v_dot2_f32_bf16 v132, v76, v32, v132
  v_dot2_f32_bf16 v133, v76, v33, v133
  v_dot2_f32_bf16 v134, v77, v32, v134
  v_dot2_f32_bf16 v135, v77, v33, v135
  s_bitset0_b32 s8, 6
LS1bl_gan6:
  s_waitcnt vmcnt(8)
  v_max_u32 v31, v78, v79
  v_cmp_eq_u32 vcc, -1, v31
  s_cbranch_vccnz LS1bl_gar7
  v_dot2_f32_bf16 v132, v78, v32, v132
  v_dot2_f32_bf16 v133, v78, v33, v133
  v_dot2_f32_bf16 v134, v79, v32, v134
  v_dot2_f32_bf16 v135, v79, v33, v135
  s_bitset0_b32 s8, 7
LS1bl_gan7:
  s_waitcnt vmcnt(7)
  v_max_u32 v31, v80, v81
  v_cmp_eq_u32 vcc, -1, v31
  s_cbranch_vccnz LS1bl_gar8
  v_dot2_f32_bf16 v132, v80, v32, v132
  v_dot2_f32_bf16 v133, v80, v33, v133
  v_dot2_f32_bf16 v134, v81, v32, v134
  v_dot2_f32_bf16 v135, v81, v33, v135
  s_bitset0_b32 s8, 8
LS1bl_gan8:
  s_waitcnt vmcnt(6)
  v_max_u32 v31, v82, v83
  v_cmp_eq_u32 vcc, -1, v31
  s_cbranch_vccnz LS1bl_gar9
  v_dot2_f32_bf16 v132, v82, v32, v132
  v_dot2_f32_bf16 v133, v82, v33, v133
  v_dot2_f32_bf16 v134, v83, v32, v134
  v_dot2_f32_bf16 v135, v83, v33, v135
  s_bitset0_b32 s8, 9
LS1bl_gan9:
  s_waitcnt vmcnt(5)
  v_max_u32 v31, v84, v85
  v_cmp_eq_u32 vcc, -1, v31
  s_cbranch_vccnz LS1bl_gar10
  v_dot2_f32_bf16 v132, v84, v32, v132
  v_dot2_f32_bf16 v133, v84, v33, v133
  v_dot2_f32_bf16 v134, v85, v32, v134
  v_dot2_f32_bf16 v135, v85, v33, v135
  s_bitset0_b32 s8, 10
LS1bl_gan10:
  s_waitcnt vmcnt(4)
  v_max_u32 v31, v86, v87
  v_cmp_eq_u32 vcc, -1, v31
  s_cbranch_vccnz LS1bl_gar11
  v_dot2_f32_bf16 v132, v86, v32, v132
  v_dot2_f32_bf16 v133, v86, v33, v133
  v_dot2_f32_bf16 v134, v87, v32, v134
  v_dot2_f32_bf16 v135, v87, v33, v135
  s_bitset0_b32 s8, 11
LS1bl_gan11:
  s_waitcnt vmcnt(3)
  v_max_u32 v31, v88, v89
  v_cmp_eq_u32 vcc, -1, v31
  s_cbranch_vccnz LS1bl_gar12
  v_dot2_f32_bf16 v132, v88, v32, v132
  v_dot2_f32_bf16 v133, v88, v33, v133
  v_dot2_f32_bf16 v134, v89, v32, v134
  v_dot2_f32_bf16 v135, v89, v33, v135
  s_bitset0_b32 s8, 12
LS1bl_gan12:
  s_waitcnt vmcnt(2)
  v_max_u32 v31, v90, v91
  v_cmp_eq_u32 vcc, -1, v31
  s_cbranch_vccnz LS1bl_gar13
  v_dot2_f32_bf16 v132, v90, v32, v132
  v_dot2_f32_bf16 v133, v90, v33, v133
  v_dot2_f32_bf16 v134, v91, v32, v134
  v_dot2_f32_bf16 v135, v91, v33, v135
  s_bitset0_b32 s8, 13
LS1bl_gan13:
  s_waitcnt vmcnt(1)
  v_max_u32 v31, v92, v93
  v_cmp_eq_u32 vcc, -1, v31
  s_cbranch_vccnz LS1bl_gar14
  v_dot2_f32_bf16 v132, v92, v32, v132
  v_dot2_f32_bf16 v133, v92, v33, v133
  v_dot2_f32_bf16 v134, v93, v32, v134
  v_dot2_f32_bf16 v135, v93, v33, v135
  s_bitset0_b32 s8, 14
LS1bl_gan14:
  s_waitcnt vmcnt(0)
  v_max_u32 v31, v94, v95
  v_cmp_eq_u32 vcc, -1, v31
  s_cbranch_vccnz LS1bl_gar15
  v_dot2_f32_bf16 v132, v94, v32, v132
  v_dot2_f32_bf16 v133, v94, v33, v133
  v_dot2_f32_bf16 v134, v95, v32, v134
  v_dot2_f32_bf16 v135, v95, v33, v135
  s_bitset0_b32 s8, 15
LS1bl_gan15:
LS1bl_gchk:
  s_cmp_eq_u32 s8, 0
  s_cbranch_scc1 LS1bl_gok
  s_waitcnt vmcnt(0)
  s_bitcmp1_b32 s8, 16
  s_cbranch_scc0 LS1bl_gbn16
  v_max3_u32 v31, v128, v129, v130
  v_max_u32 v31, v31, v131
  v_cmp_eq_u32 vcc, -1, v31
  s_cbranch_vccnz LS1bl_gbr16
  v_add_f32_dpp v128, v128, v128 row_ror:8 row_mask:0xf bank_mask:0xf
  v_add_f32_dpp v129, v129, v129 row_ror:8 row_mask:0xf bank_mask:0xf
  v_add_f32_dpp v130, v130, v130 row_ror:8 row_mask:0xf bank_mask:0xf
  v_add_f32_dpp v131, v131, v131 row_ror:8 row_mask:0xf bank_mask:0xf
  v_add_f32_dpp v128, v128, v128 row_ror:4 row_mask:0xf bank_mask:0xf
  v_add_f32_dpp v129, v129, v129 row_ror:4 row_mask:0xf bank_mask:0xf
  v_add_f32_dpp v130, v130, v130 row_ror:4 row_mask:0xf bank_mask:0xf
  v_add_f32_dpp v131, v131, v131 row_ror:4 row_mask:0xf bank_mask:0xf
  v_add_f32_dpp v128, v128, v128 row_ror:2 row_mask:0xf bank_mask:0xf
  v_add_f32_dpp v129, v129, v129 row_ror:2 row_mask:0xf bank_mask:0xf
  v_add_f32_dpp v130, v130, v130 row_ror:2 row_mask:0xf bank_mask:0xf
  v_add_f32_dpp v131, v131, v131 row_ror:2 row_mask:0xf bank_mask:0xf
  v_add_f32_dpp v128, v128, v128 row_ror:1 row_mask:0xf bank_mask:0xf
  v_add_f32_dpp v129, v129, v129 row_ror:1 row_mask:0xf bank_mask:0xf
  v_add_f32_dpp v130, v130, v130 row_ror:1 row_mask:0xf bank_mask:0xf
  v_add_f32_dpp v131, v131, v131 row_ror:1 row_mask:0xf bank_mask:0xf
  v_cvt_pk_bf16_f32 v142, v128, v129
  v_cvt_pk_bf16_f32 v143, v130, v131
  s_bitset0_b32 s8, 16
LS1bl_gbn16:
  s_bitcmp1_b32 s8, 0
  s_cbranch_scc0 LS1bl_gbn0
  v_max_u32 v31, v64, v65
  v_cmp_eq_u32 vcc, -1, v31
  s_cbranch_vccnz LS1bl_gbr0
  v_dot2_f32_bf16 v132, v64, v32, v132
  v_dot2_f32_bf16 v133, v64, v33, v133
  v_dot2_f32_bf16 v134, v65, v32, v134
  v_dot2_f32_bf16 v135, v65, v33, v135
  s_bitset0_b32 s8, 0
LS1bl_gbn0:
  s_bitcmp1_b32 s8, 1
  s_cbranch_scc0 LS1bl_gbn1
  v_max_u32 v31, v66, v67
  v_cmp_eq_u32 vcc, -1, v31
  s_cbranch_vccnz LS1bl_gbr1
  v_dot2_f32_bf16 v132, v66, v32, v132
  v_dot2_f32_bf16 v133, v66, v33, v133
  v_dot2_f32_bf16 v134, v67, v32, v134
  v_dot2_f32_bf16 v135, v67, v33, v135
  s_bitset0_b32 s8, 1
LS1bl_gbn1:
  s_bitcmp1_b32 s8, 2
  s_cbranch_scc0 LS1bl_gbn2
  v_max_u32 v31, v68, v69
  v_cmp_eq_u32 vcc, -1, v31
  s_cbranch_vccnz LS1bl_gbr2
  v_dot2_f32_bf16 v132, v68, v32, v132
  v_dot2_f32_bf16 v133, v68, v33, v133
  v_dot2_f32_bf16 v134, v69, v32, v134
  v_dot2_f32_bf16 v135, v69, v33, v135
  s_bitset0_b32 s8, 2
LS1bl_gbn2:
  s_bitcmp1_b32 s8, 3
  s_cbranch_scc0 LS1bl_gbn3
  v_max_u32 v31, v70, v71
  v_cmp_eq_u32 vcc, -1, v31
  s_cbranch_vccnz LS1bl_gbr3
  v_dot2_f32_bf16 v132, v70, v32, v132
  v_dot2_f32_bf16 v133, v70, v33, v133
  v_dot2_f32_bf16 v134, v71, v32, v134
  v_dot2_f32_bf16 v135, v71, v33, v135
  s_bitset0_b32 s8, 3
LS1bl_gbn3:
  s_bitcmp1_b32 s8, 4
  s_cbranch_scc0 LS1bl_gbn4
  v_max_u32 v31, v72, v73
  v_cmp_eq_u32 vcc, -1, v31
  s_cbranch_vccnz LS1bl_gbr4
  v_dot2_f32_bf16 v132, v72, v32, v132
  v_dot2_f32_bf16 v133, v72, v33, v133
  v_dot2_f32_bf16 v134, v73, v32, v134
  v_dot2_f32_bf16 v135, v73, v33, v135
  s_bitset0_b32 s8, 4
LS1bl_gbn4:
  s_bitcmp1_b32 s8, 5
  s_cbranch_scc0 LS1bl_gbn5
  v_max_u32 v31, v74, v75
  v_cmp_eq_u32 vcc, -1, v31
  s_cbranch_vccnz LS1bl_gbr5
  v_dot2_f32_bf16 v132, v74, v32, v132
  v_dot2_f32_bf16 v133, v74, v33, v133
  v_dot2_f32_bf16 v134, v75, v32, v134
  v_dot2_f32_bf16 v135, v75, v33, v135
  s_bitset0_b32 s8, 5
LS1bl_gbn5:
  s_bitcmp1_b32 s8, 6
  s_cbranch_scc0 LS1bl_gbn6
  v_max_u32 v31, v76, v77
  v_cmp_eq_u32 vcc, -1, v31
  s_cbranch_vccnz LS1bl_gbr6
  v_dot2_f32_bf16 v132, v76, v32, v132
  v_dot2_f32_bf16 v133, v76, v33, v133
  v_dot2_f32_bf16 v134, v77, v32, v134
  v_dot2_f32_bf16 v135, v77, v33, v135
  s_bitset0_b32 s8, 6
LS1bl_gbn6:
  s_bitcmp1_b32 s8, 7
  s_cbranch_scc0 LS1bl_gbn7
  v_max_u32 v31, v78, v79
  v_cmp_eq_u32 vcc, -1, v31
  s_cbranch_vccnz LS1bl_gbr7
  v_dot2_f32_bf16 v132, v78, v32, v132
  v_dot2_f32_bf16 v133, v78, v33, v133
  v_dot2_f32_bf16 v134, v79, v32, v134
  v_dot2_f32_bf16 v135, v79, v33, v135
  s_bitset0_b32 s8, 7
LS1bl_gbn7:
  s_bitcmp1_b32 s8, 8
  s_cbranch_scc0 LS1bl_gbn8
  v_max_u32 v31, v80, v81
  v_cmp_eq_u32 vcc, -1, v31
  s_cbranch_vccnz LS1bl_gbr8
  v_dot2_f32_bf16 v132, v80, v32, v132
  v_dot2_f32_bf16 v133, v80, v33, v133
  v_dot2_f32_bf16 v134, v81, v32, v134
  v_dot2_f32_bf16 v135, v81, v33, v135
  s_bitset0_b32 s8, 8
LS1bl_gbn8:
  s_bitcmp1_b32 s8, 9
  s_cbranch_scc0 LS1bl_gbn9
  v_max_u32 v31, v82, v83
  v_cmp_eq_u32 vcc, -1, v31
  s_cbranch_vccnz LS1bl_gbr9
  v_dot2_f32_bf16 v132, v82, v32, v132
  v_dot2_f32_bf16 v133, v82, v33, v133
  v_dot2_f32_bf16 v134, v83, v32, v134
  v_dot2_f32_bf16 v135, v83, v33, v135
  s_bitset0_b32 s8, 9
LS1bl_gbn9:
  s_bitcmp1_b32 s8, 10
  s_cbranch_scc0 LS1bl_gbn10
  v_max_u32 v31, v84, v85
  v_cmp_eq_u32 vcc, -1, v31
  s_cbranch_vccnz LS1bl_gbr10
  v_dot2_f32_bf16 v132, v84, v32, v132
  v_dot2_f32_bf16 v133, v84, v33, v133
  v_dot2_f32_bf16 v134, v85, v32, v134
  v_dot2_f32_bf16 v135, v85, v33, v135
  s_bitset0_b32 s8, 10
LS1bl_gbn10:
  s_bitcmp1_b32 s8, 11
  s_cbranch_scc0 LS1bl_gbn11
  v_max_u32 v31, v86, v87
  v_cmp_eq_u32 vcc, -1, v31
  s_cbranch_vccnz LS1bl_gbr11
  v_dot2_f32_bf16 v132, v86, v32, v132
  v_dot2_f32_bf16 v133, v86, v33, v133
  v_dot2_f32_bf16 v134, v87, v32, v134
  v_dot2_f32_bf16 v135, v87, v33, v135
  s_bitset0_b32 s8, 11
LS1bl_gbn11:
  s_bitcmp1_b32 s8, 12
  s_cbranch_scc0 LS1bl_gbn12
  v_max_u32 v31, v88, v89
  v_cmp_eq_u32 vcc, -1, v31
  s_cbranch_vccnz LS1bl_gbr12
  v_dot2_f32_bf16 v132, v88, v32, v132
  v_dot2_f32_bf16 v133, v88, v33, v133
  v_dot2_f32_bf16 v134, v89, v32, v134
  v_dot2_f32_bf16 v135, v89, v33, v135
  s_bitset0_b32 s8, 12
LS1bl_gbn12:
  s_bitcmp1_b32 s8, 13
  s_cbranch_scc0 LS1bl_gbn13
  v_max_u32 v31, v90, v91
  v_cmp_eq_u32 vcc, -1, v31
  s_cbranch_vccnz LS1bl_gbr13
  v_dot2_f32_bf16 v132, v90, v32, v132
  v_dot2_f32_bf16 v133, v90, v33, v133
  v_dot2_f32_bf16 v134, v91, v32, v134
  v_dot2_f32_bf16 v135, v91, v33, v135
  s_bitset0_b32 s8, 13
LS1bl_gbn13:
  s_bitcmp1_b32 s8, 14
  s_cbranch_scc0 LS1bl_gbn14
  v_max_u32 v31, v92, v93
  v_cmp_eq_u32 vcc, -1, v31
  s_cbranch_vccnz LS1bl_gbr14
  v_dot2_f32_bf16 v132, v92, v32, v132
  v_dot2_f32_bf16 v133, v92, v33, v133
  v_dot2_f32_bf16 v134, v93, v32, v134
  v_dot2_f32_bf16 v135, v93, v33, v135
  s_bitset0_b32 s8, 14
LS1bl_gbn14:
  s_bitcmp1_b32 s8, 15
  s_cbranch_scc0 LS1bl_gbn15
  v_max_u32 v31, v94, v95
  v_cmp_eq_u32 vcc, -1, v31
  s_cbranch_vccnz LS1bl_gbr15
  v_dot2_f32_bf16 v132, v94, v32, v132
  v_dot2_f32_bf16 v133, v94, v33, v133
  v_dot2_f32_bf16 v134, v95, v32, v134
  v_dot2_f32_bf16 v135, v95, v33, v135
  s_bitset0_b32 s8, 15
LS1bl_gbn15:
  s_sub_u32 s0, s0, 1
  s_cbranch_scc0 LS1bl_gchk
  s_mov_b32 s0, 0
  s_waitcnt vmcnt(0)
  s_branch LS1bl_gok
LS1bl_gar16:
  buffer_load_dwordx4 v[128:131], v27, s[56:59], s50 offen sc1
  s_branch LS1bl_gan16
LS1bl_gar0:
  s_add_u32 s7, s50, 0
  buffer_load_dwordx2 v[64:65], v26, s[56:59], s7 offen sc1
  s_branch LS1bl_gan0
LS1bl_gar1:
  s_add_u32 s7, s50, 2304
  buffer_load_dwordx2 v[66:67], v26, s[56:59], s7 offen sc1
  s_branch LS1bl_gan1
LS1bl_gar2:
  s_add_u32 s7, s50, 4608
  buffer_load_dwordx2 v[68:69], v26, s[56:59], s7 offen sc1
  s_branch LS1bl_gan2
LS1bl_gar3:
  s_add_u32 s7, s50, 6912
  buffer_load_dwordx2 v[70:71], v26, s[56:59], s7 offen sc1
  s_branch LS1bl_gan3
LS1bl_gar4:
  s_add_u32 s7, s50, 9216
  buffer_load_dwordx2 v[72:73], v26, s[56:59], s7 offen sc1
  s_branch LS1bl_gan4
LS1bl_gar5:
  s_add_u32 s7, s50, 11520
  buffer_load_dwordx2 v[74:75], v26, s[56:59], s7 offen sc1
  s_branch LS1bl_gan5
LS1bl_gar6:
  s_add_u32 s7, s50, 13824
  buffer_load_dwordx2 v[76:77], v26, s[56:59], s7 offen sc1
  s_branch LS1bl_gan6
LS1bl_gar7:
  s_add_u32 s7, s50, 16128
  buffer_load_dwordx2 v[78:79], v26, s[56:59], s7 offen sc1
  s_branch LS1bl_gan7
LS1bl_gar8:
  s_add_u32 s7, s50, 18432
  buffer_load_dwordx2 v[80:81], v26, s[56:59], s7 offen sc1
  s_branch LS1bl_gan8
LS1bl_gar9:
  s_add_u32 s7, s50, 20736
  buffer_load_dwordx2 v[82:83], v26, s[56:59], s7 offen sc1
  s_branch LS1bl_gan9
LS1bl_gar10:
  s_add_u32 s7, s50, 23040
  buffer_load_dwordx2 v[84:85], v26, s[56:59], s7 offen sc1
  s_branch LS1bl_gan10
LS1bl_gar11:
  s_add_u32 s7, s50, 25344
  buffer_load_dwordx2 v[86:87], v26, s[56:59], s7 offen sc1
  s_branch LS1bl_gan11
LS1bl_gar12:
  s_add_u32 s7, s50, 27648
  buffer_load_dwordx2 v[88:89], v26, s[56:59], s7 offen sc1
  s_branch LS1bl_gan12
LS1bl_gar13:
  s_add_u32 s7, s50, 29952
  buffer_load_dwordx2 v[90:91], v26, s[56:59], s7 offen sc1
  s_branch LS1bl_gan13
LS1bl_gar14:
  s_add_u32 s7, s50, 32256
  buffer_load_dwordx2 v[92:93], v26, s[56:59], s7 offen sc1
  s_branch LS1bl_gan14
LS1bl_gar15:
  s_add_u32 s7, s50, 34560
  buffer_load_dwordx2 v[94:95], v26, s[56:59], s7 offen sc1
  s_branch LS1bl_gan15
LS1bl_gbr16:
  buffer_load_dwordx4 v[128:131], v27, s[56:59], s50 offen sc1
  s_branch LS1bl_gbn16
LS1bl_gbr0:
  s_add_u32 s7, s50, 0
  buffer_load_dwordx2 v[64:65], v26, s[56:59], s7 offen sc1
  s_branch LS1bl_gbn0
LS1bl_gbr1:
  s_add_u32 s7, s50, 2304
  buffer_load_dwordx2 v[66:67], v26, s[56:59], s7 offen sc1
  s_branch LS1bl_gbn1
LS1bl_gbr2:
  s_add_u32 s7, s50, 4608
  buffer_load_dwordx2 v[68:69], v26, s[56:59], s7 offen sc1
  s_branch LS1bl_gbn2
LS1bl_gbr3:
  s_add_u32 s7, s50, 6912
  buffer_load_dwordx2 v[70:71], v26, s[56:59], s7 offen sc1
  s_branch LS1bl_gbn3
LS1bl_gbr4:
  s_add_u32 s7, s50, 9216
  buffer_load_dwordx2 v[72:73], v26, s[56:59], s7 offen sc1
  s_branch LS1bl_gbn4
LS1bl_gbr5:
  s_add_u32 s7, s50, 11520
  buffer_load_dwordx2 v[74:75], v26, s[56:59], s7 offen sc1
  s_branch LS1bl_gbn5
LS1bl_gbr6:
  s_add_u32 s7, s50, 13824
  buffer_load_dwordx2 v[76:77], v26, s[56:59], s7 offen sc1
  s_branch LS1bl_gbn6
LS1bl_gbr7:
  s_add_u32 s7, s50, 16128
  buffer_load_dwordx2 v[78:79], v26, s[56:59], s7 offen sc1
  s_branch LS1bl_gbn7
LS1bl_gbr8:
  s_add_u32 s7, s50, 18432
  buffer_load_dwordx2 v[80:81], v26, s[56:59], s7 offen sc1
  s_branch LS1bl_gbn8
LS1bl_gbr9:
  s_add_u32 s7, s50, 20736
  buffer_load_dwordx2 v[82:83], v26, s[56:59], s7 offen sc1
  s_branch LS1bl_gbn9
LS1bl_gbr10:
  s_add_u32 s7, s50, 23040
  buffer_load_dwordx2 v[84:85], v26, s[56:59], s7 offen sc1
  s_branch LS1bl_gbn10
LS1bl_gbr11:
  s_add_u32 s7, s50, 25344
  buffer_load_dwordx2 v[86:87], v26, s[56:59], s7 offen sc1
  s_branch LS1bl_gbn11
LS1bl_gbr12:
  s_add_u32 s7, s50, 27648
  buffer_load_dwordx2 v[88:89], v26, s[56:59], s7 offen sc1
  s_branch LS1bl_gbn12
LS1bl_gbr13:
  s_add_u32 s7, s50, 29952
  buffer_load_dwordx2 v[90:91], v26, s[56:59], s7 offen sc1
  s_branch LS1bl_gbn13
LS1bl_gbr14:
  s_add_u32 s7, s50, 32256
  buffer_load_dwordx2 v[92:93], v26, s[56:59], s7 offen sc1
  s_branch LS1bl_gbn14
LS1bl_gbr15:
  s_add_u32 s7, s50, 34560
  buffer_load_dwordx2 v[94:95], v26, s[56:59], s7 offen sc1
  s_branch LS1bl_gbn15
LS1bl_gok:
  v_cvt_pk_bf16_f32 v140, v132, v133
  v_cvt_pk_bf16_f32 v141, v134, v135
  ds_write_b64 v28, v[140:141]
  s_mov_b32 exec_lo, 0x00010001
  s_mov_b32 exec_hi, 0x00010001
  ds_write_b64 v29, v[142:143]
  s_mov_b64 exec, -1
  s_waitcnt lgkmcnt(0)
  s_barrier
  s_lshl_b32 s7, s5, 2
  s_add_u32 s6, s15, 3
  s_add_u32 s7, s7, 161824
  v_mov_b32 v232, s6
  v_mov_b32 v233, s7
  s_mov_b64 exec, 1
  ds_write_b32 v233, v232
  s_mov_b64 exec, -1
LS1bl_fin:
LS1bl_skip:
  s_branch LXl_loop
.section .rodata,"a"
.p2align 6
.amdhsa_kernel hh_all_kernel
  .amdhsa_next_free_vgpr 256
  .amdhsa_next_free_sgpr 102
  .amdhsa_accum_offset 256
  .amdhsa_group_segment_fixed_size 0
  .amdhsa_kernarg_size 96
  .amdhsa_user_sgpr_count 2
  .amdhsa_user_sgpr_kernarg_segment_ptr 1
  .amdhsa_system_sgpr_workgroup_id_x 1
.end_amdhsa_kernel
```
